```python
import torch

def _softmax(x, axis=-1):
    return torch.softmax(x, dim=axis)
def _gelu(x):
    return torch.nn.functional.gelu(x, approximate="tanh")
def _silu(x):
    return torch.nn.functional.silu(x)
def _sigmoid(x):
    return torch.sigmoid(x)
def _layernorm(x, axis=-1, eps=1e-5):
    m = x.mean(dim=axis, keepdim=True)
    v = x.var(dim=axis, keepdim=True, unbiased=False)
    return (x - m) / torch.sqrt(v + eps)
def _scatter_add(tgt, idx, src, axis=0):
    return tgt.clone().index_add_(axis, idx, src)
def _segment_sum(src, seg, n):
    out = torch.zeros((n,) + src.shape[1:], dtype=src.dtype)
    return out.index_add_(0, seg, src)
def _pad(x, pw):
    flat = tuple(v for pair in reversed(pw) for v in pair)
    return torch.nn.functional.pad(x, flat)

kernel_name = 'recurrent_scan__ssm_conv_s5__glu_gated_reglu__prompt'

def setup_inputs():

    _w = (lambda a: (lambda t: t.to(torch.bfloat16) if t.is_floating_point() else t)(torch.as_tensor(a)))
    def _A_setup():
        B, S, D = 1, 2048, 640
        P = D
        Lambda_re = -0.5 * (lambda _x: torch.exp(torch.as_tensor(_x)))((lambda *s: torch.randn(*s, dtype=torch.bfloat16) * 0.8)(P))
        Lambda_im = (lambda *s: torch.randn(*s, dtype=torch.bfloat16) * 0.8)(P) * 1.0
        B_re = (lambda *s: torch.randn(*s, dtype=torch.bfloat16) * 0.8)(P, D) * (D ** -0.5)
        B_im = (lambda *s: torch.randn(*s, dtype=torch.bfloat16) * 0.8)(P, D) * (D ** -0.5)
        C_re = (lambda *s: torch.randn(*s, dtype=torch.bfloat16) * 0.8)(D, P) * (P ** -0.5)
        C_im = (lambda *s: torch.randn(*s, dtype=torch.bfloat16) * 0.8)(D, P) * (P ** -0.5)
        log_dt = (lambda *s: torch.randn(*s, dtype=torch.bfloat16) * 0.8)(P) * 0.3 - 2.0
        Dskip = (lambda *s: torch.randn(*s, dtype=torch.bfloat16) * 0.8)(D)
        return {
            "x": _w((lambda *s: torch.randn(*s, dtype=torch.bfloat16) * 0.05)(B, S, D)),
            "Lambda_re": _w(Lambda_re),
            "Lambda_im": _w(Lambda_im),
            "B_re": _w(B_re),
            "B_im": _w(B_im),
            "C_re": _w(C_re),
            "C_im": _w(C_im),
            "log_dt": _w(log_dt),
            "Dskip": _w(Dskip),
        }
    _A_in = _A_setup()

    def _B_setup():
        B, S, D, F = 1, 2048, 640, 1728
        return {
            "x": _w((lambda *s: torch.randn(*s, dtype=torch.bfloat16) * 0.05)(B, S, D)),
            "W_gate": _w((lambda *s: torch.randn(*s, dtype=torch.bfloat16) * 0.2)(D, F) * (2.0 / D) ** 0.5),
            "W_up": _w((lambda *s: torch.randn(*s, dtype=torch.bfloat16) * 0.2)(D, F) * (2.0 / D) ** 0.5),
            "W_down": _w((lambda *s: torch.randn(*s, dtype=torch.bfloat16) * 0.2)(F, D) * (1.0 / F) ** 0.5),
        }
    _B_in = _B_setup()

    return {
        "A_x": _A_in["x"],
        "A_Lambda_re": _A_in["Lambda_re"],
        "A_Lambda_im": _A_in["Lambda_im"],
        "A_B_re": _A_in["B_re"],
        "A_B_im": _A_in["B_im"],
        "A_C_re": _A_in["C_re"],
        "A_C_im": _A_in["C_im"],
        "A_log_dt": _A_in["log_dt"],
        "A_Dskip": _A_in["Dskip"],
        "B_x": _B_in["x"],
        "B_W_gate": _B_in["W_gate"],
        "B_W_up": _B_in["W_up"],
        "B_W_down": _B_in["W_down"],
    }

def reference(A_x, A_Lambda_re, A_Lambda_im, A_B_re, A_B_im, A_C_re, A_C_im, A_log_dt, A_Dskip, B_x, B_W_gate, B_W_up, B_W_down):
    def _A_ref(x, Lambda_re, Lambda_im, B_re, B_im, C_re, C_im, log_dt, Dskip):
        Bsz, L, H = x.shape
        Lam = Lambda_re + 1j * Lambda_im
        Bmat = B_re + 1j * B_im
        Cmat = C_re + 1j * C_im
        dt = torch.exp(log_dt)
        Lam_bar = torch.exp(dt * Lam)
        B_bar = ((Lam_bar - 1.0) / Lam)[:, None] * Bmat
        Bu = torch.einsum("bld,pd->blp", x + 0j, B_bar)
        h = torch.zeros_like(Bu[:, 0, :])
        hs = []
        for t in range(L):
            h = Lam_bar[None, :] * h + Bu[:, t, :]
            hs.append(h)
        hseq = torch.stack(hs, 1)
        y = 2.0 * torch.einsum("blp,dp->bld", hseq, Cmat).real + x * Dskip[None, None, :]
        return y

    def _B_ref(x, W_gate, W_up, W_down):
        gate = torch.einsum("bsd,df->bsf", x, W_gate)
        up = torch.einsum("bsd,df->bsf", x, W_up)
        gate = gate * (lambda x, dt: x.to(dt))(gate > 0, gate.dtype)
        h = gate * up
        return torch.einsum("bsf,fd->bsd", h, W_down)

    x = A_x
    xn = _layernorm(x, axis=-1)
    s = _A_ref(xn, A_Lambda_re, A_Lambda_im, A_B_re, A_B_im, A_C_re, A_C_im, A_log_dt, A_Dskip)
    g = _silu(_B_ref(xn, B_W_gate, B_W_up, B_W_down))
    return x + s * g
```

```asm
; @launch grid=(256,1,1) block=(256,1,1) lds=163840
.amdgcn_target "amdgcn-amd-amdhsa--gfx950"
.text
.globl recurrent_scan__ssm_conv_s5__glu_gated_reglu__prompt_kernel
.p2align 8
.type recurrent_scan__ssm_conv_s5__glu_gated_reglu__prompt_kernel,@function
recurrent_scan__ssm_conv_s5__glu_gated_reglu__prompt_kernel:
  s_cmp_ge_u32 s2, 256
  s_cbranch_scc1 L_end
  s_load_dwordx16 s[36:51], s[0:1], 0
  s_load_dwordx16 s[52:67], s[0:1], 64
  s_getpc_b64 s[84:85]
  s_lshr_b32 s3, s2, 3
  s_mul_i32 s3, s3, 1664
  v_and_b32_e32 v2, 31, v0
  v_lshl_add_u32 v3, v2, 7, s3
  v_min_u32 v3, 51912, v3
  global_load_dword v91, v3, s[84:85]
  v_lshrrev_b32_e32 v2, 6, v0
  v_and_b32_e32 v1, 63, v0
  v_readfirstlane_b32 s28, v2
  s_and_b32 s84, s2, 7
  s_lshr_b32 s85, s2, 3
  s_and_b32 s29, s84, 1
  s_lshl_b32 s29, s29, 3
  s_and_b32 s86, s85, 7
  s_add_u32 s29, s29, s86
  s_lshr_b32 s86, s84, 1
  s_lshr_b32 s87, s85, 3
  s_lshl_b32 s30, s86, 2
  s_add_u32 s30, s30, s87
  s_lshl_b32 s33, s84, 2
  s_and_b32 s84, s85, 3
  s_add_u32 s33, s33, s84
  s_lshr_b32 s34, s85, 2
  s_mov_b32 s31, 0xffff0000
  s_and_b32 s35, s30, 3
  s_mul_i32 s35, s35, 5
  s_lshr_b32 s35, s35, 1
  s_min_u32 s84, s86, 2
  s_add_u32 s35, s35, s84
  s_lshr_b32 s35, s35, 4
  s_lshl_b32 s35, s35, 7
  s_mul_i32 s84, s86, 3
  s_add_u32 s84, s84, s87
  s_lshl_b32 s93, s84, 1
  s_add_u32 s94, s93, 1
  s_lshl_b32 s85, s86, 1
  s_add_u32 s85, s85, 12
  s_add_u32 s86, s86, 24
  s_cmp_eq_u32 s87, 3
  s_cselect_b32 s95, s85, s84
  s_cselect_b32 s94, s86, s94
  v_lshrrev_b32_e32 v52, 3, v1
  v_and_b32_e32 v51, 7, v1
  v_lshrrev_b32_e32 v56, 2, v51
  v_lshlrev_b32_e32 v56, 4, v56
  v_and_or_b32 v56, v51, 3, v56
  s_lshr_b32 s84, s30, 2
  s_lshl2_add_u32 s92, s29, s84
  s_lshl_b32 s84, s92, 5
  s_lshl2_add_u32 s84, s87, s84
  v_add_u32_e64 v50, s84, v56
  v_mul_u32_u24 v56, 1280, v50
  s_mul_i32 s85, s28, 20
  v_add_u32_e32 v57, s85, v52
  v_lshl_add_u32 v48, v57, 4, v56
  v_lshrrev_b32_e64 v58, 5, v1
  v_lshl_add_u32 v49, v58, 28, v48
  v_lshlrev_b32_e64 v64, 9, v57
  v_lshl_add_u32 v64, v51, 4, v64
  v_lshl_add_u32 v65, v58, 28, v64
  s_waitcnt lgkmcnt(0)
  s_mov_b32 s4, s36
  s_mov_b32 s5, s37
  s_mov_b32 s6, 2621440
  s_mov_b32 s7, 0x20000
  buffer_load_dwordx4 v[96:99], v48, s[4:7], 0 offen offset:0
  buffer_load_dwordx4 v[100:103], v48, s[4:7], 0 offen offset:128
  buffer_load_dwordx4 v[104:107], v49, s[4:7], 0 offen offset:256
  s_add_u32 s84, s66, 13041664
  s_addc_u32 s85, s67, 0
  s_load_dword s32, s[84:85], 0
  s_cmp_eq_u32 s87, 3
  s_cbranch_scc1 L_T2
  s_mov_b32 s80, s35
  s_mov_b32 s8, s42
  s_mov_b32 s9, s43
  s_mov_b32 s10, 819200
  s_mov_b32 s11, 0x20000
  s_sub_u32 s12, s44, 1024
  s_subb_u32 s13, s45, 0
  s_mov_b32 s14, 820224
  s_mov_b32 s15, 0x20000
  s_mov_b32 s16, s56
  s_mov_b32 s17, s57
  s_mov_b32 s18, 2211840
  s_mov_b32 s19, 0x20000
  s_sub_u32 s20, s58, 2048
  s_subb_u32 s21, s59, 0
  s_mov_b32 s22, 2213888
  s_mov_b32 s23, 0x20000
  s_lshl_b32 s84, s29, 2
  s_add_u32 s84, s84, s28
  v_lshl_add_u32 v56, v1, 7, s80
  v_subrev_u32 v57, 1280, v56
  v_min_u32_e32 v56, v56, v57
  s_mul_i32 s85, s84, 3456
  v_mul_u32_u24 v57, 1728, v56
  v_add_u32_e32 v90, s85, v57
  s_lshr_b32 s84, s84, 1
  s_mul_i32 s84, s84, 1280
  v_add_u32_e64 v53, s84, v56
  s_mul_i32 s88, s95, 40960
  s_lshl_b32 s81, s93, 7
  s_lshl_b32 s82, s94, 7
  s_mov_b64 exec, 1023
  buffer_load_dword v91, v53, s[8:11], s88 offen
  buffer_load_dword v91, v53, s[12:15], s88 offen offset:1024
  buffer_load_dword v91, v90, s[16:19], s81 offen
  buffer_load_dword v91, v90, s[20:23], s81 offen offset:2048
  s_mov_b64 exec, -1
  v_and_b32_e32 v79, 31, v1
  s_lshl_b32 s84, s95, 5
  v_add_u32_e32 v54, s84, v79
  v_lshlrev_b32_e64 v55, 1, v54
  global_load_ushort v60, v55, s[38:39]
  global_load_ushort v61, v55, s[40:41]
  global_load_ushort v62, v55, s[50:51]
  s_sub_u32 s84, 15, s29
  s_lshl_b32 s84, s84, 10
  v_lshl_add_u32 v46, v79, 4, s84
  v_lshrrev_b32_e64 v56, 5, v1
  v_lshl_add_u32 v46, v56, 13, v46
  v_lshlrev_b32_e32 v56, 3, v56
  v_sub_u32_e32 v56, s29, v56
  v_med3_i32 v28, v56, 0, 8
  v_lshlrev_b32_e32 v43, 3, v79
  s_lshl_b32 s84, s28, 10
  s_add_u32 s84, s84, 73728
  v_add_u32_e32 v43, s84, v43
  s_mov_b32 s24, s66
  s_mov_b32 s25, s67
  s_mov_b32 s26, 20447232
  s_mov_b32 s27, 0x20000
  s_mul_i32 s42, s92, 40960
  s_lshl_b32 s84, s87, 7
  s_add_u32 s42, s42, s84
  s_add_u32 s42, s42, 17825792
  s_add_u32 s41, s42, 4096
  s_add_u32 s40, s42, 8192
  v_mov_b32_e32 v68, 0
  v_mov_b32_e32 v69, 0
  v_mov_b32_e32 v70, 0
  v_mov_b32_e64 v71, 0
  v_mov_b32 v72, 0x3f803f80
  v_lshlrev_b32_e64 v66, 3, v51
  v_add_u32 v66, 80896, v66
  v_lshl_add_u32 v67, s28, 6, v66
  v_lshlrev_b32_e32 v20, 4, v1
  v_and_b32_e32 v79, 31, v1
  v_lshrrev_b32_e64 v54, 5, v1
  v_bfe_u32 v55, v1, 1, 3
  v_xor_b32_e32 v55, v55, v54
  v_lshlrev_b32_e32 v55, 4, v55
  v_lshl_add_u32 v56, v79, 7, v55
  v_lshrrev_b32_e64 v57, 3, v79
  v_mul_u32_u24 v57, 5120, v57
  v_add_u32_e32 v5, v57, v56
  v_xor_b32_e32 v6, 32, v5
  v_xor_b32_e64 v7, 64, v5
  v_xor_b32 v8, 0x60, v5
  v_add_u32 v9, 40960, v5
  v_add_u32 v10, 40960, v6
  v_add_u32 v11, 40960, v7
  v_add_u32 v12, 40960, v8
  v_bfe_u32 v56, v1, 2, 2
  v_lshlrev_b32_e64 v56, 7, v56
  v_lshl_add_u32 v56, v54, 10, v56
  v_bfe_u32 v57, v1, 4, 1
  v_lshl_add_u32 v56, v57, 5, v56
  v_and_b32_e64 v57, 3, v1
  v_lshl_add_u32 v56, v57, 3, v56
  v_bfe_u32 v57, v1, 3, 1
  v_lshl_add_u32 v13, v57, 6, v56
  v_xor_b32_e64 v14, 64, v13
  v_add_u32 v15, 40960, v13
  v_add_u32 v16, 40960, v14
  v_and_b32_e32 v56, 7, v1
  s_and_b32 s84, s28, 1
  s_lshl_b32 s84, s84, 2
  v_lshrrev_b32_e32 v57, 1, v52
  v_add_u32_e32 v57, s84, v57
  v_xor_b32_e32 v57, v57, v56
  s_lshl_b32 s84, s28, 3
  v_add_u32_e32 v58, s84, v52
  v_mul_u32_u24 v58, 1280, v58
  v_lshl_add_u32 v2, v57, 4, v58
  v_bfe_u32 v57, v1, 4, 1
  v_lshlrev_b32_e32 v57, 2, v57
  v_xor_b32_e32 v57, v57, v56
  s_lshl_b32 s84, s28, 4
  v_add_u32_e32 v58, s84, v52
  v_mul_u32_u24 v58, 3456, v58
  v_lshl_add_u32 v3, v57, 4, v58
  v_add_u32 v4, 26624, v3
  v_bfe_u32 v56, v1, 2, 1
  v_lshlrev_b32_e64 v56, 10, v56
  v_lshl_add_u32 v56, v54, 8, v56
  v_lshrrev_b32_e64 v57, 3, v79
  v_lshl_add_u32 v56, v57, 6, v56
  v_and_b32_e64 v57, 3, v1
  v_lshl_add_u32 v19, v57, 4, v56
  v_lshlrev_b32_e64 v56, 3, v79
  v_lshl_add_u32 v56, v54, 9, v56
  s_lshl_b32 s84, s28, 10
  s_add_u32 s84, s84, 76800
  v_add_u32_e32 v42, s84, v56
  s_lshl_b32 s84, s28, 11
  s_add_u32 s84, s84, 16384
  v_bfe_u32 v56, v1, 1, 2
  v_bfe_u32 v58, v1, 3, 1
  v_xor_b32_e32 v58, v58, v54
  v_lshlrev_b32_e32 v58, 1, v58
  v_xor_b32_e32 v56, v56, v58
  v_lshlrev_b32_e64 v56, 4, v56
  v_lshl_add_u32 v56, v79, 6, v56
  v_add_u32_e32 v44, s84, v56
  v_lshrrev_b32_e32 v56, 4, v1
  v_lshlrev_b32_e64 v56, 3, v56
  v_bfe_u32 v58, v1, 2, 2
  v_add_u32_e32 v56, v56, v58
  v_lshlrev_b32_e32 v56, 6, v56
  v_and_b32_e32 v58, 2, v58
  v_xor_b32_e32 v58, v58, v57
  v_lshl_add_u32 v56, v58, 3, v56
  v_bfe_u32 v58, v1, 4, 1
  v_lshl_add_u32 v56, v58, 5, v56
  v_add_u32_e32 v45, s84, v56
  v_mov_b32_e32 v58, 0
  v_mov_b32_e32 v59, 0
  v_lshlrev_b32_e32 v56, 3, v1
  s_lshl_b32 s84, s28, 9
  s_add_u32 s84, s84, 73728
  v_add_u32_e32 v56, s84, v56
  ds_write_b64 v56, v[58:59]
  ds_write_b64 v56, v[58:59] offset:1024
  s_mul_i32 s88, s95, 40960
  s_lshl_b32 s84, s29, 1
  s_lshr_b32 s85, s28, 1
  s_add_u32 s84, s84, s85
  s_mul_i32 s84, s84, 385024
  s_and_b32 s85, s28, 1
  s_lshl_b32 s85, s85, 11
  s_add_u32 s84, s84, s85
  s_lshr_b32 s85, s95, 1
  s_lshl_b32 s85, s85, 2
  s_and_b32 s86, s95, 1
  s_add_u32 s85, s85, s86
  s_lshl_b32 s85, s85, 12
  s_add_u32 s92, s84, s85
  s_add_u32 s84, s84, 163840
  s_lshl_b32 s85, s93, 13
  s_add_u32 s91, s84, s85
  s_lshl_b32 s85, s94, 13
  s_add_u32 s89, s84, s85
  s_cmp_eq_u32 s94, 27
  s_cselect_b32 s89, 0x10000000, s89
  s_cselect_b32 s94, 0x200000, s94
  s_lshl_b32 s93, s93, 7
  s_lshl_b32 s94, s94, 7
  s_lshl_b32 s84, s30, 14
  s_add_u32 s84, s84, 12648448
  s_add_u32 s36, s66, s84
  s_addc_u32 s37, s67, 0
  s_mov_b32 s38, 16384
  s_mov_b32 s39, 0x20000
  s_lshl_b32 s84, s2, 2
  s_add_u32 s84, s84, s28
  s_mov_b32 s70, 819200
  s_cmpk_lt_u32 s84, 540
  s_cselect_b32 s77, 1, 0
  s_cselect_b32 s85, 0, 540
  s_cselect_b32 s68, s60, s46
  s_cselect_b32 s69, s61, s47
  s_cselect_b32 s70, 2211840, s70
  s_mov_b32 s71, 0x20000
  s_cmpk_ge_u32 s84, 740
  s_cselect_b32 s85, 740, s85
  s_cselect_b32 s68, s48, s68
  s_cselect_b32 s69, s49, s69
  s_cselect_b32 s96, 2, 0
  s_sub_u32 s84, s84, s85
  s_mul_i32 s85, s84, 6554
  s_lshr_b32 s85, s85, 16
  s_mul_i32 s86, s85, 10
  s_sub_u32 s86, s84, s86
  s_mul_i32 s72, s85, 40960
  s_lshl_b32 s84, s86, 7
  s_add_u32 s72, s72, s84
  v_and_b32_e64 v56, 7, v1
  v_mul_u32_u24 v57, 1280, v52
  v_lshl_add_u32 v88, v56, 4, v57
  s_lshl_b32 s3, s28, 12
  s_mul_i32 s80, s28, 4096
  s_add_u32 s80, s80, 81920
  s_lshl_b32 s84, s86, 2
  s_add_u32 s78, s84, 0
  s_add_u32 s84, s84, s96
  s_add_u32 s84, s84, 0
  s_lshl_b32 s79, s85, 1
  s_add_u32 s79, s79, 0
  s_add_u32 s97, s85, 40
  s_cmp_eq_u32 s77, 1
  s_cselect_b32 s78, s78, s79
  s_cselect_b32 s84, s97, s84
  s_mul_i32 s79, s78, 205
  s_lshr_b32 s79, s79, 10
  s_mul_i32 s79, s79, 465
  s_mul_i32 s84, s84, 5
  s_add_u32 s84, s84, s79
  s_add_u32 s84, s84, s78
  s_lshl_b32 s84, s84, 10
  s_add_u32 s84, s84, 13631488
  s_cmp_ge_u32 s78, 40
  s_cselect_b32 s73, 0x10000000, s84
  s_lshl_b32 s84, s86, 2
  s_add_u32 s78, s84, 1
  s_add_u32 s84, s84, s96
  s_add_u32 s84, s84, 1
  s_lshl_b32 s79, s85, 1
  s_add_u32 s79, s79, 0
  s_add_u32 s97, s85, 40
  s_cmp_eq_u32 s77, 1
  s_cselect_b32 s78, s78, s79
  s_cselect_b32 s84, s97, s84
  s_mul_i32 s79, s78, 205
  s_lshr_b32 s79, s79, 10
  s_mul_i32 s79, s79, 465
  s_mul_i32 s84, s84, 5
  s_add_u32 s84, s84, s79
  s_add_u32 s84, s84, s78
  s_lshl_b32 s84, s84, 10
  s_add_u32 s84, s84, 13631488
  s_cmp_ge_u32 s78, 40
  s_cselect_b32 s74, 0x10000000, s84
  s_lshl_b32 s84, s86, 2
  s_add_u32 s78, s84, 2
  s_add_u32 s84, s84, s96
  s_add_u32 s84, s84, 0
  s_lshl_b32 s79, s85, 1
  s_add_u32 s79, s79, 1
  s_add_u32 s97, s85, 40
  s_cmp_eq_u32 s77, 1
  s_cselect_b32 s78, s78, s79
  s_cselect_b32 s84, s97, s84
  s_mul_i32 s79, s78, 205
  s_lshr_b32 s79, s79, 10
  s_mul_i32 s79, s79, 465
  s_mul_i32 s84, s84, 5
  s_add_u32 s84, s84, s79
  s_add_u32 s84, s84, s78
  s_lshl_b32 s84, s84, 10
  s_add_u32 s84, s84, 13631488
  s_cmp_ge_u32 s78, 40
  s_cselect_b32 s75, 0x10000000, s84
  s_lshl_b32 s84, s86, 2
  s_add_u32 s78, s84, 3
  s_add_u32 s84, s84, s96
  s_add_u32 s84, s84, 1
  s_lshl_b32 s79, s85, 1
  s_add_u32 s79, s79, 1
  s_add_u32 s97, s85, 40
  s_cmp_eq_u32 s77, 1
  s_cselect_b32 s78, s78, s79
  s_cselect_b32 s84, s97, s84
  s_mul_i32 s79, s78, 205
  s_lshr_b32 s79, s79, 10
  s_mul_i32 s79, s79, 465
  s_mul_i32 s84, s84, 5
  s_add_u32 s84, s84, s79
  s_add_u32 s84, s84, s78
  s_lshl_b32 s84, s84, 10
  s_add_u32 s84, s84, 13631488
  s_cmp_ge_u32 s78, 40
  s_cselect_b32 s76, 0x10000000, s84
  s_cmp_eq_u32 s28, 1
  s_cselect_b32 s96, 16, 24
  v_subrev_u32_e32 v57, 12, v1
  v_min_u32_e32 v57, v57, v1
  v_and_b32_e32 v58, 1, v57
  v_lshlrev_b32_e32 v57, 1, v57
  v_sub_u32_e32 v57, v57, v58
  v_add_u32_e32 v58, 2, v57
  v_cmp_gt_u32 vcc, 12, v1
  s_nop 1
  v_cndmask_b32 v57, v57, v58, vcc
  s_cmp_ge_u32 s28, 2
  s_cselect_b64 vcc, -1, 0
  v_cndmask_b32 v56, v1, v57, vcc
  s_mul_i32 s85, s28, 24
  s_and_b32 s86, s28, 2
  s_sub_u32 s85, s85, s86
  v_add_u32_e32 v56, s85, v56
  v_add_u32_e32 v57, 22, v1
  v_mov_b32 v58, 0x8000
  v_cmp_gt_u32 vcc, 18, v1
  s_nop 1
  v_cndmask_b32 v57, v57, v58, vcc
  v_cmp_gt_u32 vcc, s96, v1
  s_nop 1
  v_cndmask_b32 v56, v57, v56, vcc
  s_mul_i32 s84, s34, 481280
  s_add_u32 s84, s84, 13631488
  v_mul_u32_u24 v57, 5120, v56
  v_add_u32_e64 v21, s84, v57
  s_mul_i32 s84, s33, 385024
  v_lshl_add_u32 v47, v56, 12, s84
  v_add_u32 v94, 4096, v20
  s_mul_i32 s97, s28, 10240
  v_and_b32_e32 v56, 15, v1
  v_lshrrev_b32_e32 v57, 4, v1
  v_lshlrev_b32_e64 v58, 7, v56
  v_lshl_add_u32 v58, v57, 4, v58
  v_add_u32_e32 v89, s80, v58
  v_lshrrev_b32_e32 v58, 1, v57
  v_lshlrev_b32_e32 v58, 4, v58
  v_and_b32_e32 v57, 1, v57
  v_lshl_add_u32 v58, v57, 2, v58
  v_lshrrev_b32_e32 v56, 2, v56
  v_add_u32_e32 v58, v58, v56
  v_lshlrev_b32_e32 v58, 7, v58
  v_and_b32_e32 v56, 3, v1
  v_lshl_add_u32 v58, v56, 3, v58
  v_add_u32_e32 v92, s80, v58
  s_cmp_eq_u32 s77, 1
  s_cselect_b64 s[78:79], 0, -1
  s_waitcnt vmcnt(7)
  v_dot2c_f32_bf16 v68, v96, v72
  v_dot2c_f32_bf16 v69, v96, v96
  v_dot2c_f32_bf16 v70, v97, v72
  v_dot2c_f32_bf16 v71, v97, v97
  v_dot2c_f32_bf16 v68, v98, v72
  v_dot2c_f32_bf16 v69, v98, v98
  v_dot2c_f32_bf16 v70, v99, v72
  v_dot2c_f32_bf16 v71, v99, v99
  v_dot2c_f32_bf16 v68, v100, v72
  v_dot2c_f32_bf16 v69, v100, v100
  v_dot2c_f32_bf16 v70, v101, v72
  v_dot2c_f32_bf16 v71, v101, v101
  v_dot2c_f32_bf16 v68, v102, v72
  v_dot2c_f32_bf16 v69, v102, v102
  v_dot2c_f32_bf16 v70, v103, v72
  v_dot2c_f32_bf16 v71, v103, v103
  v_dot2c_f32_bf16 v68, v104, v72
  v_dot2c_f32_bf16 v69, v104, v104
  v_dot2c_f32_bf16 v70, v105, v72
  v_dot2c_f32_bf16 v71, v105, v105
  v_dot2c_f32_bf16 v68, v106, v72
  v_dot2c_f32_bf16 v69, v106, v106
  v_dot2c_f32_bf16 v70, v107, v72
  v_dot2c_f32_bf16 v71, v107, v107
  s_nop 1
  v_add_f32_e32 v68, v68, v70
  v_add_f32_e32 v69, v69, v71
  s_nop 1
  v_add_f32_dpp v68, v68, v68 row_ror:8 row_mask:0xf bank_mask:0xf
  v_add_f32_dpp v69, v69, v69 row_ror:8 row_mask:0xf bank_mask:0xf
  v_mov_b32_e32 v70, v68
  v_mov_b32_e32 v71, v69
  s_nop 0
  v_permlane16_swap_b32 v68, v70
  v_permlane16_swap_b32 v69, v71
  v_add_f32_e32 v68, v68, v70
  v_add_f32_e32 v69, v69, v71
  v_mov_b32_e32 v70, v68
  v_mov_b32_e32 v71, v69
  s_nop 0
  v_permlane32_swap_b32 v68, v70
  v_permlane32_swap_b32 v69, v71
  v_add_f32_e32 v68, v68, v70
  v_add_f32_e32 v69, v69, v71
  ds_write_b64 v67, v[68:69]
  s_waitcnt lgkmcnt(0)
  s_barrier
  ds_read_b64 v[108:109], v66 offset:0
  ds_read_b64 v[110:111], v66 offset:64
  ds_read_b64 v[112:113], v66 offset:128
  ds_read_b64 v[114:115], v66 offset:192
  s_waitcnt lgkmcnt(0)
  v_pk_add_f32 v[68:69], v[108:109], v[110:111]
  v_pk_add_f32 v[70:71], v[112:113], v[114:115]
  v_pk_add_f32 v[68:69], v[68:69], v[70:71]
  v_mul_f32 v68, 0x3acccccd, v68
  v_mul_f32 v69, 0x3acccccd, v69
  v_fma_f32 v69, -v68, v68, v69
  v_max_f32_e32 v69, 0, v69
  v_cvt_pk_bf16_f32 v68, v68, v68
  v_lshlrev_b32_e64 v68, 16, v68
  v_cvt_pk_bf16_f32 v69, v69, v69
  v_lshlrev_b32_e64 v69, 16, v69
  v_add_f32 v69, 0x3727c5ac, v69
  v_cvt_pk_bf16_f32 v69, v69, v69
  v_lshlrev_b32_e32 v69, 16, v69
  v_sqrt_f32_e32 v69, v69
  s_nop 0
  v_cvt_pk_bf16_f32 v69, v69, v69
  v_lshlrev_b32_e32 v69, 16, v69
  v_rcp_f32_e32 v69, v69
  v_lshlrev_b32_e32 v70, 16, v96
  v_and_b32_e64 v71, s31, v96
  v_pk_add_f32 v[70:71], v[70:71], v[68:69] op_sel_hi:[1,0] neg_lo:[0,1] neg_hi:[0,1]
  v_cvt_pk_bf16_f32 v96, v70, v71
  v_lshlrev_b32_e32 v70, 16, v96
  v_and_b32_e32 v71, s31, v96
  v_pk_mul_f32 v[70:71], v[70:71], v[68:69] op_sel:[0,1] op_sel_hi:[1,1]
  v_cvt_pk_bf16_f32 v96, v70, v71
  v_lshlrev_b32_e32 v70, 16, v97
  v_and_b32_e32 v71, s31, v97
  v_pk_add_f32 v[70:71], v[70:71], v[68:69] op_sel_hi:[1,0] neg_lo:[0,1] neg_hi:[0,1]
  v_cvt_pk_bf16_f32 v97, v70, v71
  v_lshlrev_b32_e32 v70, 16, v97
  v_and_b32_e32 v71, s31, v97
  v_pk_mul_f32 v[70:71], v[70:71], v[68:69] op_sel:[0,1] op_sel_hi:[1,1]
  v_cvt_pk_bf16_f32 v97, v70, v71
  v_lshlrev_b32_e32 v70, 16, v98
  v_and_b32_e32 v71, s31, v98
  v_pk_add_f32 v[70:71], v[70:71], v[68:69] op_sel_hi:[1,0] neg_lo:[0,1] neg_hi:[0,1]
  v_cvt_pk_bf16_f32 v98, v70, v71
  v_lshlrev_b32_e32 v70, 16, v98
  v_and_b32_e32 v71, s31, v98
  v_pk_mul_f32 v[70:71], v[70:71], v[68:69] op_sel:[0,1] op_sel_hi:[1,1]
  v_cvt_pk_bf16_f32 v98, v70, v71
  v_lshlrev_b32_e32 v70, 16, v99
  v_and_b32_e32 v71, s31, v99
  v_pk_add_f32 v[70:71], v[70:71], v[68:69] op_sel_hi:[1,0] neg_lo:[0,1] neg_hi:[0,1]
  v_cvt_pk_bf16_f32 v99, v70, v71
  v_lshlrev_b32_e32 v70, 16, v99
  v_and_b32_e32 v71, s31, v99
  v_pk_mul_f32 v[70:71], v[70:71], v[68:69] op_sel:[0,1] op_sel_hi:[1,1]
  v_cvt_pk_bf16_f32 v99, v70, v71
  buffer_store_dwordx4 v[96:99], v64, s[24:27], s42 offen sc0 sc1
  v_lshlrev_b32_e32 v70, 16, v100
  v_and_b32_e32 v71, s31, v100
  v_pk_add_f32 v[70:71], v[70:71], v[68:69] op_sel_hi:[1,0] neg_lo:[0,1] neg_hi:[0,1]
  v_cvt_pk_bf16_f32 v100, v70, v71
  v_lshlrev_b32_e32 v70, 16, v100
  v_and_b32_e32 v71, s31, v100
  v_pk_mul_f32 v[70:71], v[70:71], v[68:69] op_sel:[0,1] op_sel_hi:[1,1]
  v_cvt_pk_bf16_f32 v100, v70, v71
  v_lshlrev_b32_e32 v70, 16, v101
  v_and_b32_e32 v71, s31, v101
  v_pk_add_f32 v[70:71], v[70:71], v[68:69] op_sel_hi:[1,0] neg_lo:[0,1] neg_hi:[0,1]
  v_cvt_pk_bf16_f32 v101, v70, v71
  v_lshlrev_b32_e32 v70, 16, v101
  v_and_b32_e32 v71, s31, v101
  v_pk_mul_f32 v[70:71], v[70:71], v[68:69] op_sel:[0,1] op_sel_hi:[1,1]
  v_cvt_pk_bf16_f32 v101, v70, v71
  v_lshlrev_b32_e32 v70, 16, v102
  v_and_b32_e32 v71, s31, v102
  v_pk_add_f32 v[70:71], v[70:71], v[68:69] op_sel_hi:[1,0] neg_lo:[0,1] neg_hi:[0,1]
  v_cvt_pk_bf16_f32 v102, v70, v71
  v_lshlrev_b32_e32 v70, 16, v102
  v_and_b32_e32 v71, s31, v102
  v_pk_mul_f32 v[70:71], v[70:71], v[68:69] op_sel:[0,1] op_sel_hi:[1,1]
  v_cvt_pk_bf16_f32 v102, v70, v71
  v_lshlrev_b32_e32 v70, 16, v103
  v_and_b32_e32 v71, s31, v103
  v_pk_add_f32 v[70:71], v[70:71], v[68:69] op_sel_hi:[1,0] neg_lo:[0,1] neg_hi:[0,1]
  v_cvt_pk_bf16_f32 v103, v70, v71
  v_lshlrev_b32_e32 v70, 16, v103
  v_and_b32_e32 v71, s31, v103
  v_pk_mul_f32 v[70:71], v[70:71], v[68:69] op_sel:[0,1] op_sel_hi:[1,1]
  v_cvt_pk_bf16_f32 v103, v70, v71
  buffer_store_dwordx4 v[100:103], v64, s[24:27], s41 offen sc0 sc1
  v_lshlrev_b32_e32 v70, 16, v104
  v_and_b32_e32 v71, s31, v104
  v_pk_add_f32 v[70:71], v[70:71], v[68:69] op_sel_hi:[1,0] neg_lo:[0,1] neg_hi:[0,1]
  v_cvt_pk_bf16_f32 v104, v70, v71
  v_lshlrev_b32_e32 v70, 16, v104
  v_and_b32_e32 v71, s31, v104
  v_pk_mul_f32 v[70:71], v[70:71], v[68:69] op_sel:[0,1] op_sel_hi:[1,1]
  v_cvt_pk_bf16_f32 v104, v70, v71
  v_lshlrev_b32_e32 v70, 16, v105
  v_and_b32_e32 v71, s31, v105
  v_pk_add_f32 v[70:71], v[70:71], v[68:69] op_sel_hi:[1,0] neg_lo:[0,1] neg_hi:[0,1]
  v_cvt_pk_bf16_f32 v105, v70, v71
  v_lshlrev_b32_e32 v70, 16, v105
  v_and_b32_e32 v71, s31, v105
  v_pk_mul_f32 v[70:71], v[70:71], v[68:69] op_sel:[0,1] op_sel_hi:[1,1]
  v_cvt_pk_bf16_f32 v105, v70, v71
  v_lshlrev_b32_e32 v70, 16, v106
  v_and_b32_e32 v71, s31, v106
  v_pk_add_f32 v[70:71], v[70:71], v[68:69] op_sel_hi:[1,0] neg_lo:[0,1] neg_hi:[0,1]
  v_cvt_pk_bf16_f32 v106, v70, v71
  v_lshlrev_b32_e32 v70, 16, v106
  v_and_b32_e32 v71, s31, v106
  v_pk_mul_f32 v[70:71], v[70:71], v[68:69] op_sel:[0,1] op_sel_hi:[1,1]
  v_cvt_pk_bf16_f32 v106, v70, v71
  v_lshlrev_b32_e32 v70, 16, v107
  v_and_b32_e32 v71, s31, v107
  v_pk_add_f32 v[70:71], v[70:71], v[68:69] op_sel_hi:[1,0] neg_lo:[0,1] neg_hi:[0,1]
  v_cvt_pk_bf16_f32 v107, v70, v71
  v_lshlrev_b32_e32 v70, 16, v107
  v_and_b32_e32 v71, s31, v107
  v_pk_mul_f32 v[70:71], v[70:71], v[68:69] op_sel:[0,1] op_sel_hi:[1,1]
  v_cvt_pk_bf16_f32 v107, v70, v71
  buffer_store_dwordx4 v[104:107], v65, s[24:27], s40 offen sc0 sc1
  v_lshlrev_b32_e64 v50, 3, v50
  s_mov_b32 s43, 12582912
  s_cmp_eq_u32 s28, 0
  s_cselect_b32 s43, s43, 0x10000000
  buffer_store_dwordx2 v[68:69], v50, s[24:27], s43 offen sc0 sc1
  s_add_u32 s32, s32, 0x9e3779b9
  s_cmp_eq_u32 s32, 0
  s_cselect_b32 s32, 0x9e3779b9, s32
  s_mul_i32 s90, s28, 6144
  s_lshl2_add_u32 s84, s29, s28
  s_mul_i32 s41, s84, 40960
  s_add_u32 s41, s41, 17825792
  s_add_u32 s42, s41, 40960
  s_lshl_b32 s40, s35, 5
  s_add_u32 s40, s40, s41
  v_add_u32 v48, 98304, v5
  v_add_u32 v49, 98304, v6
  v_add_u32 v50, 98304, v7
  v_add_u32 v51, 98304, v8
  v_add_u32 v17, 98304, v13
  v_add_u32 v18, 98304, v14
  s_mov_b32 m0, s80
  s_add_u32 s81, s72, 0
  buffer_load_dwordx4 v88, s[68:71], s81 offen offset:0  lds
  s_add_u32 s81, s72, 9216
  buffer_load_dwordx4 v88, s[68:71], s81 offen offset:1024  lds
  s_add_u32 s81, s72, 18432
  buffer_load_dwordx4 v88, s[68:71], s81 offen offset:2048  lds
  s_add_u32 s81, s72, 27648
  buffer_load_dwordx4 v88, s[68:71], s81 offen offset:3072  lds
  s_mov_b32 s43, s84
  s_waitcnt vmcnt(4)
  s_barrier
  s_lshl_b32 s84, s29, 11
  s_lshl_b32 s85, s30, 7
  s_add_u32 s84, s84, s85
  s_add_u32 s84, s84, 12910592
  s_cmp_eq_u32 s28, 0
  s_cselect_b32 s84, s84, 0x10000000
  v_mov_b32_e32 v54, 0
  v_mov_b32_e32 v55, s32
  buffer_store_dword v55, v54, s[24:27], s84 offen sc0 sc1
  s_mov_b32 s84, s43
  s_add_u32 m0, s90, 49152
  s_add_u32 s84, s88, s35
  buffer_load_dwordx4 v2, s[8:11], s84 offen offset:0  lds
  v_lshlrev_b32_e32 v60, 16, v60
  v_lshlrev_b32_e32 v61, 16, v61
  v_lshlrev_b32_e64 v62, 16, v62
  v_mul_f32 v62, 0x3fb8aa3b, v62
  v_exp_f32_e32 v62, v62
  s_nop 0
  v_cvt_pk_bf16_f32 v62, v62, v62
  buffer_load_dwordx4 v2, s[12:15], s84 offen offset:1024  lds
  v_lshlrev_b32_e32 v62, 16, v62
  v_mul_f32_e32 v63, v62, v60
  v_mul_f32_e64 v73, v62, v61
  v_mul_f32 v63, 0x3fb8aa3b, v63
  v_mul_f32 v73, 0x3e22f983, v73
  v_exp_f32_e64 v63, v63
  s_mul_i32 s84, s35, 1728
  s_add_u32 m0, s90, 51200
  s_add_u32 s84, s84, s93
  buffer_load_dwordx4 v3, s[16:19], s84 offen offset:0  lds
  v_fract_f32_e32 v73, v73
  v_cos_f32_e32 v74, v73
  v_sin_f32_e32 v75, v73
  v_mul_f32_e32 v22, v63, v74
  v_mul_f32_e32 v23, v63, v75
  v_add_f32_e64 v74, -1.0, v22
  buffer_load_dwordx4 v4, s[16:19], s84 offen offset:1024  lds
  v_mul_f32_e32 v75, v60, v60
  v_fmac_f32_e32 v75, v61, v61
  v_rcp_f32_e32 v75, v75
  v_mul_f32_e32 v24, v74, v60
  v_fmac_f32_e32 v24, v23, v61
  v_mul_f32_e32 v25, v23, v60
  buffer_load_dwordx4 v3, s[20:23], s84 offen offset:2048  lds
  v_fma_f32 v25, -v74, v61, v25
  v_add_f32_e32 v75, v75, v75
  v_mul_f32_e32 v24, v24, v75
  v_mul_f32_e32 v25, v25, v75
  v_mul_f32_e32 v74, v22, v22
  v_mul_f32_e64 v75, v22, v23
  buffer_load_dwordx4 v4, s[20:23], s84 offen offset:3072  lds
  s_addk_i32 s35, 128
  s_cmpk_eq_u32 s35, 1280
  s_cselect_b32 s35, 0, s35
  v_fma_f32 v74, -v23, v23, v74
  v_fmac_f32_e32 v75, v23, v22
  v_mul_f32_e32 v76, v74, v74
  v_mul_f32_e32 v77, v74, v75
  v_fma_f32 v76, -v75, v75, v76
  v_fmac_f32_e32 v77, v75, v74
  s_add_u32 m0, s90, 0
  s_add_u32 s84, s88, s35
  buffer_load_dwordx4 v2, s[8:11], s84 offen offset:0  lds
  v_mul_f32_e32 v74, v76, v76
  v_mul_f32_e64 v75, v76, v77
  v_fma_f32 v74, -v77, v77, v74
  v_fmac_f32_e32 v75, v77, v76
  v_mul_f32_e32 v30, v74, v74
  v_mul_f32_e64 v31, v74, v75
  buffer_load_dwordx4 v2, s[12:15], s84 offen offset:1024  lds
  v_fma_f32 v30, -v75, v75, v30
  v_fmac_f32_e32 v31, v75, v74
  v_mul_f32_e32 v74, v30, v30
  v_mul_f32_e64 v75, v30, v31
  v_fma_f32 v74, -v31, v31, v74
  v_fmac_f32_e64 v75, v31, v30
  s_mul_i32 s84, s35, 1728
  s_add_u32 m0, s90, 2048
  s_add_u32 s84, s84, s93
  buffer_load_dwordx4 v3, s[16:19], s84 offen offset:0  lds
  v_mul_f32_e32 v76, v74, v74
  v_mul_f32_e64 v77, v74, v75
  v_fma_f32 v76, -v75, v75, v76
  v_fmac_f32_e32 v77, v75, v74
  v_mul_f32_e32 v32, v76, v76
  v_mul_f32_e64 v33, v76, v77
  buffer_load_dwordx4 v4, s[16:19], s84 offen offset:1024  lds
  v_fma_f32 v32, -v77, v77, v32
  v_fmac_f32_e32 v33, v77, v76
  s_bitcmp1_b32 s28, 0
  s_cselect_b64 vcc, -1, 0
  v_cndmask_b32 v74, 1.0, v74, vcc
  v_cndmask_b32 v75, 0, v75, vcc
  buffer_load_dwordx4 v3, s[20:23], s84 offen offset:2048  lds
  s_bitcmp1_b32 s28, 1
  s_cselect_b64 vcc, -1, 0
  v_cndmask_b32 v76, 1.0, v76, vcc
  v_cndmask_b32 v77, 0, v77, vcc
  v_mul_f32_e32 v34, v74, v76
  v_mul_f32_e64 v35, v74, v77
  buffer_load_dwordx4 v4, s[20:23], s84 offen offset:3072  lds
  s_addk_i32 s35, 128
  s_cmpk_eq_u32 s35, 1280
  s_cselect_b32 s35, 0, s35
  v_fma_f32 v34, -v75, v77, v34
  v_fmac_f32_e32 v35, v75, v76
  v_mul_f32_e32 v36, v34, v30
  v_mul_f32_e32 v37, v34, v31
  v_fma_f32 v36, -v35, v31, v36
  v_fmac_f32_e64 v37, v35, v30
  s_add_u32 m0, s90, 24576
  s_add_u32 s84, s88, s35
  buffer_load_dwordx4 v2, s[8:11], s84 offen offset:0  lds
  v_mul_f32_e32 v74, v32, v32
  v_mul_f32_e64 v75, v32, v33
  v_fma_f32 v74, -v33, v33, v74
  v_fmac_f32_e32 v75, v33, v32
  v_mul_f32_e32 v76, v74, v74
  v_mul_f32_e64 v77, v74, v75
  buffer_load_dwordx4 v2, s[12:15], s84 offen offset:1024  lds
  v_fma_f32 v76, -v75, v75, v76
  v_fmac_f32_e32 v77, v75, v74
  v_mul_f32_e32 v26, v76, v76
  v_mul_f32_e64 v27, v76, v77
  v_fma_f32 v26, -v77, v77, v26
  v_fmac_f32_e32 v27, v77, v76
  s_waitcnt vmcnt(15)
  ds_read_b64_tr_b16 a[192:193], v92 offset:0
  ds_read_b64_tr_b16 a[194:195], v92 offset:1024
  ds_read_b64_tr_b16 a[196:197], v92 offset:32
  ds_read_b64_tr_b16 a[198:199], v92 offset:1056
  ds_read_b64_tr_b16 a[200:201], v92 offset:64
  ds_read_b64_tr_b16 a[202:203], v92 offset:1088
  ds_read_b64_tr_b16 a[204:205], v92 offset:96
  ds_read_b64_tr_b16 a[206:207], v92 offset:1120
  s_mov_b64 exec, s[78:79]
  ds_read_b128 a[192:195], v89 offset:0
  ds_read_b128 a[196:199], v89 offset:64
  ds_read_b128 a[200:203], v89 offset:2048
  ds_read_b128 a[204:207], v89 offset:2112
  s_mov_b64 exec, -1
  s_mul_i32 s84, s35, 1728
  s_add_u32 m0, s90, 26624
  s_add_u32 s84, s84, s93
  buffer_load_dwordx4 v3, s[16:19], s84 offen offset:0  lds
  buffer_load_dwordx4 v4, s[16:19], s84 offen offset:1024  lds
  s_waitcnt lgkmcnt(0)
  buffer_store_dwordx4 a[192:195], v20, s[24:27], s73 offen sc0 sc1
  buffer_store_dwordx4 a[196:199], v20, s[24:27], s74 offen sc0 sc1
  buffer_store_dwordx4 a[200:203], v20, s[24:27], s75 offen sc0 sc1
  buffer_store_dwordx4 a[204:207], v20, s[24:27], s76 offen sc0 sc1
  buffer_load_dwordx4 v3, s[20:23], s84 offen offset:2048  lds
  buffer_load_dwordx4 v4, s[20:23], s84 offen offset:3072  lds
  s_addk_i32 s35, 128
  s_cmpk_eq_u32 s35, 1280
  s_cselect_b32 s35, 0, s35
  s_add_u32 m0, s90, 98304
  s_add_u32 s84, s88, s35
  buffer_load_dwordx4 v2, s[8:11], s84 offen offset:0  lds
  buffer_load_dwordx4 v2, s[12:15], s84 offen offset:1024  lds
  s_lshl_b32 s43, s29, 11
  s_add_u32 s43, s43, 12910592
  s_cmp_eq_u32 s28, 0
  s_cselect_b32 s43, s43, 0x10000000
  s_cselect_b32 s44, s32, 0
  v_and_b32_e32 v54, 15, v1
  v_lshlrev_b32_e64 v54, 7, v54
  buffer_load_dword v55, v54, s[24:27], s43 offen sc0 sc1
  s_mul_i32 s84, s35, 1728
  s_add_u32 m0, s90, 100352
  s_add_u32 s84, s84, s93
  buffer_load_dwordx4 v3, s[16:19], s84 offen offset:0  lds
  buffer_load_dwordx4 v4, s[16:19], s84 offen offset:1024  lds
  buffer_load_dwordx4 v3, s[20:23], s84 offen offset:2048  lds
  buffer_load_dwordx4 v4, s[20:23], s84 offen offset:3072  lds
  s_addk_i32 s35, 128
  s_cmpk_eq_u32 s35, 1280
  s_cselect_b32 s35, 0, s35
  s_add_u32 m0, s90, 122880
  s_add_u32 s84, s88, s35
  buffer_load_dwordx4 v2, s[8:11], s84 offen offset:0  lds
  buffer_load_dwordx4 v2, s[12:15], s84 offen offset:1024  lds
  s_mul_i32 s84, s35, 1728
  s_add_u32 m0, s90, 124928
  s_add_u32 s84, s84, s93
  buffer_load_dwordx4 v3, s[16:19], s84 offen offset:0  lds
  buffer_load_dwordx4 v4, s[16:19], s84 offen offset:1024  lds
  buffer_load_dwordx4 v3, s[20:23], s84 offen offset:2048  lds
  buffer_load_dwordx4 v4, s[20:23], s84 offen offset:3072  lds
  s_addk_i32 s35, 128
  s_cmpk_eq_u32 s35, 1280
  s_cselect_b32 s35, 0, s35
  s_waitcnt vmcnt(10)
  v_cmp_ne_u32 vcc, s44, v55
  s_cbranch_vccnz L_p31
L_p3r1:
  s_barrier
  buffer_load_dwordx4 v[96:99], v20, s[24:27], s40 offen offset:0 sc0 sc1
  buffer_load_dwordx4 v[100:103], v20, s[24:27], s40 offen offset:1024 sc0 sc1
  buffer_load_dwordx4 v[104:107], v20, s[24:27], s40 offen offset:2048 sc0 sc1
  buffer_load_dwordx4 v[108:111], v20, s[24:27], s40 offen offset:3072 sc0 sc1
  s_add_u32 s40, s40, 4096
  s_cmp_eq_u32 s40, s42
  s_cselect_b32 s40, s41, s40
  buffer_load_dwordx4 v[112:115], v20, s[24:27], s40 offen offset:0 sc0 sc1
  buffer_load_dwordx4 v[116:119], v20, s[24:27], s40 offen offset:1024 sc0 sc1
  buffer_load_dwordx4 v[120:123], v20, s[24:27], s40 offen offset:2048 sc0 sc1
  buffer_load_dwordx4 v[124:127], v20, s[24:27], s40 offen offset:3072 sc0 sc1
  s_add_u32 s40, s40, 4096
  s_cmp_eq_u32 s40, s42
  s_cselect_b32 s40, s41, s40
.p2align 3
  s_barrier
  ds_read_b128 a[160:163], v9 offset:8192
  ds_read_b128 a[164:167], v9 offset:9216
  ds_read_b64_tr_b16 a[168:169], v15 offset:10240
  ds_read_b64_tr_b16 a[170:171], v15 offset:10752
  ds_read_b64_tr_b16 a[172:173], v15 offset:12288
  ds_read_b64_tr_b16 a[174:175], v15 offset:12800
  ds_read_b64_tr_b16 a[176:177], v16 offset:10240
  ds_read_b64_tr_b16 a[178:179], v16 offset:10752
  ds_read_b64_tr_b16 a[180:181], v16 offset:12288
  ds_read_b64_tr_b16 a[182:183], v16 offset:12800
  ds_read_b128 a[184:187], v10 offset:8192
  s_waitcnt vmcnt(7) lgkmcnt(7)
  v_mfma_f32_32x32x16_bf16 v[56:71], v[96:99], a[160:163], 0
  ds_read_b128 a[188:191], v10 offset:9216
  buffer_load_dwordx4 v[128:131], v20, s[24:27], s40 offen offset:0 sc0 sc1
  v_mfma_f32_32x32x16_bf16 v[72:87], v[96:99], a[164:167], 0
  ds_read_b64_tr_b16 a[160:161], v15 offset:16384
  ds_read_b64_tr_b16 a[162:163], v15 offset:16896
  buffer_load_dwordx4 v[132:135], v20, s[24:27], s40 offen offset:1024 sc0 sc1
  v_mfma_f32_32x32x16_bf16 v[192:207], a[168:171], v[96:99], 0
  ds_read_b64_tr_b16 a[164:165], v15 offset:18432
  ds_read_b64_tr_b16 a[166:167], v15 offset:18944
  s_waitcnt lgkmcnt(6)
  v_mfma_f32_32x32x16_bf16 v[208:223], a[172:175], v[96:99], 0
  ds_read_b64_tr_b16 a[168:169], v16 offset:16384
  ds_read_b64_tr_b16 a[170:171], v16 offset:16896
  buffer_load_dwordx4 v[136:139], v20, s[24:27], s40 offen offset:2048 sc0 sc1
  v_mfma_f32_32x32x16_bf16 v[224:239], a[176:179], v[96:99], 0
  ds_read_b64_tr_b16 a[172:173], v16 offset:18432
  ds_read_b64_tr_b16 a[174:175], v16 offset:18944
  buffer_load_dwordx4 v[140:143], v20, s[24:27], s40 offen offset:3072 sc0 sc1
  s_add_u32 s40, s40, 4096
  s_cmp_eq_u32 s40, s42
  s_cselect_b32 s40, s41, s40
  v_mfma_f32_32x32x16_bf16 v[240:255], a[180:183], v[96:99], 0
  s_waitcnt vmcnt(10)
  ds_read_b128 a[176:179], v11 offset:8192
  s_waitcnt lgkmcnt(7)
  v_mfma_f32_32x32x16_bf16 v[56:71], v[100:103], a[184:187], v[56:71]
  ds_read_b128 a[180:183], v11 offset:9216
  buffer_load_dwordx4 v[144:147], v20, s[24:27], s40 offen offset:0 sc0 sc1
  v_mfma_f32_32x32x16_bf16 v[72:87], v[100:103], a[188:191], v[72:87]
  ds_read_b64_tr_b16 a[184:185], v15 offset:22528
  ds_read_b64_tr_b16 a[186:187], v15 offset:23040
  v_mfma_f32_32x32x16_bf16 v[192:207], a[160:163], v[100:103], v[192:207]
  ds_read_b64_tr_b16 a[188:189], v15 offset:24576
  ds_read_b64_tr_b16 a[190:191], v15 offset:25088
  s_waitcnt lgkmcnt(6)
  buffer_load_dwordx4 v[148:151], v20, s[24:27], s40 offen offset:1024 sc0 sc1
  v_mfma_f32_32x32x16_bf16 v[208:223], a[164:167], v[100:103], v[208:223]
  ds_read_b64_tr_b16 a[160:161], v16 offset:22528
  ds_read_b64_tr_b16 a[162:163], v16 offset:23040
  buffer_load_dwordx4 v[152:155], v20, s[24:27], s40 offen offset:2048 sc0 sc1
  v_mfma_f32_32x32x16_bf16 v[224:239], a[168:171], v[100:103], v[224:239]
  ds_read_b64_tr_b16 a[164:165], v16 offset:24576
  ds_read_b64_tr_b16 a[166:167], v16 offset:25088
  v_mfma_f32_32x32x16_bf16 v[240:255], a[172:175], v[100:103], v[240:255]
  s_waitcnt vmcnt(12)
  ds_read_b128 a[168:171], v12 offset:8192
  s_waitcnt lgkmcnt(7)
  buffer_load_dwordx4 v[156:159], v20, s[24:27], s40 offen offset:3072 sc0 sc1
  s_add_u32 s40, s40, 4096
  s_cmp_eq_u32 s40, s42
  s_cselect_b32 s40, s41, s40
  v_mfma_f32_32x32x16_bf16 v[56:71], v[104:107], a[176:179], v[56:71]
  ds_read_b128 a[172:175], v12 offset:9216
  v_mfma_f32_32x32x16_bf16 v[72:87], v[104:107], a[180:183], v[72:87]
  ds_read_b64_tr_b16 a[176:177], v15 offset:28672
  ds_read_b64_tr_b16 a[178:179], v15 offset:29184
  buffer_load_dwordx4 v[160:163], v20, s[24:27], s40 offen offset:0 sc0 sc1
  v_mfma_f32_32x32x16_bf16 v[192:207], a[184:187], v[104:107], v[192:207]
  ds_read_b64_tr_b16 a[180:181], v15 offset:30720
  ds_read_b64_tr_b16 a[182:183], v15 offset:31232
  s_waitcnt lgkmcnt(6)
  buffer_load_dwordx4 v[164:167], v20, s[24:27], s40 offen offset:1024 sc0 sc1
  v_mfma_f32_32x32x16_bf16 v[208:223], a[188:191], v[104:107], v[208:223]
  ds_read_b64_tr_b16 a[184:185], v16 offset:28672
  ds_read_b64_tr_b16 a[186:187], v16 offset:29184
  v_mfma_f32_32x32x16_bf16 v[224:239], a[160:163], v[104:107], v[224:239]
  ds_read_b64_tr_b16 a[188:189], v16 offset:30720
  ds_read_b64_tr_b16 a[190:191], v16 offset:31232
  buffer_load_dwordx4 v[168:171], v20, s[24:27], s40 offen offset:2048 sc0 sc1
  s_lshr_b32 s85, s2, 2
  s_mul_i32 s85, s85, 112
  s_lshl2_add_u32 s85, s2, s85
  s_add_u32 s85, s85, 13008896
  s_cmp_eq_u32 s28, 0
  s_cselect_b32 s85, s85, 0x10000000
  v_mov_b32_e32 v54, 0
  v_mov_b32_e32 v55, s32
  v_mfma_f32_32x32x16_bf16 v[240:255], a[164:167], v[104:107], v[240:255]
  s_waitcnt vmcnt(15) lgkmcnt(6)
  v_mfma_f32_32x32x16_bf16 v[56:71], v[108:111], a[168:171], v[56:71]
  s_waitcnt lgkmcnt(0)
  s_barrier
  ds_read_b128 a[160:163], v5 offset:0
  ds_read_b128 a[164:167], v5 offset:1024
  buffer_store_dword v55, v54, s[24:27], s85 offen sc0 sc1
  v_mfma_f32_32x32x16_bf16 v[72:87], v[108:111], a[172:175], v[72:87]
  s_add_u32 m0, s90, 49152
  s_add_u32 s84, s88, s35
  ds_read_b64_tr_b16 a[168:169], v13 offset:2048
  ds_read_b64_tr_b16 a[170:171], v13 offset:2560
  buffer_load_dwordx4 v2, s[8:11], s84 offen offset:0  lds
  v_mfma_f32_32x32x16_bf16 v[192:207], a[176:179], v[108:111], v[192:207]
  ds_read_b64_tr_b16 a[172:173], v13 offset:4096
  ds_read_b64_tr_b16 a[174:175], v13 offset:4608
  buffer_load_dwordx4 v[172:175], v20, s[24:27], s40 offen offset:3072 sc0 sc1
  s_add_u32 s40, s40, 4096
  s_cmp_eq_u32 s40, s42
  s_cselect_b32 s40, s41, s40
  v_mfma_f32_32x32x16_bf16 v[208:223], a[180:183], v[108:111], v[208:223]
  ds_read_b64_tr_b16 a[176:177], v14 offset:2048
  ds_read_b64_tr_b16 a[178:179], v14 offset:2560
  v_mfma_f32_32x32x16_bf16 v[224:239], a[184:187], v[108:111], v[224:239]
  ds_read_b64_tr_b16 a[180:181], v14 offset:4096
  ds_read_b64_tr_b16 a[182:183], v14 offset:4608
  buffer_load_dwordx4 v2, s[12:15], s84 offen offset:1024  lds
  v_mfma_f32_32x32x16_bf16 v[240:255], a[188:191], v[108:111], v[240:255]
  s_waitcnt vmcnt(18)
  ds_read_b128 a[184:187], v6 offset:0
  s_waitcnt lgkmcnt(7)
  v_mfma_f32_32x32x16_bf16 v[56:71], v[112:115], a[160:163], v[56:71]
  ds_read_b128 a[188:191], v6 offset:1024
  buffer_load_dwordx4 v[176:179], v20, s[24:27], s40 offen offset:0 sc0 sc1
  v_mfma_f32_32x32x16_bf16 v[72:87], v[112:115], a[164:167], v[72:87]
  ds_read_b64_tr_b16 a[160:161], v13 offset:8192
  ds_read_b64_tr_b16 a[162:163], v13 offset:8704
  v_mfma_f32_32x32x16_bf16 v[192:207], a[168:171], v[112:115], v[192:207]
  s_mul_i32 s84, s35, 1728
  s_add_u32 m0, s90, 51200
  s_add_u32 s84, s84, s93
  ds_read_b64_tr_b16 a[164:165], v13 offset:10240
  ds_read_b64_tr_b16 a[166:167], v13 offset:10752
  s_waitcnt lgkmcnt(6)
  buffer_load_dwordx4 v3, s[16:19], s84 offen offset:0  lds
  v_mfma_f32_32x32x16_bf16 v[208:223], a[172:175], v[112:115], v[208:223]
  ds_read_b64_tr_b16 a[168:169], v14 offset:8192
  ds_read_b64_tr_b16 a[170:171], v14 offset:8704
  v_mfma_f32_32x32x16_bf16 v[224:239], a[176:179], v[112:115], v[224:239]
  ds_read_b64_tr_b16 a[172:173], v14 offset:10240
  ds_read_b64_tr_b16 a[174:175], v14 offset:10752
  buffer_load_dwordx4 v[180:183], v20, s[24:27], s40 offen offset:1024 sc0 sc1
  v_mfma_f32_32x32x16_bf16 v[240:255], a[180:183], v[112:115], v[240:255]
  s_waitcnt vmcnt(20)
  ds_read_b128 a[176:179], v7 offset:0
  s_waitcnt lgkmcnt(7)
  v_mfma_f32_32x32x16_bf16 v[56:71], v[116:119], a[184:187], v[56:71]
  ds_read_b128 a[180:183], v7 offset:1024
  buffer_load_dwordx4 v4, s[16:19], s84 offen offset:1024  lds
  v_mfma_f32_32x32x16_bf16 v[72:87], v[116:119], a[188:191], v[72:87]
  ds_read_b64_tr_b16 a[184:185], v13 offset:14336
  ds_read_b64_tr_b16 a[186:187], v13 offset:14848
  v_mfma_f32_32x32x16_bf16 v[192:207], a[160:163], v[116:119], v[192:207]
  ds_read_b64_tr_b16 a[188:189], v13 offset:16384
  ds_read_b64_tr_b16 a[190:191], v13 offset:16896
  s_waitcnt lgkmcnt(6)
  buffer_load_dwordx4 v[184:187], v20, s[24:27], s40 offen offset:2048 sc0 sc1
  v_mfma_f32_32x32x16_bf16 v[208:223], a[164:167], v[116:119], v[208:223]
  ds_read_b64_tr_b16 a[160:161], v14 offset:14336
  ds_read_b64_tr_b16 a[162:163], v14 offset:14848
  v_mfma_f32_32x32x16_bf16 v[224:239], a[168:171], v[116:119], v[224:239]
  ds_read_b64_tr_b16 a[164:165], v14 offset:16384
  ds_read_b64_tr_b16 a[166:167], v14 offset:16896
  buffer_load_dwordx4 v3, s[20:23], s84 offen offset:2048  lds
  v_mfma_f32_32x32x16_bf16 v[240:255], a[172:175], v[116:119], v[240:255]
  s_waitcnt vmcnt(22)
  ds_read_b128 a[168:171], v8 offset:0
  s_waitcnt lgkmcnt(7)
  v_mfma_f32_32x32x16_bf16 v[56:71], v[120:123], a[176:179], v[56:71]
  ds_read_b128 a[172:175], v8 offset:1024
  buffer_load_dwordx4 v[188:191], v20, s[24:27], s40 offen offset:3072 sc0 sc1
  s_add_u32 s40, s40, 4096
  s_cmp_eq_u32 s40, s42
  s_cselect_b32 s40, s41, s40
  v_mfma_f32_32x32x16_bf16 v[72:87], v[120:123], a[180:183], v[72:87]
  ds_read_b64_tr_b16 a[176:177], v13 offset:20480
  ds_read_b64_tr_b16 a[178:179], v13 offset:20992
  v_mfma_f32_32x32x16_bf16 v[192:207], a[184:187], v[120:123], v[192:207]
  ds_read_b64_tr_b16 a[180:181], v13 offset:22528
  ds_read_b64_tr_b16 a[182:183], v13 offset:23040
  s_waitcnt lgkmcnt(6)
  buffer_load_dwordx4 v4, s[20:23], s84 offen offset:3072  lds
  s_addk_i32 s35, 128
  s_cmpk_eq_u32 s35, 1280
  s_cselect_b32 s35, 0, s35
  v_mfma_f32_32x32x16_bf16 v[208:223], a[188:191], v[120:123], v[208:223]
  ds_read_b64_tr_b16 a[184:185], v14 offset:20480
  ds_read_b64_tr_b16 a[186:187], v14 offset:20992
  v_mfma_f32_32x32x16_bf16 v[224:239], a[160:163], v[120:123], v[224:239]
  ds_read_b64_tr_b16 a[188:189], v14 offset:22528
  ds_read_b64_tr_b16 a[190:191], v14 offset:23040
  buffer_load_dwordx4 a[32:35], v20, s[24:27], s40 offen offset:0 sc0 sc1
  v_mfma_f32_32x32x16_bf16 v[240:255], a[164:167], v[120:123], v[240:255]
  s_waitcnt vmcnt(24) lgkmcnt(6)
  v_mfma_f32_32x32x16_bf16 v[56:71], v[124:127], a[168:171], v[56:71]
  s_waitcnt lgkmcnt(0)
  s_barrier
  ds_read_b128 a[160:163], v5 offset:24576
  ds_read_b128 a[164:167], v5 offset:25600
  v_mfma_f32_32x32x16_bf16 v[72:87], v[124:127], a[172:175], v[72:87]
  s_add_u32 m0, s90, 0
  s_add_u32 s84, s88, s35
  ds_read_b64_tr_b16 a[168:169], v13 offset:26624
  ds_read_b64_tr_b16 a[170:171], v13 offset:27136
  buffer_load_dwordx4 v2, s[8:11], s84 offen offset:0  lds
  v_mfma_f32_32x32x16_bf16 v[192:207], a[176:179], v[124:127], v[192:207]
  ds_read_b64_tr_b16 a[172:173], v13 offset:28672
  ds_read_b64_tr_b16 a[174:175], v13 offset:29184
  buffer_load_dwordx4 a[36:39], v20, s[24:27], s40 offen offset:1024 sc0 sc1
  v_mfma_f32_32x32x16_bf16 v[208:223], a[180:183], v[124:127], v[208:223]
  ds_read_b64_tr_b16 a[176:177], v14 offset:26624
  ds_read_b64_tr_b16 a[178:179], v14 offset:27136
  v_mfma_f32_32x32x16_bf16 v[224:239], a[184:187], v[124:127], v[224:239]
  ds_read_b64_tr_b16 a[180:181], v14 offset:28672
  ds_read_b64_tr_b16 a[182:183], v14 offset:29184
  buffer_load_dwordx4 v2, s[12:15], s84 offen offset:1024  lds
  v_mfma_f32_32x32x16_bf16 v[240:255], a[188:191], v[124:127], v[240:255]
  s_waitcnt vmcnt(26)
  ds_read_b128 a[184:187], v6 offset:24576
  s_waitcnt lgkmcnt(7)
  v_mfma_f32_32x32x16_bf16 v[56:71], v[128:131], a[160:163], v[56:71]
  ds_read_b128 a[188:191], v6 offset:25600
  buffer_load_dwordx4 a[40:43], v20, s[24:27], s40 offen offset:2048 sc0 sc1
  v_mfma_f32_32x32x16_bf16 v[72:87], v[128:131], a[164:167], v[72:87]
  ds_read_b64_tr_b16 a[160:161], v13 offset:32768
  ds_read_b64_tr_b16 a[162:163], v13 offset:33280
  v_mfma_f32_32x32x16_bf16 v[192:207], a[168:171], v[128:131], v[192:207]
  s_mul_i32 s84, s35, 1728
  s_add_u32 m0, s90, 2048
  s_add_u32 s84, s84, s93
  ds_read_b64_tr_b16 a[164:165], v13 offset:34816
  ds_read_b64_tr_b16 a[166:167], v13 offset:35328
  s_waitcnt lgkmcnt(6)
  buffer_load_dwordx4 v3, s[16:19], s84 offen offset:0  lds
  v_mfma_f32_32x32x16_bf16 v[208:223], a[172:175], v[128:131], v[208:223]
  ds_read_b64_tr_b16 a[168:169], v14 offset:32768
  ds_read_b64_tr_b16 a[170:171], v14 offset:33280
  v_mfma_f32_32x32x16_bf16 v[224:239], a[176:179], v[128:131], v[224:239]
  ds_read_b64_tr_b16 a[172:173], v14 offset:34816
  ds_read_b64_tr_b16 a[174:175], v14 offset:35328
  buffer_load_dwordx4 a[44:47], v20, s[24:27], s40 offen offset:3072 sc0 sc1
  s_add_u32 s40, s40, 4096
  s_cmp_eq_u32 s40, s42
  s_cselect_b32 s40, s41, s40
  v_mfma_f32_32x32x16_bf16 v[240:255], a[180:183], v[128:131], v[240:255]
  s_waitcnt vmcnt(28)
  ds_read_b128 a[176:179], v7 offset:24576
  s_waitcnt lgkmcnt(7)
  v_mfma_f32_32x32x16_bf16 v[56:71], v[132:135], a[184:187], v[56:71]
  ds_read_b128 a[180:183], v7 offset:25600
  buffer_load_dwordx4 v4, s[16:19], s84 offen offset:1024  lds
  v_mfma_f32_32x32x16_bf16 v[72:87], v[132:135], a[188:191], v[72:87]
  ds_read_b64_tr_b16 a[184:185], v13 offset:38912
  ds_read_b64_tr_b16 a[186:187], v13 offset:39424
  v_mfma_f32_32x32x16_bf16 v[192:207], a[160:163], v[132:135], v[192:207]
  ds_read_b64_tr_b16 a[188:189], v13 offset:40960
  ds_read_b64_tr_b16 a[190:191], v13 offset:41472
  s_waitcnt lgkmcnt(6)
  buffer_load_dwordx4 a[48:51], v20, s[24:27], s40 offen offset:0 sc0 sc1
  v_mfma_f32_32x32x16_bf16 v[208:223], a[164:167], v[132:135], v[208:223]
  ds_read_b64_tr_b16 a[160:161], v14 offset:38912
  ds_read_b64_tr_b16 a[162:163], v14 offset:39424
  v_mfma_f32_32x32x16_bf16 v[224:239], a[168:171], v[132:135], v[224:239]
  ds_read_b64_tr_b16 a[164:165], v14 offset:40960
  ds_read_b64_tr_b16 a[166:167], v14 offset:41472
  buffer_load_dwordx4 v3, s[20:23], s84 offen offset:2048  lds
  v_mfma_f32_32x32x16_bf16 v[240:255], a[172:175], v[132:135], v[240:255]
  s_waitcnt vmcnt(30)
  ds_read_b128 a[168:171], v8 offset:24576
  s_waitcnt lgkmcnt(7)
  v_mfma_f32_32x32x16_bf16 v[56:71], v[136:139], a[176:179], v[56:71]
  ds_read_b128 a[172:175], v8 offset:25600
  buffer_load_dwordx4 a[52:55], v20, s[24:27], s40 offen offset:1024 sc0 sc1
  v_mfma_f32_32x32x16_bf16 v[72:87], v[136:139], a[180:183], v[72:87]
  ds_read_b64_tr_b16 a[176:177], v13 offset:45056
  ds_read_b64_tr_b16 a[178:179], v13 offset:45568
  v_mfma_f32_32x32x16_bf16 v[192:207], a[184:187], v[136:139], v[192:207]
  ds_read_b64_tr_b16 a[180:181], v13 offset:47104
  ds_read_b64_tr_b16 a[182:183], v13 offset:47616
  s_waitcnt lgkmcnt(6)
  buffer_load_dwordx4 v4, s[20:23], s84 offen offset:3072  lds
  s_addk_i32 s35, 128
  s_cmpk_eq_u32 s35, 1280
  s_cselect_b32 s35, 0, s35
  v_mfma_f32_32x32x16_bf16 v[208:223], a[188:191], v[136:139], v[208:223]
  ds_read_b64_tr_b16 a[184:185], v14 offset:45056
  ds_read_b64_tr_b16 a[186:187], v14 offset:45568
  v_mfma_f32_32x32x16_bf16 v[224:239], a[160:163], v[136:139], v[224:239]
  ds_read_b64_tr_b16 a[188:189], v14 offset:47104
  ds_read_b64_tr_b16 a[190:191], v14 offset:47616
  buffer_load_dwordx4 a[56:59], v20, s[24:27], s40 offen offset:2048 sc0 sc1
  v_mfma_f32_32x32x16_bf16 v[240:255], a[164:167], v[136:139], v[240:255]
  s_waitcnt vmcnt(32) lgkmcnt(6)
  v_mfma_f32_32x32x16_bf16 v[56:71], v[140:143], a[168:171], v[56:71]
  s_waitcnt lgkmcnt(0)
  s_barrier
  ds_read_b128 a[160:163], v48 offset:0
  ds_read_b128 a[164:167], v48 offset:1024
  v_mfma_f32_32x32x16_bf16 v[72:87], v[140:143], a[172:175], v[72:87]
  s_add_u32 m0, s90, 24576
  s_add_u32 s84, s88, s35
  ds_read_b64_tr_b16 a[168:169], v17 offset:2048
  ds_read_b64_tr_b16 a[170:171], v17 offset:2560
  buffer_load_dwordx4 v2, s[8:11], s84 offen offset:0  lds
  v_mfma_f32_32x32x16_bf16 v[192:207], a[176:179], v[140:143], v[192:207]
  ds_read_b64_tr_b16 a[172:173], v17 offset:4096
  ds_read_b64_tr_b16 a[174:175], v17 offset:4608
  buffer_load_dwordx4 a[60:63], v20, s[24:27], s40 offen offset:3072 sc0 sc1
  s_add_u32 s40, s40, 4096
  s_cmp_eq_u32 s40, s42
  s_cselect_b32 s40, s41, s40
  v_mfma_f32_32x32x16_bf16 v[208:223], a[180:183], v[140:143], v[208:223]
  ds_read_b64_tr_b16 a[176:177], v18 offset:2048
  ds_read_b64_tr_b16 a[178:179], v18 offset:2560
  v_mfma_f32_32x32x16_bf16 v[224:239], a[184:187], v[140:143], v[224:239]
  ds_read_b64_tr_b16 a[180:181], v18 offset:4096
  ds_read_b64_tr_b16 a[182:183], v18 offset:4608
  buffer_load_dwordx4 v2, s[12:15], s84 offen offset:1024  lds
  v_mfma_f32_32x32x16_bf16 v[240:255], a[188:191], v[140:143], v[240:255]
  s_waitcnt vmcnt(34)
  ds_read_b128 a[184:187], v49 offset:0
  s_waitcnt lgkmcnt(7)
  v_mfma_f32_32x32x16_bf16 v[56:71], v[144:147], a[160:163], v[56:71]
  ds_read_b128 a[188:191], v49 offset:1024
  buffer_load_dwordx4 a[64:67], v20, s[24:27], s40 offen offset:0 sc0 sc1
  v_mfma_f32_32x32x16_bf16 v[72:87], v[144:147], a[164:167], v[72:87]
  ds_read_b64_tr_b16 a[160:161], v17 offset:8192
  ds_read_b64_tr_b16 a[162:163], v17 offset:8704
  v_mfma_f32_32x32x16_bf16 v[192:207], a[168:171], v[144:147], v[192:207]
  s_mul_i32 s84, s35, 1728
  s_add_u32 m0, s90, 26624
  s_add_u32 s84, s84, s93
  ds_read_b64_tr_b16 a[164:165], v17 offset:10240
  ds_read_b64_tr_b16 a[166:167], v17 offset:10752
  s_waitcnt lgkmcnt(6)
  buffer_load_dwordx4 v3, s[16:19], s84 offen offset:0  lds
  v_mfma_f32_32x32x16_bf16 v[208:223], a[172:175], v[144:147], v[208:223]
  ds_read_b64_tr_b16 a[168:169], v18 offset:8192
  ds_read_b64_tr_b16 a[170:171], v18 offset:8704
  v_mfma_f32_32x32x16_bf16 v[224:239], a[176:179], v[144:147], v[224:239]
  ds_read_b64_tr_b16 a[172:173], v18 offset:10240
  ds_read_b64_tr_b16 a[174:175], v18 offset:10752
  buffer_load_dwordx4 a[68:71], v20, s[24:27], s40 offen offset:1024 sc0 sc1
  v_mfma_f32_32x32x16_bf16 v[240:255], a[180:183], v[144:147], v[240:255]
  s_waitcnt vmcnt(36)
  ds_read_b128 a[176:179], v50 offset:0
  s_waitcnt lgkmcnt(7)
  v_mfma_f32_32x32x16_bf16 v[56:71], v[148:151], a[184:187], v[56:71]
  ds_read_b128 a[180:183], v50 offset:1024
  buffer_load_dwordx4 v4, s[16:19], s84 offen offset:1024  lds
  v_mfma_f32_32x32x16_bf16 v[72:87], v[148:151], a[188:191], v[72:87]
  ds_read_b64_tr_b16 a[184:185], v17 offset:14336
  ds_read_b64_tr_b16 a[186:187], v17 offset:14848
  v_mfma_f32_32x32x16_bf16 v[192:207], a[160:163], v[148:151], v[192:207]
  ds_read_b64_tr_b16 a[188:189], v17 offset:16384
  ds_read_b64_tr_b16 a[190:191], v17 offset:16896
  s_waitcnt lgkmcnt(6)
  buffer_load_dwordx4 a[72:75], v20, s[24:27], s40 offen offset:2048 sc0 sc1
  v_mfma_f32_32x32x16_bf16 v[208:223], a[164:167], v[148:151], v[208:223]
  ds_read_b64_tr_b16 a[160:161], v18 offset:14336
  ds_read_b64_tr_b16 a[162:163], v18 offset:14848
  v_mfma_f32_32x32x16_bf16 v[224:239], a[168:171], v[148:151], v[224:239]
  ds_read_b64_tr_b16 a[164:165], v18 offset:16384
  ds_read_b64_tr_b16 a[166:167], v18 offset:16896
  buffer_load_dwordx4 v3, s[20:23], s84 offen offset:2048  lds
  v_mfma_f32_32x32x16_bf16 v[240:255], a[172:175], v[148:151], v[240:255]
  s_waitcnt vmcnt(38)
  ds_read_b128 a[168:171], v51 offset:0
  s_waitcnt lgkmcnt(7)
  v_mfma_f32_32x32x16_bf16 v[56:71], v[152:155], a[176:179], v[56:71]
  ds_read_b128 a[172:175], v51 offset:1024
  buffer_load_dwordx4 a[76:79], v20, s[24:27], s40 offen offset:3072 sc0 sc1
  s_add_u32 s40, s40, 4096
  s_cmp_eq_u32 s40, s42
  s_cselect_b32 s40, s41, s40
  v_mfma_f32_32x32x16_bf16 v[72:87], v[152:155], a[180:183], v[72:87]
  ds_read_b64_tr_b16 a[176:177], v17 offset:20480
  ds_read_b64_tr_b16 a[178:179], v17 offset:20992
  v_mfma_f32_32x32x16_bf16 v[192:207], a[184:187], v[152:155], v[192:207]
  ds_read_b64_tr_b16 a[180:181], v17 offset:22528
  ds_read_b64_tr_b16 a[182:183], v17 offset:23040
  s_waitcnt lgkmcnt(6)
  buffer_load_dwordx4 v4, s[20:23], s84 offen offset:3072  lds
  s_addk_i32 s35, 128
  s_cmpk_eq_u32 s35, 1280
  s_cselect_b32 s35, 0, s35
  v_mfma_f32_32x32x16_bf16 v[208:223], a[188:191], v[152:155], v[208:223]
  ds_read_b64_tr_b16 a[184:185], v18 offset:20480
  ds_read_b64_tr_b16 a[186:187], v18 offset:20992
  v_mfma_f32_32x32x16_bf16 v[224:239], a[160:163], v[152:155], v[224:239]
  ds_read_b64_tr_b16 a[188:189], v18 offset:22528
  ds_read_b64_tr_b16 a[190:191], v18 offset:23040
  buffer_load_dwordx4 a[80:83], v20, s[24:27], s40 offen offset:0 sc0 sc1
  v_mfma_f32_32x32x16_bf16 v[240:255], a[164:167], v[152:155], v[240:255]
  s_waitcnt vmcnt(40) lgkmcnt(6)
  v_mfma_f32_32x32x16_bf16 v[56:71], v[156:159], a[168:171], v[56:71]
  s_waitcnt lgkmcnt(0)
  s_barrier
  ds_read_b128 a[160:163], v48 offset:24576
  ds_read_b128 a[164:167], v48 offset:25600
  v_mfma_f32_32x32x16_bf16 v[72:87], v[156:159], a[172:175], v[72:87]
  ds_read_b64_tr_b16 a[168:169], v17 offset:26624
  ds_read_b64_tr_b16 a[170:171], v17 offset:27136
  buffer_load_dwordx4 a[84:87], v20, s[24:27], s40 offen offset:1024 sc0 sc1
  v_mfma_f32_32x32x16_bf16 v[192:207], a[176:179], v[156:159], v[192:207]
  ds_read_b64_tr_b16 a[172:173], v17 offset:28672
  ds_read_b64_tr_b16 a[174:175], v17 offset:29184
  s_mov_b64 exec, 1023
  buffer_load_dword v91, v90, s[16:19], s94 offen
  buffer_load_dword v91, v90, s[20:23], s94 offen offset:2048
  s_mov_b64 exec, -1
  v_mfma_f32_32x32x16_bf16 v[208:223], a[180:183], v[156:159], v[208:223]
  ds_read_b64_tr_b16 a[176:177], v18 offset:26624
  ds_read_b64_tr_b16 a[178:179], v18 offset:27136
  v_mfma_f32_32x32x16_bf16 v[224:239], a[184:187], v[156:159], v[224:239]
  ds_read_b64_tr_b16 a[180:181], v18 offset:28672
  ds_read_b64_tr_b16 a[182:183], v18 offset:29184
  v_mfma_f32_32x32x16_bf16 v[240:255], a[188:191], v[156:159], v[240:255]
  s_waitcnt vmcnt(42)
  ds_read_b128 a[184:187], v49 offset:24576
  s_waitcnt lgkmcnt(7)
  v_mfma_f32_32x32x16_bf16 v[56:71], v[160:163], a[160:163], v[56:71]
  ds_read_b128 a[188:191], v49 offset:25600
  v_mfma_f32_32x32x16_bf16 v[72:87], v[160:163], a[164:167], v[72:87]
  ds_read_b64_tr_b16 a[160:161], v17 offset:32768
  ds_read_b64_tr_b16 a[162:163], v17 offset:33280
  v_mfma_f32_32x32x16_bf16 v[192:207], a[168:171], v[160:163], v[192:207]
  ds_read_b64_tr_b16 a[164:165], v17 offset:34816
  ds_read_b64_tr_b16 a[166:167], v17 offset:35328
  s_waitcnt lgkmcnt(6)
  buffer_load_dwordx4 a[88:91], v20, s[24:27], s40 offen offset:2048 sc0 sc1
  v_mfma_f32_32x32x16_bf16 v[208:223], a[172:175], v[160:163], v[208:223]
  ds_read_b64_tr_b16 a[168:169], v18 offset:32768
  ds_read_b64_tr_b16 a[170:171], v18 offset:33280
  v_mfma_f32_32x32x16_bf16 v[224:239], a[176:179], v[160:163], v[224:239]
  ds_read_b64_tr_b16 a[172:173], v18 offset:34816
  ds_read_b64_tr_b16 a[174:175], v18 offset:35328
  v_mfma_f32_32x32x16_bf16 v[240:255], a[180:183], v[160:163], v[240:255]
  s_waitcnt vmcnt(42)
  ds_read_b128 a[176:179], v50 offset:24576
  s_waitcnt lgkmcnt(7)
  v_mfma_f32_32x32x16_bf16 v[56:71], v[164:167], a[184:187], v[56:71]
  ds_read_b128 a[180:183], v50 offset:25600
  v_mfma_f32_32x32x16_bf16 v[72:87], v[164:167], a[188:191], v[72:87]
  ds_read_b64_tr_b16 a[184:185], v17 offset:38912
  ds_read_b64_tr_b16 a[186:187], v17 offset:39424
  v_mfma_f32_32x32x16_bf16 v[192:207], a[160:163], v[164:167], v[192:207]
  ds_read_b64_tr_b16 a[188:189], v17 offset:40960
  ds_read_b64_tr_b16 a[190:191], v17 offset:41472
  s_waitcnt lgkmcnt(6)
  v_mfma_f32_32x32x16_bf16 v[208:223], a[164:167], v[164:167], v[208:223]
  ds_read_b64_tr_b16 a[160:161], v18 offset:38912
  ds_read_b64_tr_b16 a[162:163], v18 offset:39424
  v_mfma_f32_32x32x16_bf16 v[224:239], a[168:171], v[164:167], v[224:239]
  ds_read_b64_tr_b16 a[164:165], v18 offset:40960
  ds_read_b64_tr_b16 a[166:167], v18 offset:41472
  buffer_load_dwordx4 a[92:95], v20, s[24:27], s40 offen offset:3072 sc0 sc1
  v_mfma_f32_32x32x16_bf16 v[240:255], a[172:175], v[164:167], v[240:255]
  s_waitcnt vmcnt(42)
  ds_read_b128 a[168:171], v51 offset:24576
  s_waitcnt lgkmcnt(7)
  v_mfma_f32_32x32x16_bf16 v[56:71], v[168:171], a[176:179], v[56:71]
  ds_read_b128 a[172:175], v51 offset:25600
  v_mfma_f32_32x32x16_bf16 v[72:87], v[168:171], a[180:183], v[72:87]
  ds_read_b64_tr_b16 a[176:177], v17 offset:45056
  ds_read_b64_tr_b16 a[178:179], v17 offset:45568
  v_mfma_f32_32x32x16_bf16 v[192:207], a[184:187], v[168:171], v[192:207]
  ds_read_b64_tr_b16 a[180:181], v17 offset:47104
  ds_read_b64_tr_b16 a[182:183], v17 offset:47616
  s_waitcnt lgkmcnt(6)
  s_mov_b32 s87, 13008896
  s_cmp_eq_u32 s28, 0
  s_cselect_b32 s87, s87, 0x10000000
  s_cselect_b32 s77, s32, 0
  v_lshlrev_b32_e32 v52, 7, v1
  v_mfma_f32_32x32x16_bf16 v[208:223], a[188:191], v[168:171], v[208:223]
  ds_read_b64_tr_b16 a[184:185], v18 offset:45056
  ds_read_b64_tr_b16 a[186:187], v18 offset:45568
  v_mfma_f32_32x32x16_bf16 v[224:239], a[160:163], v[168:171], v[224:239]
  ds_read_b64_tr_b16 a[188:189], v18 offset:47104
  ds_read_b64_tr_b16 a[190:191], v18 offset:47616
  buffer_load_dwordx4 v[38:41], v52, s[24:27], s87 offen sc0 sc1
  v_mfma_f32_32x32x16_bf16 v[240:255], a[164:167], v[168:171], v[240:255]
  s_waitcnt vmcnt(40) lgkmcnt(6)
  v_mfma_f32_32x32x16_bf16 v[56:71], v[172:175], a[168:171], v[56:71]
  s_waitcnt vmcnt(31) lgkmcnt(0)
  s_barrier
  ds_read_b128 a[160:163], v9 offset:8192
  ds_read_b128 a[164:167], v9 offset:9216
  v_mfma_f32_32x32x16_bf16 v[72:87], v[172:175], a[172:175], v[72:87]
  ds_read_b64_tr_b16 a[168:169], v15 offset:10240
  ds_read_b64_tr_b16 a[170:171], v15 offset:10752
  v_mfma_f32_32x32x16_bf16 v[192:207], a[176:179], v[172:175], v[192:207]
  ds_read_b64_tr_b16 a[172:173], v15 offset:12288
  ds_read_b64_tr_b16 a[174:175], v15 offset:12800
  v_mfma_f32_32x32x16_bf16 v[208:223], a[180:183], v[172:175], v[208:223]
  ds_read_b64_tr_b16 a[176:177], v16 offset:10240
  ds_read_b64_tr_b16 a[178:179], v16 offset:10752
  v_mfma_f32_32x32x16_bf16 v[224:239], a[184:187], v[172:175], v[224:239]
  ds_read_b64_tr_b16 a[180:181], v16 offset:12288
  ds_read_b64_tr_b16 a[182:183], v16 offset:12800
  v_mfma_f32_32x32x16_bf16 v[240:255], a[188:191], v[172:175], v[240:255]
  ds_read_b128 a[184:187], v10 offset:8192
  s_waitcnt lgkmcnt(7)
  v_mfma_f32_32x32x16_bf16 v[56:71], v[176:179], a[160:163], v[56:71]
  ds_read_b128 a[188:191], v10 offset:9216
  v_mfma_f32_32x32x16_bf16 v[72:87], v[176:179], a[164:167], v[72:87]
  ds_read_b64_tr_b16 a[160:161], v15 offset:16384
  ds_read_b64_tr_b16 a[162:163], v15 offset:16896
  v_mfma_f32_32x32x16_bf16 v[192:207], a[168:171], v[176:179], v[192:207]
  ds_read_b64_tr_b16 a[164:165], v15 offset:18432
  ds_read_b64_tr_b16 a[166:167], v15 offset:18944
  s_waitcnt lgkmcnt(6)
  v_mfma_f32_32x32x16_bf16 v[208:223], a[172:175], v[176:179], v[208:223]
  ds_read_b64_tr_b16 a[168:169], v16 offset:16384
  ds_read_b64_tr_b16 a[170:171], v16 offset:16896
  v_mfma_f32_32x32x16_bf16 v[224:239], a[176:179], v[176:179], v[224:239]
  ds_read_b64_tr_b16 a[172:173], v16 offset:18432
  ds_read_b64_tr_b16 a[174:175], v16 offset:18944
  v_mfma_f32_32x32x16_bf16 v[240:255], a[180:183], v[176:179], v[240:255]
  ds_read_b128 a[176:179], v11 offset:8192
  s_waitcnt lgkmcnt(7)
  v_mfma_f32_32x32x16_bf16 v[56:71], v[180:183], a[184:187], v[56:71]
  ds_read_b128 a[180:183], v11 offset:9216
  v_mfma_f32_32x32x16_bf16 v[72:87], v[180:183], a[188:191], v[72:87]
  ds_read_b64_tr_b16 a[184:185], v15 offset:22528
  ds_read_b64_tr_b16 a[186:187], v15 offset:23040
  v_mfma_f32_32x32x16_bf16 v[192:207], a[160:163], v[180:183], v[192:207]
  ds_read_b64_tr_b16 a[188:189], v15 offset:24576
  ds_read_b64_tr_b16 a[190:191], v15 offset:25088
  s_waitcnt lgkmcnt(6)
  v_mfma_f32_32x32x16_bf16 v[208:223], a[164:167], v[180:183], v[208:223]
  ds_read_b64_tr_b16 a[160:161], v16 offset:22528
  ds_read_b64_tr_b16 a[162:163], v16 offset:23040
  v_mfma_f32_32x32x16_bf16 v[224:239], a[168:171], v[180:183], v[224:239]
  ds_read_b64_tr_b16 a[164:165], v16 offset:24576
  ds_read_b64_tr_b16 a[166:167], v16 offset:25088
  v_mfma_f32_32x32x16_bf16 v[240:255], a[172:175], v[180:183], v[240:255]
  ds_read_b128 a[168:171], v12 offset:8192
  s_waitcnt lgkmcnt(7)
  v_mfma_f32_32x32x16_bf16 v[56:71], v[184:187], a[176:179], v[56:71]
  ds_read_b128 a[172:175], v12 offset:9216
  v_mfma_f32_32x32x16_bf16 v[72:87], v[184:187], a[180:183], v[72:87]
  ds_read_b64_tr_b16 a[176:177], v15 offset:28672
  ds_read_b64_tr_b16 a[178:179], v15 offset:29184
  v_mfma_f32_32x32x16_bf16 v[192:207], a[184:187], v[184:187], v[192:207]
  ds_read_b64_tr_b16 a[180:181], v15 offset:30720
  ds_read_b64_tr_b16 a[182:183], v15 offset:31232
  s_waitcnt lgkmcnt(6)
  v_mfma_f32_32x32x16_bf16 v[208:223], a[188:191], v[184:187], v[208:223]
  ds_read_b64_tr_b16 a[184:185], v16 offset:28672
  ds_read_b64_tr_b16 a[186:187], v16 offset:29184
  s_waitcnt vmcnt(0)
  v_bitop3_b32 v38, v38, v39, s77 bitop3:0x7e
  v_bitop3_b32 v40, v40, v41, s77 bitop3:0x7e
  v_or_b32_e32 v38, v38, v40
  v_cmp_ne_u32 vcc, 0, v38
  v_mfma_f32_32x32x16_bf16 v[224:239], a[160:163], v[184:187], v[224:239]
  ds_read_b64_tr_b16 a[188:189], v16 offset:30720
  ds_read_b64_tr_b16 a[190:191], v16 offset:31232
  v_mfma_f32_32x32x16_bf16 v[240:255], a[164:167], v[184:187], v[240:255]
  s_waitcnt lgkmcnt(6)
  s_cbranch_vccnz L_f21
L_f2r1:
  v_mfma_f32_32x32x16_bf16 v[56:71], v[188:191], a[168:171], v[56:71]
  s_waitcnt lgkmcnt(0)
  s_barrier
  ds_read_b128 a[160:163], v5 offset:0
  ds_read_b128 a[164:167], v5 offset:1024
  v_mfma_f32_32x32x16_bf16 v[72:87], v[188:191], a[172:175], v[72:87]
  s_add_u32 m0, s90, 49152
  s_add_u32 s84, s88, s35
  ds_read_b64_tr_b16 a[168:169], v13 offset:2048
  ds_read_b64_tr_b16 a[170:171], v13 offset:2560
  buffer_load_dwordx4 v2, s[8:11], s84 offen offset:0  lds
  s_add_u32 s85, s2, s28
  s_mov_b32 s87, 13041664
  s_cmp_eq_u32 s85, 0
  s_cselect_b32 s87, s87, 0x10000000
  v_readlane_b32 s82, v21, 0
  v_mfma_f32_32x32x16_bf16 v[192:207], a[176:179], v[188:191], v[192:207]
  ds_read_b64_tr_b16 a[172:173], v13 offset:4096
  ds_read_b64_tr_b16 a[174:175], v13 offset:4608
  buffer_store_dword v55, v54, s[24:27], s87 offen sc0 sc1
  v_mfma_f32_32x32x16_bf16 v[208:223], a[180:183], v[188:191], v[208:223]
  s_add_u32 m0, s97, 81920
  ds_read_b64_tr_b16 a[176:177], v14 offset:2048
  ds_read_b64_tr_b16 a[178:179], v14 offset:2560
  buffer_load_dwordx4 v20, s[24:27], s82 offen offset:0 sc0 sc1 lds
  v_mfma_f32_32x32x16_bf16 v[224:239], a[184:187], v[188:191], v[224:239]
  s_add_u32 m0, s90, 49152
  ds_read_b64_tr_b16 a[180:181], v14 offset:4096
  ds_read_b64_tr_b16 a[182:183], v14 offset:4608
  buffer_load_dwordx4 v2, s[12:15], s84 offen offset:1024  lds
  v_mfma_f32_32x32x16_bf16 v[240:255], a[188:191], v[188:191], v[240:255]
  ds_read_b128 a[184:187], v6 offset:0
  s_waitcnt lgkmcnt(7)
  v_mfma_f32_32x32x16_bf16 v[56:71], a[32:35], a[160:163], v[56:71]
  s_add_u32 m0, s97, 81920
  ds_read_b128 a[188:191], v6 offset:1024
  buffer_load_dwordx4 v20, s[24:27], s82 offen offset:1024 sc0 sc1 lds
  v_mfma_f32_32x32x16_bf16 v[72:87], a[32:35], a[164:167], v[72:87]
  ds_read_b64_tr_b16 a[160:161], v13 offset:8192
  ds_read_b64_tr_b16 a[162:163], v13 offset:8704
  v_mfma_f32_32x32x16_bf16 v[192:207], a[168:171], a[32:35], v[192:207]
  s_mul_i32 s84, s35, 1728
  s_add_u32 m0, s90, 51200
  s_add_u32 s84, s84, s93
  ds_read_b64_tr_b16 a[164:165], v13 offset:10240
  ds_read_b64_tr_b16 a[166:167], v13 offset:10752
  s_waitcnt lgkmcnt(6)
  buffer_load_dwordx4 v3, s[16:19], s84 offen offset:0  lds
  v_mfma_f32_32x32x16_bf16 v[208:223], a[172:175], a[32:35], v[208:223]
  s_add_u32 m0, s97, 81920
  ds_read_b64_tr_b16 a[168:169], v14 offset:8192
  ds_read_b64_tr_b16 a[170:171], v14 offset:8704
  buffer_load_dwordx4 v20, s[24:27], s82 offen offset:2048 sc0 sc1 lds
  v_mfma_f32_32x32x16_bf16 v[224:239], a[176:179], a[32:35], v[224:239]
  ds_read_b64_tr_b16 a[172:173], v14 offset:10240
  ds_read_b64_tr_b16 a[174:175], v14 offset:10752
  v_mfma_f32_32x32x16_bf16 v[240:255], a[180:183], a[32:35], v[240:255]
  s_add_u32 m0, s90, 51200
  ds_read_b128 a[176:179], v7 offset:0
  s_waitcnt lgkmcnt(7)
  buffer_load_dwordx4 v4, s[16:19], s84 offen offset:1024  lds
  v_mfma_f32_32x32x16_bf16 v[56:71], a[36:39], a[184:187], v[56:71]
  ds_read_b128 a[180:183], v7 offset:1024
  v_mfma_f32_32x32x16_bf16 v[72:87], a[36:39], a[188:191], v[72:87]
  s_add_u32 m0, s97, 81920
  ds_read_b64_tr_b16 a[184:185], v13 offset:14336
  ds_read_b64_tr_b16 a[186:187], v13 offset:14848
  buffer_load_dwordx4 v20, s[24:27], s82 offen offset:3072 sc0 sc1 lds
  v_mfma_f32_32x32x16_bf16 v[192:207], a[160:163], a[36:39], v[192:207]
  ds_read_b64_tr_b16 a[188:189], v13 offset:16384
  ds_read_b64_tr_b16 a[190:191], v13 offset:16896
  s_waitcnt lgkmcnt(6)
  v_mfma_f32_32x32x16_bf16 v[208:223], a[164:167], a[36:39], v[208:223]
  s_add_u32 m0, s90, 51200
  ds_read_b64_tr_b16 a[160:161], v14 offset:14336
  ds_read_b64_tr_b16 a[162:163], v14 offset:14848
  buffer_load_dwordx4 v3, s[20:23], s84 offen offset:2048  lds
  v_mfma_f32_32x32x16_bf16 v[224:239], a[168:171], a[36:39], v[224:239]
  s_add_u32 m0, s97, 86016
  ds_read_b64_tr_b16 a[164:165], v14 offset:16384
  ds_read_b64_tr_b16 a[166:167], v14 offset:16896
  buffer_load_dwordx4 v94, s[24:27], s82 offen offset:0 sc0 sc1 lds
  v_mfma_f32_32x32x16_bf16 v[240:255], a[172:175], a[36:39], v[240:255]
  ds_read_b128 a[168:171], v8 offset:0
  s_waitcnt lgkmcnt(7)
  v_mfma_f32_32x32x16_bf16 v[56:71], a[40:43], a[176:179], v[56:71]
  s_add_u32 m0, s90, 51200
  ds_read_b128 a[172:175], v8 offset:1024
  buffer_load_dwordx4 v4, s[20:23], s84 offen offset:3072  lds
  s_addk_i32 s35, 128
  s_cmpk_eq_u32 s35, 1280
  s_cselect_b32 s35, 0, s35
  v_readlane_b32 s83, v21, 1
  v_mfma_f32_32x32x16_bf16 v[72:87], a[40:43], a[180:183], v[72:87]
  ds_read_b64_tr_b16 a[176:177], v13 offset:20480
  ds_read_b64_tr_b16 a[178:179], v13 offset:20992
  v_mfma_f32_32x32x16_bf16 v[192:207], a[184:187], a[40:43], v[192:207]
  s_add_u32 m0, s97, 87040
  ds_read_b64_tr_b16 a[180:181], v13 offset:22528
  ds_read_b64_tr_b16 a[182:183], v13 offset:23040
  s_waitcnt lgkmcnt(6)
  buffer_load_dwordx4 v20, s[24:27], s83 offen offset:0 sc0 sc1 lds
  v_mfma_f32_32x32x16_bf16 v[208:223], a[188:191], a[40:43], v[208:223]
  ds_read_b64_tr_b16 a[184:185], v14 offset:20480
  ds_read_b64_tr_b16 a[186:187], v14 offset:20992
  v_mfma_f32_32x32x16_bf16 v[224:239], a[160:163], a[40:43], v[224:239]
  ds_read_b64_tr_b16 a[188:189], v14 offset:22528
  ds_read_b64_tr_b16 a[190:191], v14 offset:23040
  buffer_load_dwordx4 v20, s[24:27], s83 offen offset:1024 sc0 sc1 lds
  v_mfma_f32_32x32x16_bf16 v[240:255], a[164:167], a[40:43], v[240:255]
  s_waitcnt lgkmcnt(6)
  v_mfma_f32_32x32x16_bf16 v[56:71], a[44:47], a[168:171], v[56:71]
  s_waitcnt lgkmcnt(0)
  s_barrier
  ds_read_b128 a[160:163], v5 offset:24576
  ds_read_b128 a[164:167], v5 offset:25600
  v_mfma_f32_32x32x16_bf16 v[72:87], a[44:47], a[172:175], v[72:87]
  s_add_u32 m0, s90, 0
  s_add_u32 s84, s88, s35
  ds_read_b64_tr_b16 a[168:169], v13 offset:26624
  ds_read_b64_tr_b16 a[170:171], v13 offset:27136
  buffer_load_dwordx4 v2, s[8:11], s84 offen offset:0  lds
  v_mfma_f32_32x32x16_bf16 v[192:207], a[176:179], a[44:47], v[192:207]
  s_add_u32 m0, s97, 87040
  ds_read_b64_tr_b16 a[172:173], v13 offset:28672
  ds_read_b64_tr_b16 a[174:175], v13 offset:29184
  buffer_load_dwordx4 v20, s[24:27], s83 offen offset:2048 sc0 sc1 lds
  v_mfma_f32_32x32x16_bf16 v[208:223], a[180:183], a[44:47], v[208:223]
  ds_read_b64_tr_b16 a[176:177], v14 offset:26624
  ds_read_b64_tr_b16 a[178:179], v14 offset:27136
  v_mfma_f32_32x32x16_bf16 v[224:239], a[184:187], a[44:47], v[224:239]
  s_add_u32 m0, s90, 0
  ds_read_b64_tr_b16 a[180:181], v14 offset:28672
  ds_read_b64_tr_b16 a[182:183], v14 offset:29184
  buffer_load_dwordx4 v2, s[12:15], s84 offen offset:1024  lds
  v_mfma_f32_32x32x16_bf16 v[240:255], a[188:191], a[44:47], v[240:255]
  ds_read_b128 a[184:187], v6 offset:24576
  s_waitcnt lgkmcnt(7)
  v_mfma_f32_32x32x16_bf16 v[56:71], a[48:51], a[160:163], v[56:71]
  s_add_u32 m0, s97, 87040
  ds_read_b128 a[188:191], v6 offset:25600
  buffer_load_dwordx4 v20, s[24:27], s83 offen offset:3072 sc0 sc1 lds
  v_mfma_f32_32x32x16_bf16 v[72:87], a[48:51], a[164:167], v[72:87]
  ds_read_b64_tr_b16 a[160:161], v13 offset:32768
  ds_read_b64_tr_b16 a[162:163], v13 offset:33280
  v_mfma_f32_32x32x16_bf16 v[192:207], a[168:171], a[48:51], v[192:207]
  s_mul_i32 s84, s35, 1728
  s_add_u32 m0, s90, 2048
  s_add_u32 s84, s84, s93
  ds_read_b64_tr_b16 a[164:165], v13 offset:34816
  ds_read_b64_tr_b16 a[166:167], v13 offset:35328
  s_waitcnt lgkmcnt(6)
  buffer_load_dwordx4 v3, s[16:19], s84 offen offset:0  lds
  v_mfma_f32_32x32x16_bf16 v[208:223], a[172:175], a[48:51], v[208:223]
  s_add_u32 m0, s97, 91136
  ds_read_b64_tr_b16 a[168:169], v14 offset:32768
  ds_read_b64_tr_b16 a[170:171], v14 offset:33280
  buffer_load_dwordx4 v94, s[24:27], s83 offen offset:0 sc0 sc1 lds
  v_mfma_f32_32x32x16_bf16 v[224:239], a[176:179], a[48:51], v[224:239]
  ds_read_b64_tr_b16 a[172:173], v14 offset:34816
  ds_read_b64_tr_b16 a[174:175], v14 offset:35328
  v_mfma_f32_32x32x16_bf16 v[240:255], a[180:183], a[48:51], v[240:255]
  s_add_u32 m0, s90, 2048
  ds_read_b128 a[176:179], v7 offset:24576
  s_waitcnt lgkmcnt(7)
  buffer_load_dwordx4 v4, s[16:19], s84 offen offset:1024  lds
  v_readlane_b32 s96, v21, 2
  v_mfma_f32_32x32x16_bf16 v[56:71], a[52:55], a[184:187], v[56:71]
  ds_read_b128 a[180:183], v7 offset:25600
  v_mfma_f32_32x32x16_bf16 v[72:87], a[52:55], a[188:191], v[72:87]
  s_add_u32 m0, s97, 122880
  ds_read_b64_tr_b16 a[184:185], v13 offset:38912
  ds_read_b64_tr_b16 a[186:187], v13 offset:39424
  buffer_load_dwordx4 v20, s[24:27], s96 offen offset:0 sc0 sc1 lds
  v_mfma_f32_32x32x16_bf16 v[192:207], a[160:163], a[52:55], v[192:207]
  ds_read_b64_tr_b16 a[188:189], v13 offset:40960
  ds_read_b64_tr_b16 a[190:191], v13 offset:41472
  s_waitcnt lgkmcnt(6)
  v_mfma_f32_32x32x16_bf16 v[208:223], a[164:167], a[52:55], v[208:223]
  s_add_u32 m0, s90, 2048
  ds_read_b64_tr_b16 a[160:161], v14 offset:38912
  ds_read_b64_tr_b16 a[162:163], v14 offset:39424
  buffer_load_dwordx4 v3, s[20:23], s84 offen offset:2048  lds
  v_mfma_f32_32x32x16_bf16 v[224:239], a[168:171], a[52:55], v[224:239]
  s_add_u32 m0, s97, 122880
  ds_read_b64_tr_b16 a[164:165], v14 offset:40960
  ds_read_b64_tr_b16 a[166:167], v14 offset:41472
  buffer_load_dwordx4 v20, s[24:27], s96 offen offset:1024 sc0 sc1 lds
  v_mfma_f32_32x32x16_bf16 v[240:255], a[172:175], a[52:55], v[240:255]
  ds_read_b128 a[168:171], v8 offset:24576
  s_waitcnt lgkmcnt(7)
  v_mfma_f32_32x32x16_bf16 v[56:71], a[56:59], a[176:179], v[56:71]
  s_add_u32 m0, s90, 2048
  ds_read_b128 a[172:175], v8 offset:25600
  buffer_load_dwordx4 v4, s[20:23], s84 offen offset:3072  lds
  s_addk_i32 s35, 128
  s_cmpk_eq_u32 s35, 1280
  s_cselect_b32 s35, 0, s35
  v_mfma_f32_32x32x16_bf16 v[72:87], a[56:59], a[180:183], v[72:87]
  ds_read_b64_tr_b16 a[176:177], v13 offset:45056
  ds_read_b64_tr_b16 a[178:179], v13 offset:45568
  v_mfma_f32_32x32x16_bf16 v[192:207], a[184:187], a[56:59], v[192:207]
  s_add_u32 m0, s97, 122880
  ds_read_b64_tr_b16 a[180:181], v13 offset:47104
  ds_read_b64_tr_b16 a[182:183], v13 offset:47616
  s_waitcnt lgkmcnt(6)
  buffer_load_dwordx4 v20, s[24:27], s96 offen offset:2048 sc0 sc1 lds
  v_mfma_f32_32x32x16_bf16 v[208:223], a[188:191], a[56:59], v[208:223]
  ds_read_b64_tr_b16 a[184:185], v14 offset:45056
  ds_read_b64_tr_b16 a[186:187], v14 offset:45568
  v_mfma_f32_32x32x16_bf16 v[224:239], a[160:163], a[56:59], v[224:239]
  ds_read_b64_tr_b16 a[188:189], v14 offset:47104
  ds_read_b64_tr_b16 a[190:191], v14 offset:47616
  buffer_load_dwordx4 v20, s[24:27], s96 offen offset:3072 sc0 sc1 lds
  v_mfma_f32_32x32x16_bf16 v[240:255], a[164:167], a[56:59], v[240:255]
  s_waitcnt lgkmcnt(6)
  v_mfma_f32_32x32x16_bf16 v[56:71], a[60:63], a[168:171], v[56:71]
  s_waitcnt vmcnt(15) lgkmcnt(0)
  s_barrier
  ds_read_b128 a[160:163], v9 offset:8192
  ds_read_b128 a[164:167], v9 offset:9216
  v_mfma_f32_32x32x16_bf16 v[72:87], a[60:63], a[172:175], v[72:87]
  s_mul_i32 s84, s35, 1728
  s_add_u32 m0, s3, 24576
  s_add_u32 s84, s84, s94
  ds_read_b64_tr_b16 a[168:169], v15 offset:10240
  ds_read_b64_tr_b16 a[170:171], v15 offset:10752
  buffer_load_dwordx4 v3, s[16:19], s84 offen offset:0  lds
  v_mfma_f32_32x32x16_bf16 v[192:207], a[176:179], a[60:63], v[192:207]
  s_add_u32 m0, s97, 126976
  ds_read_b64_tr_b16 a[172:173], v15 offset:12288
  ds_read_b64_tr_b16 a[174:175], v15 offset:12800
  buffer_load_dwordx4 v94, s[24:27], s96 offen offset:0 sc0 sc1 lds
  v_readlane_b32 s82, v21, 3
  v_mfma_f32_32x32x16_bf16 v[208:223], a[180:183], a[60:63], v[208:223]
  ds_read_b64_tr_b16 a[176:177], v16 offset:10240
  ds_read_b64_tr_b16 a[178:179], v16 offset:10752
  v_mfma_f32_32x32x16_bf16 v[224:239], a[184:187], a[60:63], v[224:239]
  s_add_u32 m0, s97, 128000
  ds_read_b64_tr_b16 a[180:181], v16 offset:12288
  ds_read_b64_tr_b16 a[182:183], v16 offset:12800
  buffer_load_dwordx4 v20, s[24:27], s82 offen offset:0 sc0 sc1 lds
  v_mfma_f32_32x32x16_bf16 v[240:255], a[188:191], a[60:63], v[240:255]
  ds_read_b128 a[184:187], v10 offset:8192
  s_waitcnt lgkmcnt(7)
  v_mfma_f32_32x32x16_bf16 v[56:71], a[64:67], a[160:163], v[56:71]
  s_add_u32 m0, s3, 24576
  ds_read_b128 a[188:191], v10 offset:9216
  buffer_load_dwordx4 v4, s[16:19], s84 offen offset:1024  lds
  v_mfma_f32_32x32x16_bf16 v[72:87], a[64:67], a[164:167], v[72:87]
  ds_read_b64_tr_b16 a[160:161], v15 offset:16384
  ds_read_b64_tr_b16 a[162:163], v15 offset:16896
  v_mfma_f32_32x32x16_bf16 v[192:207], a[168:171], a[64:67], v[192:207]
  s_add_u32 m0, s97, 128000
  ds_read_b64_tr_b16 a[164:165], v15 offset:18432
  ds_read_b64_tr_b16 a[166:167], v15 offset:18944
  s_waitcnt lgkmcnt(6)
  buffer_load_dwordx4 v20, s[24:27], s82 offen offset:1024 sc0 sc1 lds
  v_mfma_f32_32x32x16_bf16 v[208:223], a[172:175], a[64:67], v[208:223]
  ds_read_b64_tr_b16 a[168:169], v16 offset:16384
  ds_read_b64_tr_b16 a[170:171], v16 offset:16896
  buffer_load_dwordx4 v20, s[24:27], s82 offen offset:2048 sc0 sc1 lds
  v_mfma_f32_32x32x16_bf16 v[224:239], a[176:179], a[64:67], v[224:239]
  ds_read_b64_tr_b16 a[172:173], v16 offset:18432
  ds_read_b64_tr_b16 a[174:175], v16 offset:18944
  v_mfma_f32_32x32x16_bf16 v[240:255], a[180:183], a[64:67], v[240:255]
  s_add_u32 m0, s3, 24576
  ds_read_b128 a[176:179], v11 offset:8192
  s_waitcnt lgkmcnt(7)
  buffer_load_dwordx4 v3, s[20:23], s84 offen offset:2048  lds
  v_mfma_f32_32x32x16_bf16 v[56:71], a[68:71], a[184:187], v[56:71]
  ds_read_b128 a[180:183], v11 offset:9216
  v_mfma_f32_32x32x16_bf16 v[72:87], a[68:71], a[188:191], v[72:87]
  s_add_u32 m0, s97, 128000
  ds_read_b64_tr_b16 a[184:185], v15 offset:22528
  ds_read_b64_tr_b16 a[186:187], v15 offset:23040
  buffer_load_dwordx4 v20, s[24:27], s82 offen offset:3072 sc0 sc1 lds
  v_mfma_f32_32x32x16_bf16 v[192:207], a[160:163], a[68:71], v[192:207]
  ds_read_b64_tr_b16 a[188:189], v15 offset:24576
  ds_read_b64_tr_b16 a[190:191], v15 offset:25088
  s_waitcnt lgkmcnt(6)
  v_mfma_f32_32x32x16_bf16 v[208:223], a[164:167], a[68:71], v[208:223]
  s_add_u32 m0, s97, 132096
  ds_read_b64_tr_b16 a[160:161], v16 offset:22528
  ds_read_b64_tr_b16 a[162:163], v16 offset:23040
  buffer_load_dwordx4 v94, s[24:27], s82 offen offset:0 sc0 sc1 lds
  v_mfma_f32_32x32x16_bf16 v[224:239], a[168:171], a[68:71], v[224:239]
  s_add_u32 m0, s3, 24576
  ds_read_b64_tr_b16 a[164:165], v16 offset:24576
  ds_read_b64_tr_b16 a[166:167], v16 offset:25088
  buffer_load_dwordx4 v4, s[20:23], s84 offen offset:3072  lds
  s_addk_i32 s35, 128
  s_cmpk_eq_u32 s35, 1280
  s_cselect_b32 s35, 0, s35
  v_readlane_b32 s83, v21, 12
  v_mfma_f32_32x32x16_bf16 v[240:255], a[172:175], a[68:71], v[240:255]
  ds_read_b128 a[168:171], v12 offset:8192
  s_waitcnt lgkmcnt(7)
  v_mfma_f32_32x32x16_bf16 v[56:71], a[72:75], a[176:179], v[56:71]
  ds_read_b128 a[172:175], v12 offset:9216
  buffer_load_dwordx4 a[192:195], v20, s[24:27], s83 offen offset:2048 sc0 sc1
  v_mfma_f32_32x32x16_bf16 v[72:87], a[72:75], a[180:183], v[72:87]
  ds_read_b64_tr_b16 a[176:177], v15 offset:28672
  ds_read_b64_tr_b16 a[178:179], v15 offset:29184
  v_mfma_f32_32x32x16_bf16 v[192:207], a[184:187], a[72:75], v[192:207]
  ds_read_b64_tr_b16 a[180:181], v15 offset:30720
  ds_read_b64_tr_b16 a[182:183], v15 offset:31232
  s_waitcnt lgkmcnt(6)
  buffer_load_dwordx4 a[196:199], v20, s[24:27], s83 offen offset:3072 sc0 sc1
  v_mfma_f32_32x32x16_bf16 v[208:223], a[188:191], a[72:75], v[208:223]
  ds_read_b64_tr_b16 a[184:185], v16 offset:28672
  ds_read_b64_tr_b16 a[186:187], v16 offset:29184
  v_mfma_f32_32x32x16_bf16 v[224:239], a[160:163], a[72:75], v[224:239]
  ds_read_b64_tr_b16 a[188:189], v16 offset:30720
  ds_read_b64_tr_b16 a[190:191], v16 offset:31232
  buffer_load_dwordx4 a[200:203], v94, s[24:27], s83 offen offset:0 sc0 sc1
  v_mfma_f32_32x32x16_bf16 v[240:255], a[164:167], a[72:75], v[240:255]
  s_waitcnt lgkmcnt(6)
  v_mfma_f32_32x32x16_bf16 v[56:71], a[76:79], a[168:171], v[56:71]
  s_waitcnt vmcnt(15) lgkmcnt(0)
  s_barrier
  ds_read_b128 a[160:163], v5 offset:0
  ds_read_b128 a[164:167], v5 offset:1024
  v_mfma_f32_32x32x16_bf16 v[72:87], a[76:79], a[172:175], v[72:87]
  s_mul_i32 s84, s35, 1728
  s_add_u32 m0, s3, 40960
  s_add_u32 s84, s84, s94
  ds_read_b64_tr_b16 a[168:169], v13 offset:2048
  ds_read_b64_tr_b16 a[170:171], v13 offset:2560
  buffer_load_dwordx4 v3, s[16:19], s84 offen offset:0  lds
  v_mfma_f32_32x32x16_bf16 v[192:207], a[176:179], a[76:79], v[192:207]
  ds_read_b64_tr_b16 a[172:173], v13 offset:4096
  ds_read_b64_tr_b16 a[174:175], v13 offset:4608
  buffer_load_dwordx4 v4, s[16:19], s84 offen offset:1024  lds
  v_readlane_b32 s96, v21, 13
  v_mfma_f32_32x32x16_bf16 v[208:223], a[180:183], a[76:79], v[208:223]
  ds_read_b64_tr_b16 a[176:177], v14 offset:2048
  ds_read_b64_tr_b16 a[178:179], v14 offset:2560
  v_mfma_f32_32x32x16_bf16 v[224:239], a[184:187], a[76:79], v[224:239]
  ds_read_b64_tr_b16 a[180:181], v14 offset:4096
  ds_read_b64_tr_b16 a[182:183], v14 offset:4608
  buffer_load_dwordx4 a[204:207], v20, s[24:27], s96 offen offset:0 sc0 sc1
  v_mfma_f32_32x32x16_bf16 v[240:255], a[188:191], a[76:79], v[240:255]
  ds_read_b128 a[184:187], v6 offset:0
  s_waitcnt lgkmcnt(7)
  v_mfma_f32_32x32x16_bf16 v[56:71], a[80:83], a[160:163], v[56:71]
  ds_read_b128 a[188:191], v6 offset:1024
  buffer_load_dwordx4 v3, s[20:23], s84 offen offset:2048  lds
  v_mfma_f32_32x32x16_bf16 v[72:87], a[80:83], a[164:167], v[72:87]
  ds_read_b64_tr_b16 a[160:161], v13 offset:8192
  ds_read_b64_tr_b16 a[162:163], v13 offset:8704
  v_mfma_f32_32x32x16_bf16 v[192:207], a[168:171], a[80:83], v[192:207]
  ds_read_b64_tr_b16 a[164:165], v13 offset:10240
  ds_read_b64_tr_b16 a[166:167], v13 offset:10752
  s_waitcnt lgkmcnt(6)
  buffer_load_dwordx4 v4, s[20:23], s84 offen offset:3072  lds
  s_addk_i32 s35, 128
  s_cmpk_eq_u32 s35, 1280
  s_cselect_b32 s35, 0, s35
  v_mfma_f32_32x32x16_bf16 v[208:223], a[172:175], a[80:83], v[208:223]
  ds_read_b64_tr_b16 a[168:169], v14 offset:8192
  ds_read_b64_tr_b16 a[170:171], v14 offset:8704
  buffer_load_dwordx4 a[208:211], v20, s[24:27], s96 offen offset:1024 sc0 sc1
  v_mfma_f32_32x32x16_bf16 v[224:239], a[176:179], a[80:83], v[224:239]
  ds_read_b64_tr_b16 a[172:173], v14 offset:10240
  ds_read_b64_tr_b16 a[174:175], v14 offset:10752
  v_mfma_f32_32x32x16_bf16 v[240:255], a[180:183], a[80:83], v[240:255]
  s_mul_i32 s84, s35, 1728
  s_add_u32 m0, s3, 57344
  s_add_u32 s84, s84, s94
  ds_read_b128 a[176:179], v7 offset:0
  s_waitcnt lgkmcnt(7)
  buffer_load_dwordx4 v3, s[16:19], s84 offen offset:0  lds
  v_mfma_f32_32x32x16_bf16 v[56:71], a[84:87], a[184:187], v[56:71]
  ds_read_b128 a[180:183], v7 offset:1024
  v_mfma_f32_32x32x16_bf16 v[72:87], a[84:87], a[188:191], v[72:87]
  ds_read_b64_tr_b16 a[184:185], v13 offset:14336
  ds_read_b64_tr_b16 a[186:187], v13 offset:14848
  buffer_load_dwordx4 a[212:215], v20, s[24:27], s96 offen offset:2048 sc0 sc1
  v_mfma_f32_32x32x16_bf16 v[192:207], a[160:163], a[84:87], v[192:207]
  ds_read_b64_tr_b16 a[188:189], v13 offset:16384
  ds_read_b64_tr_b16 a[190:191], v13 offset:16896
  s_waitcnt lgkmcnt(6)
  v_mfma_f32_32x32x16_bf16 v[208:223], a[164:167], a[84:87], v[208:223]
  ds_read_b64_tr_b16 a[160:161], v14 offset:14336
  ds_read_b64_tr_b16 a[162:163], v14 offset:14848
  buffer_load_dwordx4 v4, s[16:19], s84 offen offset:1024  lds
  v_mfma_f32_32x32x16_bf16 v[224:239], a[168:171], a[84:87], v[224:239]
  ds_read_b64_tr_b16 a[164:165], v14 offset:16384
  ds_read_b64_tr_b16 a[166:167], v14 offset:16896
  buffer_load_dwordx4 v3, s[20:23], s84 offen offset:2048  lds
  v_mfma_f32_32x32x16_bf16 v[240:255], a[172:175], a[84:87], v[240:255]
  ds_read_b128 a[168:171], v8 offset:0
  s_waitcnt lgkmcnt(7)
  v_mfma_f32_32x32x16_bf16 v[56:71], a[88:91], a[176:179], v[56:71]
  ds_read_b128 a[172:175], v8 offset:1024
  buffer_load_dwordx4 a[216:219], v20, s[24:27], s96 offen offset:3072 sc0 sc1
  v_mfma_f32_32x32x16_bf16 v[72:87], a[88:91], a[180:183], v[72:87]
  ds_read_b64_tr_b16 a[176:177], v13 offset:20480
  ds_read_b64_tr_b16 a[178:179], v13 offset:20992
  v_mfma_f32_32x32x16_bf16 v[192:207], a[184:187], a[88:91], v[192:207]
  ds_read_b64_tr_b16 a[180:181], v13 offset:22528
  ds_read_b64_tr_b16 a[182:183], v13 offset:23040
  s_waitcnt lgkmcnt(6)
  buffer_load_dwordx4 v4, s[20:23], s84 offen offset:3072  lds
  s_addk_i32 s35, 128
  s_cmpk_eq_u32 s35, 1280
  s_cselect_b32 s35, 0, s35
  v_mfma_f32_32x32x16_bf16 v[208:223], a[188:191], a[88:91], v[208:223]
  ds_read_b64_tr_b16 a[184:185], v14 offset:20480
  ds_read_b64_tr_b16 a[186:187], v14 offset:20992
  v_mfma_f32_32x32x16_bf16 v[224:239], a[160:163], a[88:91], v[224:239]
  ds_read_b64_tr_b16 a[188:189], v14 offset:22528
  ds_read_b64_tr_b16 a[190:191], v14 offset:23040
  buffer_load_dwordx4 a[220:223], v94, s[24:27], s96 offen offset:0 sc0 sc1
  v_mfma_f32_32x32x16_bf16 v[240:255], a[164:167], a[88:91], v[240:255]
  s_waitcnt lgkmcnt(6)
  v_mfma_f32_32x32x16_bf16 v[56:71], a[92:95], a[168:171], v[56:71]
  s_waitcnt vmcnt(16) lgkmcnt(0)
  s_barrier
  ds_read_b64_tr_b16 a[160:161], v13 offset:24576
  ds_read_b64_tr_b16 a[162:163], v13 offset:25088
  ds_read_b64_tr_b16 a[164:165], v13 offset:26624
  ds_read_b64_tr_b16 a[166:167], v13 offset:27136
  v_readlane_b32 s82, v21, 14
  v_mfma_f32_32x32x16_bf16 v[72:87], a[92:95], a[172:175], v[72:87]
  s_mul_i32 s84, s35, 1728
  s_add_u32 m0, s3, 0
  s_add_u32 s84, s84, s94
  ds_read_b64_tr_b16 a[168:169], v14 offset:24576
  ds_read_b64_tr_b16 a[170:171], v14 offset:25088
  buffer_load_dwordx4 v3, s[16:19], s84 offen offset:0  lds
  v_mfma_f32_32x32x16_bf16 v[192:207], a[176:179], a[92:95], v[192:207]
  ds_read_b64_tr_b16 a[172:173], v14 offset:26624
  ds_read_b64_tr_b16 a[174:175], v14 offset:27136
  buffer_load_dwordx4 a[224:227], v20, s[24:27], s82 offen offset:0 sc0 sc1
  v_mfma_f32_32x32x16_bf16 v[208:223], a[180:183], a[92:95], v[208:223]
  ds_read_b64_tr_b16 a[176:177], v13 offset:28672
  ds_read_b64_tr_b16 a[178:179], v13 offset:29184
  v_mfma_f32_32x32x16_bf16 v[224:239], a[184:187], a[92:95], v[224:239]
  ds_read_b64_tr_b16 a[180:181], v13 offset:30720
  ds_read_b64_tr_b16 a[182:183], v13 offset:31232
  buffer_load_dwordx4 v4, s[16:19], s84 offen offset:1024  lds
  v_fma_f32 v50, v22, v56, v57
  v_fma_f32 v51, v22, v72, v73
  v_fma_f32 v50, -v23, v72, v50
  v_fmac_f32_e64 v51, v23, v56
  v_fma_f32 v48, v22, v50, v58
  v_mfma_f32_32x32x16_bf16 v[240:255], a[188:191], a[92:95], v[240:255]
  ds_read_b64_tr_b16 a[184:185], v14 offset:28672
  ds_read_b64_tr_b16 a[186:187], v14 offset:29184
  s_waitcnt lgkmcnt(8)
  v_fma_f32 v49, v22, v51, v74
  v_fma_f32 v48, -v23, v51, v48
  v_fmac_f32_e32 v49, v23, v50
  v_fma_f32 v50, v22, v48, v59
  v_fma_f32 v51, v22, v49, v75
  v_fma_f32 v50, -v23, v49, v50
  v_mfma_f32_32x32x16_bf16 a[96:111], a[160:163], v[96:99], 0
  ds_read_b64_tr_b16 a[188:189], v14 offset:30720
  ds_read_b64_tr_b16 a[190:191], v14 offset:31232
  buffer_load_dwordx4 a[228:231], v20, s[24:27], s82 offen offset:1024 sc0 sc1
  v_fmac_f32_e64 v51, v23, v48
  v_fma_f32 v48, v22, v50, v60
  v_fma_f32 v49, v22, v51, v76
  v_fma_f32 v48, -v23, v51, v48
  v_fmac_f32_e64 v49, v23, v50
  v_fma_f32 v50, v22, v48, v61
  v_fma_f32 v51, v22, v49, v77
  v_mfma_f32_32x32x16_bf16 a[112:127], a[164:167], v[96:99], 0
  ds_read_b64_tr_b16 a[160:161], v13 offset:32768
  ds_read_b64_tr_b16 a[162:163], v13 offset:33280
  buffer_load_dwordx4 v3, s[20:23], s84 offen offset:2048  lds
  v_fma_f32 v50, -v23, v49, v50
  v_fmac_f32_e64 v51, v23, v48
  v_fma_f32 v48, v22, v50, v62
  v_fma_f32 v49, v22, v51, v78
  v_fma_f32 v48, -v23, v51, v48
  v_mfma_f32_32x32x16_bf16 a[128:143], a[168:171], v[96:99], 0
  ds_read_b64_tr_b16 a[164:165], v13 offset:34816
  ds_read_b64_tr_b16 a[166:167], v13 offset:35328
  s_waitcnt lgkmcnt(8)
  v_fmac_f32_e32 v49, v23, v50
  v_fma_f32 v50, v22, v48, v63
  v_fma_f32 v51, v22, v49, v79
  v_fma_f32 v50, -v23, v49, v50
  v_fmac_f32_e64 v51, v23, v48
  v_fma_f32 v48, v22, v50, v64
  v_mfma_f32_32x32x16_bf16 a[144:159], a[172:175], v[96:99], 0
  ds_read_b64_tr_b16 a[168:169], v14 offset:32768
  ds_read_b64_tr_b16 a[170:171], v14 offset:33280
  buffer_load_dwordx4 a[232:235], v20, s[24:27], s82 offen offset:2048 sc0 sc1
  v_fma_f32 v49, v22, v51, v80
  v_fma_f32 v48, -v23, v51, v48
  v_fmac_f32_e64 v49, v23, v50
  v_fma_f32 v50, v22, v48, v65
  v_fma_f32 v51, v22, v49, v81
  v_fma_f32 v50, -v23, v49, v50
  v_fmac_f32_e64 v51, v23, v48
  v_mfma_f32_32x32x16_bf16 a[96:111], a[176:179], v[100:103], a[96:111]
  ds_read_b64_tr_b16 a[172:173], v14 offset:34816
  ds_read_b64_tr_b16 a[174:175], v14 offset:35328
  v_fma_f32 v48, v22, v50, v66
  v_fma_f32 v49, v22, v51, v82
  v_fma_f32 v48, -v23, v51, v48
  v_fmac_f32_e64 v49, v23, v50
  v_fma_f32 v50, v22, v48, v67
  v_fma_f32 v51, v22, v49, v83
  v_fma_f32 v50, -v23, v49, v50
  v_mfma_f32_32x32x16_bf16 a[112:127], a[180:183], v[100:103], a[112:127]
  ds_read_b64_tr_b16 a[176:177], v13 offset:36864
  ds_read_b64_tr_b16 a[178:179], v13 offset:37376
  s_waitcnt lgkmcnt(8)
  buffer_load_dwordx4 v4, s[20:23], s84 offen offset:3072  lds
  s_addk_i32 s35, 128
  s_cmpk_eq_u32 s35, 1280
  s_cselect_b32 s35, 0, s35
  v_fmac_f32_e64 v51, v23, v48
  v_mfma_f32_32x32x16_bf16 a[128:143], a[184:187], v[100:103], a[128:143]
  ds_read_b64_tr_b16 a[180:181], v13 offset:38912
  ds_read_b64_tr_b16 a[182:183], v13 offset:39424
  buffer_load_dwordx4 a[236:239], v20, s[24:27], s82 offen offset:3072 sc0 sc1
  v_fma_f32 v48, v22, v50, v68
  v_fma_f32 v49, v22, v51, v84
  v_fma_f32 v48, -v23, v51, v48
  v_fmac_f32_e64 v49, v23, v50
  v_fma_f32 v50, v22, v48, v69
  v_fma_f32 v51, v22, v49, v85
  v_fma_f32 v50, -v23, v49, v50
  v_mfma_f32_32x32x16_bf16 a[144:159], a[188:191], v[100:103], a[144:159]
  ds_read_b64_tr_b16 a[184:185], v14 offset:36864
  ds_read_b64_tr_b16 a[186:187], v14 offset:37376
  v_fmac_f32_e64 v51, v23, v48
  v_fma_f32 v48, v22, v50, v70
  v_fma_f32 v49, v22, v51, v86
  v_fma_f32 v48, -v23, v51, v48
  v_fmac_f32_e64 v49, v23, v50
  v_fma_f32 v50, v22, v48, v71
  v_fma_f32 v51, v22, v49, v87
  v_mfma_f32_32x32x16_bf16 a[96:111], a[160:163], v[104:107], a[96:111]
  ds_read_b64_tr_b16 a[188:189], v14 offset:38912
  ds_read_b64_tr_b16 a[190:191], v14 offset:39424
  s_waitcnt lgkmcnt(8)
  buffer_load_dwordx4 a[240:243], v94, s[24:27], s82 offen offset:0 sc0 sc1
  v_fma_f32 v50, -v23, v49, v50
  v_fmac_f32_e32 v51, v23, v48
  v_mfma_f32_32x32x16_bf16 a[112:127], a[164:167], v[104:107], a[112:127]
  ds_write_b64 v42, v[50:51] offset:0
  v_mfma_f32_32x32x16_bf16 a[128:143], a[168:171], v[104:107], a[128:143]
  s_waitcnt vmcnt(17) lgkmcnt(0)
  s_barrier
  ds_read_b64_tr_b16 a[160:161], v15 offset:0
  ds_read_b64_tr_b16 a[162:163], v15 offset:512
  ds_read_b64_tr_b16 a[164:165], v15 offset:2048
  ds_read_b64_tr_b16 a[166:167], v15 offset:2560
  v_readlane_b32 s83, v21, 15
  v_mfma_f32_32x32x16_bf16 a[144:159], a[172:175], v[104:107], a[144:159]
  s_mul_i32 s84, s35, 1728
  s_add_u32 m0, s3, 24576
  s_add_u32 s84, s84, s94
  ds_read_b64_tr_b16 a[168:169], v16 offset:0
  ds_read_b64_tr_b16 a[170:171], v16 offset:512
  buffer_load_dwordx4 v3, s[16:19], s84 offen offset:0  lds
  v_mfma_f32_32x32x16_bf16 a[96:111], a[176:179], v[108:111], a[96:111]
  ds_read_b64_tr_b16 a[172:173], v16 offset:2048
  ds_read_b64_tr_b16 a[174:175], v16 offset:2560
  ds_read_b64 v[96:97], v43 offset:0
  ds_read_b64 v[98:99], v43 offset:512
  ds_read_b64 v[100:101], v43 offset:1024
  ds_read_b64 v[102:103], v43 offset:1536
  ds_read_b64 v[104:105], v43 offset:2048
  ds_read_b64 v[38:39], v43 offset:2560
  ds_read_b64 v[40:41], v43 offset:3072
  buffer_load_dwordx4 a[244:247], v20, s[24:27], s83 offen offset:0 sc0 sc1
  v_mfma_f32_32x32x16_bf16 a[112:127], a[180:183], v[108:111], a[112:127]
  ds_read_b64_tr_b16 a[176:177], v15 offset:4096
  ds_read_b64_tr_b16 a[178:179], v15 offset:4608
  ds_read_b64 v[88:89], v43 offset:3584
  v_mfma_f32_32x32x16_bf16 a[128:143], a[184:187], v[108:111], a[128:143]
  ds_read_b64_tr_b16 a[180:181], v15 offset:6144
  ds_read_b64_tr_b16 a[182:183], v15 offset:6656
  s_waitcnt lgkmcnt(15)
  buffer_load_dwordx4 v4, s[16:19], s84 offen offset:1024  lds
  v_mfma_f32_32x32x16_bf16 a[144:159], a[188:191], v[108:111], a[144:159]
  ds_read_b64_tr_b16 a[184:185], v16 offset:4096
  ds_read_b64_tr_b16 a[186:187], v16 offset:4608
  s_waitcnt lgkmcnt(4)
  v_fmac_f32_e32 v98, v30, v96
  v_fmac_f32_e64 v99, v30, v97
  v_fma_f32 v98, -v31, v97, v98
  v_fmac_f32_e32 v99, v31, v96
  v_fmac_f32_e32 v100, v30, v98
  v_fmac_f32_e64 v101, v30, v99
  v_mfma_f32_32x32x16_bf16 a[96:111], a[160:163], v[112:115], a[96:111]
  ds_read_b64_tr_b16 a[188:189], v16 offset:6144
  ds_read_b64_tr_b16 a[190:191], v16 offset:6656
  buffer_load_dwordx4 a[248:251], v20, s[24:27], s83 offen offset:1024 sc0 sc1
  v_fma_f32 v100, -v31, v99, v100
  v_fmac_f32_e32 v101, v31, v98
  v_fmac_f32_e32 v102, v30, v100
  v_fmac_f32_e64 v103, v30, v101
  v_fma_f32 v102, -v31, v101, v102
  v_fmac_f32_e32 v103, v31, v100
  v_fmac_f32_e32 v104, v30, v102
  v_mfma_f32_32x32x16_bf16 a[112:127], a[164:167], v[112:115], a[112:127]
  ds_read_b64_tr_b16 a[160:161], v15 offset:8192
  ds_read_b64_tr_b16 a[162:163], v15 offset:8704
  buffer_load_dwordx4 v3, s[20:23], s84 offen offset:2048  lds
  v_fmac_f32_e64 v105, v30, v103
  v_fma_f32 v104, -v31, v103, v104
  v_fmac_f32_e32 v105, v31, v102
  v_fmac_f32_e32 v38, v30, v104
  v_mfma_f32_32x32x16_bf16 a[128:143], a[168:171], v[112:115], a[128:143]
  ds_read_b64_tr_b16 a[164:165], v15 offset:10240
  ds_read_b64_tr_b16 a[166:167], v15 offset:10752
  v_fmac_f32_e64 v39, v30, v105
  v_fma_f32 v38, -v31, v105, v38
  v_fmac_f32_e32 v39, v31, v104
  v_fmac_f32_e32 v40, v30, v38
  v_fmac_f32_e64 v41, v30, v39
  v_fma_f32 v40, -v31, v39, v40
  v_fmac_f32_e64 v41, v31, v38
  v_mfma_f32_32x32x16_bf16 a[144:159], a[172:175], v[112:115], a[144:159]
  ds_read_b64_tr_b16 a[168:169], v16 offset:8192
  ds_read_b64_tr_b16 a[170:171], v16 offset:8704
  buffer_load_dwordx4 a[252:255], v20, s[24:27], s83 offen offset:2048 sc0 sc1
  v_fmac_f32_e32 v88, v30, v40
  v_fmac_f32_e32 v89, v30, v41
  v_fma_f32 v88, -v31, v41, v88
  v_fmac_f32_e32 v89, v31, v40
  v_mov_b32_e32 v90, v89
  v_mov_b32_e32 v89, s32
  v_mov_b32_e32 v91, s32
  v_mfma_f32_32x32x16_bf16 a[96:111], a[176:179], v[116:119], a[96:111]
  ds_read_b64_tr_b16 a[172:173], v16 offset:10240
  ds_read_b64_tr_b16 a[174:175], v16 offset:10752
  s_waitcnt lgkmcnt(8)
  s_cmp_eq_u32 s28, 3
  s_cselect_b32 s85, 0, 0x10000000
  s_mov_b32 exec_hi, 0
  buffer_store_dwordx4 v[88:91], v46, s[36:39], s85 offen sc0 sc1
  s_mov_b32 exec_hi, -1
  v_readlane_b32 s96, v21, 17
  v_mfma_f32_32x32x16_bf16 a[112:127], a[180:183], v[116:119], a[112:127]
  ds_read_b64_tr_b16 a[176:177], v15 offset:12288
  ds_read_b64_tr_b16 a[178:179], v15 offset:12800
  buffer_load_dwordx4 v4, s[20:23], s84 offen offset:3072  lds
  s_addk_i32 s35, 128
  s_cmpk_eq_u32 s35, 1280
  s_cselect_b32 s35, 0, s35
  v_mfma_f32_32x32x16_bf16 a[128:143], a[184:187], v[116:119], a[128:143]
  ds_read_b64_tr_b16 a[180:181], v15 offset:14336
  ds_read_b64_tr_b16 a[182:183], v15 offset:14848
  s_add_u32 s85, s91, 0
  buffer_load_dwordx4 a[0:3], v20, s[24:27], s96 offen offset:1024 sc0 sc1
  v_max_f32_e32 v104, 0, v192
  v_max_f32_e32 v105, 0, v193
  v_mul_f32_e64 v104, v104, v208
  v_mfma_f32_32x32x16_bf16 a[144:159], a[188:191], v[116:119], a[144:159]
  ds_read_b64_tr_b16 a[184:185], v16 offset:12288
  ds_read_b64_tr_b16 a[186:187], v16 offset:12800
  s_waitcnt lgkmcnt(8)
  v_mul_f32_e32 v105, v105, v209
  v_cvt_pk_bf16_f32 v96, v104, v105
  v_max_f32_e64 v108, 0, v194
  v_mfma_f32_32x32x16_bf16 a[96:111], a[160:163], v[120:123], a[96:111]
  ds_read_b64_tr_b16 a[188:189], v16 offset:14336
  ds_read_b64_tr_b16 a[190:191], v16 offset:14848
  buffer_load_dwordx4 a[4:7], v20, s[24:27], s96 offen offset:2048 sc0 sc1
  v_max_f32_e32 v109, 0, v195
  v_mul_f32_e32 v108, v108, v210
  v_mul_f32_e64 v109, v109, v211
  v_cvt_pk_bf16_f32 v97, v108, v109
  v_mfma_f32_32x32x16_bf16 a[112:127], a[164:167], v[120:123], a[112:127]
  v_max_f32_e32 v104, 0, v196
  v_max_f32_e32 v105, 0, v197
  v_mul_f32_e32 v104, v104, v212
  v_mul_f32_e32 v105, v105, v213
  v_cvt_pk_bf16_f32 v98, v104, v105
  v_max_f32_e64 v108, 0, v198
  v_mfma_f32_32x32x16_bf16 a[128:143], a[168:171], v[120:123], a[128:143]
  s_waitcnt vmcnt(20) lgkmcnt(0)
  s_barrier
  ds_read_b64_tr_b16 a[160:161], v15 offset:16384
  ds_read_b64_tr_b16 a[162:163], v15 offset:16896
  ds_read_b64_tr_b16 a[164:165], v15 offset:18432
  ds_read_b64_tr_b16 a[166:167], v15 offset:18944
  v_mfma_f32_32x32x16_bf16 a[144:159], a[172:175], v[120:123], a[144:159]
  s_mul_i32 s84, s35, 1728
  s_add_u32 m0, s3, 40960
  s_add_u32 s84, s84, s94
  ds_read_b64_tr_b16 a[168:169], v16 offset:16384
  ds_read_b64_tr_b16 a[170:171], v16 offset:16896
  buffer_load_dwordx4 v3, s[16:19], s84 offen offset:0  lds
  v_mfma_f32_32x32x16_bf16 a[96:111], a[176:179], v[124:127], a[96:111]
  ds_read_b64_tr_b16 a[172:173], v16 offset:18432
  ds_read_b64_tr_b16 a[174:175], v16 offset:18944
  buffer_load_dwordx4 a[8:11], v20, s[24:27], s96 offen offset:3072 sc0 sc1
  v_max_f32_e32 v109, 0, v199
  v_mul_f32_e32 v108, v108, v214
  v_mul_f32_e32 v109, v109, v215
  v_cvt_pk_bf16_f32 v99, v108, v109
  v_mfma_f32_32x32x16_bf16 a[112:127], a[180:183], v[124:127], a[112:127]
  ds_read_b64_tr_b16 a[176:177], v15 offset:20480
  ds_read_b64_tr_b16 a[178:179], v15 offset:20992
  s_waitcnt lgkmcnt(8)
  buffer_store_dwordx4 v[96:99], v19, s[24:27], s85 offen offset:0 sc0 sc1
  v_max_f32_e32 v104, 0, v200
  v_max_f32_e64 v105, 0, v201
  v_mfma_f32_32x32x16_bf16 a[128:143], a[184:187], v[124:127], a[128:143]
  ds_read_b64_tr_b16 a[180:181], v15 offset:22528
  ds_read_b64_tr_b16 a[182:183], v15 offset:23040
  buffer_load_dwordx4 v4, s[16:19], s84 offen offset:1024  lds
  v_mul_f32_e32 v104, v104, v216
  v_mul_f32_e32 v105, v105, v217
  v_mfma_f32_32x32x16_bf16 a[144:159], a[188:191], v[124:127], a[144:159]
  ds_read_b64_tr_b16 a[184:185], v16 offset:20480
  ds_read_b64_tr_b16 a[186:187], v16 offset:20992
  v_cvt_pk_bf16_f32 v100, v104, v105
  v_max_f32_e32 v108, 0, v202
  v_max_f32_e32 v109, 0, v203
  v_mul_f32_e64 v108, v108, v218
  v_mfma_f32_32x32x16_bf16 a[96:111], a[160:163], v[128:131], a[96:111]
  ds_read_b64_tr_b16 a[188:189], v16 offset:22528
  ds_read_b64_tr_b16 a[190:191], v16 offset:23040
  s_waitcnt lgkmcnt(8)
  buffer_load_dwordx4 a[12:15], v94, s[24:27], s96 offen offset:0 sc0 sc1
  v_mul_f32_e32 v109, v109, v219
  v_cvt_pk_bf16_f32 v101, v108, v109
  v_max_f32_e64 v104, 0, v204
  v_mfma_f32_32x32x16_bf16 a[112:127], a[164:167], v[128:131], a[112:127]
  ds_read_b64_tr_b16 a[160:161], v15 offset:24576
  ds_read_b64_tr_b16 a[162:163], v15 offset:25088
  buffer_load_dwordx4 v3, s[20:23], s84 offen offset:2048  lds
  v_max_f32_e32 v105, 0, v205
  v_mul_f32_e32 v104, v104, v220
  v_readlane_b32 s82, v21, 18
  v_mfma_f32_32x32x16_bf16 a[128:143], a[168:171], v[128:131], a[128:143]
  ds_read_b64_tr_b16 a[164:165], v15 offset:26624
  ds_read_b64_tr_b16 a[166:167], v15 offset:27136
  v_mul_f32_e64 v105, v105, v221
  v_cvt_pk_bf16_f32 v102, v104, v105
  v_max_f32_e32 v108, 0, v206
  v_max_f32_e32 v109, 0, v207
  v_mfma_f32_32x32x16_bf16 a[144:159], a[172:175], v[128:131], a[144:159]
  ds_read_b64_tr_b16 a[168:169], v16 offset:24576
  ds_read_b64_tr_b16 a[170:171], v16 offset:25088
  s_waitcnt lgkmcnt(8)
  buffer_load_dwordx4 a[16:19], v20, s[24:27], s82 offen offset:0 sc0 sc1
  v_mul_f32_e32 v108, v108, v222
  v_mul_f32_e64 v109, v109, v223
  v_cvt_pk_bf16_f32 v103, v108, v109
  v_mfma_f32_32x32x16_bf16 a[96:111], a[176:179], v[132:135], a[96:111]
  ds_read_b64_tr_b16 a[172:173], v16 offset:26624
  ds_read_b64_tr_b16 a[174:175], v16 offset:27136
  buffer_store_dwordx4 v[100:103], v19, s[24:27], s85 offen offset:512 sc0 sc1
  v_mfma_f32_32x32x16_bf16 a[112:127], a[180:183], v[132:135], a[112:127]
  ds_read_b64_tr_b16 a[176:177], v15 offset:28672
  ds_read_b64_tr_b16 a[178:179], v15 offset:29184
  buffer_load_dwordx4 v4, s[20:23], s84 offen offset:3072  lds
  s_addk_i32 s35, 128
  s_cmpk_eq_u32 s35, 1280
  s_cselect_b32 s35, 0, s35
  v_mfma_f32_32x32x16_bf16 a[128:143], a[184:187], v[132:135], a[128:143]
  ds_read_b64_tr_b16 a[180:181], v15 offset:30720
  ds_read_b64_tr_b16 a[182:183], v15 offset:31232
  s_waitcnt lgkmcnt(8)
  s_add_u32 s85, s91, 4096
  buffer_load_dwordx4 a[20:23], v20, s[24:27], s82 offen offset:1024 sc0 sc1
  v_max_f32_e32 v104, 0, v224
  v_max_f32_e32 v105, 0, v225
  v_mfma_f32_32x32x16_bf16 a[144:159], a[188:191], v[132:135], a[144:159]
  ds_read_b64_tr_b16 a[184:185], v16 offset:28672
  ds_read_b64_tr_b16 a[186:187], v16 offset:29184
  v_mul_f32_e32 v104, v104, v240
  v_mul_f32_e32 v105, v105, v241
  v_cvt_pk_bf16_f32 v96, v104, v105
  v_max_f32_e64 v108, 0, v226
  v_mfma_f32_32x32x16_bf16 a[96:111], a[160:163], v[136:139], a[96:111]
  ds_read_b64_tr_b16 a[188:189], v16 offset:30720
  ds_read_b64_tr_b16 a[190:191], v16 offset:31232
  buffer_load_dwordx4 a[24:27], v20, s[24:27], s82 offen offset:2048 sc0 sc1
  v_max_f32_e32 v109, 0, v227
  v_mul_f32_e32 v108, v108, v242
  v_mul_f32_e64 v109, v109, v243
  v_cvt_pk_bf16_f32 v97, v108, v109
  v_mfma_f32_32x32x16_bf16 a[112:127], a[164:167], v[136:139], a[112:127]
  s_waitcnt lgkmcnt(6)
  v_max_f32_e32 v104, 0, v228
  v_max_f32_e32 v105, 0, v229
  v_mul_f32_e32 v104, v104, v244
  v_mul_f32_e64 v105, v105, v245
  v_cvt_pk_bf16_f32 v98, v104, v105
  v_mfma_f32_32x32x16_bf16 a[128:143], a[168:171], v[136:139], a[128:143]
  s_waitcnt vmcnt(23) lgkmcnt(0)
  s_barrier
  ds_read_b64_tr_b16 a[160:161], v13 offset:0
  ds_read_b64_tr_b16 a[162:163], v13 offset:512
  ds_read_b64_tr_b16 a[164:165], v13 offset:2048
  ds_read_b64_tr_b16 a[166:167], v13 offset:2560
  v_mfma_f32_32x32x16_bf16 a[144:159], a[172:175], v[136:139], a[144:159]
  s_mul_i32 s84, s35, 1728
  s_add_u32 m0, s3, 57344
  s_add_u32 s84, s84, s94
  ds_read_b64_tr_b16 a[168:169], v14 offset:0
  ds_read_b64_tr_b16 a[170:171], v14 offset:512
  buffer_load_dwordx4 v3, s[16:19], s84 offen offset:0  lds
  v_mfma_f32_32x32x16_bf16 a[96:111], a[176:179], v[140:143], a[96:111]
  ds_read_b64_tr_b16 a[172:173], v14 offset:2048
  ds_read_b64_tr_b16 a[174:175], v14 offset:2560
  buffer_load_dwordx4 a[28:31], v20, s[24:27], s82 offen offset:3072 sc0 sc1
  v_max_f32_e32 v108, 0, v230
  v_max_f32_e32 v109, 0, v231
  v_mul_f32_e32 v108, v108, v246
  v_mfma_f32_32x32x16_bf16 a[112:127], a[180:183], v[140:143], a[112:127]
  ds_read_b64_tr_b16 a[176:177], v13 offset:4096
  ds_read_b64_tr_b16 a[178:179], v13 offset:4608
  v_mul_f32_e64 v109, v109, v247
  v_cvt_pk_bf16_f32 v99, v108, v109
  v_mfma_f32_32x32x16_bf16 a[128:143], a[184:187], v[140:143], a[128:143]
  ds_read_b64_tr_b16 a[180:181], v13 offset:6144
  ds_read_b64_tr_b16 a[182:183], v13 offset:6656
  buffer_load_dwordx4 v4, s[16:19], s84 offen offset:1024  lds
  buffer_store_dwordx4 v[96:99], v19, s[24:27], s85 offen offset:0 sc0 sc1
  v_max_f32_e64 v104, 0, v232
  v_readlane_b32 s83, v21, 9
  v_mfma_f32_32x32x16_bf16 a[144:159], a[188:191], v[140:143], a[144:159]
  ds_read_b64_tr_b16 a[184:185], v14 offset:4096
  ds_read_b64_tr_b16 a[186:187], v14 offset:4608
  s_waitcnt lgkmcnt(8)
  v_max_f32_e32 v105, 0, v233
  v_mul_f32_e32 v104, v104, v248
  v_mul_f32_e32 v105, v105, v249
  v_mfma_f32_32x32x16_bf16 a[96:111], a[160:163], v[144:147], a[96:111]
  ds_read_b64_tr_b16 a[188:189], v14 offset:6144
  ds_read_b64_tr_b16 a[190:191], v14 offset:6656
  buffer_load_dwordx4 v[192:195], v20, s[24:27], s83 offen offset:1024 sc0 sc1
  v_cvt_pk_bf16_f32 v100, v104, v105
  v_max_f32_e32 v108, 0, v234
  v_max_f32_e32 v109, 0, v235
  v_mul_f32_e64 v108, v108, v250
  v_mfma_f32_32x32x16_bf16 a[112:127], a[164:167], v[144:147], a[112:127]
  ds_read_b64_tr_b16 a[160:161], v13 offset:8192
  ds_read_b64_tr_b16 a[162:163], v13 offset:8704
  buffer_load_dwordx4 v3, s[20:23], s84 offen offset:2048  lds
  v_mul_f32_e64 v109, v109, v251
  v_cvt_pk_bf16_f32 v101, v108, v109
  v_mfma_f32_32x32x16_bf16 a[128:143], a[168:171], v[144:147], a[128:143]
  ds_read_b64_tr_b16 a[164:165], v13 offset:10240
  ds_read_b64_tr_b16 a[166:167], v13 offset:10752
  s_waitcnt lgkmcnt(8)
  v_max_f32_e32 v104, 0, v236
  v_max_f32_e32 v105, 0, v237
  v_mul_f32_e32 v104, v104, v252
  v_mfma_f32_32x32x16_bf16 a[144:159], a[172:175], v[144:147], a[144:159]
  ds_read_b64_tr_b16 a[168:169], v14 offset:8192
  ds_read_b64_tr_b16 a[170:171], v14 offset:8704
  buffer_load_dwordx4 v[196:199], v20, s[24:27], s83 offen offset:2048 sc0 sc1
  v_mul_f32_e64 v105, v105, v253
  v_cvt_pk_bf16_f32 v102, v104, v105
  v_max_f32_e32 v108, 0, v238
  v_max_f32_e32 v109, 0, v239
  v_mfma_f32_32x32x16_bf16 a[96:111], a[176:179], v[148:151], a[96:111]
  ds_read_b64_tr_b16 a[172:173], v14 offset:10240
  ds_read_b64_tr_b16 a[174:175], v14 offset:10752
  v_mul_f32_e32 v108, v108, v254
  v_mul_f32_e32 v109, v109, v255
  v_cvt_pk_bf16_f32 v103, v108, v109
  v_mfma_f32_32x32x16_bf16 a[112:127], a[180:183], v[148:151], a[112:127]
  ds_read_b64_tr_b16 a[176:177], v13 offset:12288
  ds_read_b64_tr_b16 a[178:179], v13 offset:12800
  s_waitcnt lgkmcnt(8)
  buffer_load_dwordx4 v4, s[20:23], s84 offen offset:3072  lds
  s_addk_i32 s35, 128
  s_cmpk_eq_u32 s35, 1280
  s_cselect_b32 s35, 0, s35
  v_mfma_f32_32x32x16_bf16 a[128:143], a[184:187], v[148:151], a[128:143]
  ds_read_b64_tr_b16 a[180:181], v13 offset:14336
  ds_read_b64_tr_b16 a[182:183], v13 offset:14848
  buffer_store_dwordx4 v[100:103], v19, s[24:27], s85 offen offset:512 sc0 sc1
  v_mfma_f32_32x32x16_bf16 a[144:159], a[188:191], v[148:151], a[144:159]
  ds_read_b64_tr_b16 a[184:185], v14 offset:12288
  ds_read_b64_tr_b16 a[186:187], v14 offset:12800
  buffer_load_dwordx4 v[200:203], v20, s[24:27], s83 offen offset:3072 sc0 sc1
  v_mfma_f32_32x32x16_bf16 a[96:111], a[160:163], v[152:155], a[96:111]
  ds_read_b64_tr_b16 a[188:189], v14 offset:14336
  ds_read_b64_tr_b16 a[190:191], v14 offset:14848
  s_waitcnt lgkmcnt(8)
  buffer_load_dwordx4 v[204:207], v94, s[24:27], s83 offen offset:0 sc0 sc1
  v_mfma_f32_32x32x16_bf16 a[112:127], a[164:167], v[152:155], a[112:127]
  s_movk_i32 s87, 1024
  buffer_load_dwordx4 v[124:127], v46, s[36:39], s87 offen offset:0 sc0 sc1
  v_mfma_f32_32x32x16_bf16 a[128:143], a[168:171], v[152:155], a[128:143]
  s_waitcnt vmcnt(25) lgkmcnt(0)
  s_barrier
  ds_read_b64_tr_b16 a[160:161], v13 offset:24576
  ds_read_b64_tr_b16 a[162:163], v13 offset:25088
  ds_read_b64_tr_b16 a[164:165], v13 offset:26624
  ds_read_b64_tr_b16 a[166:167], v13 offset:27136
  v_readlane_b32 s96, v21, 10
  v_mfma_f32_32x32x16_bf16 a[144:159], a[172:175], v[152:155], a[144:159]
  s_mul_i32 s84, s35, 1728
  s_add_u32 m0, s3, 0
  s_add_u32 s84, s84, s94
  ds_read_b64_tr_b16 a[168:169], v14 offset:24576
  ds_read_b64_tr_b16 a[170:171], v14 offset:25088
  buffer_load_dwordx4 v3, s[16:19], s84 offen offset:0  lds
  buffer_load_dwordx4 v[120:123], v46, s[36:39], s87 offen offset:1024 sc0 sc1
  v_mfma_f32_32x32x16_bf16 a[96:111], a[176:179], v[156:159], a[96:111]
  ds_read_b64_tr_b16 a[172:173], v14 offset:26624
  ds_read_b64_tr_b16 a[174:175], v14 offset:27136
  buffer_load_dwordx4 v[208:211], v20, s[24:27], s96 offen offset:0 sc0 sc1
  v_mfma_f32_32x32x16_bf16 a[112:127], a[180:183], v[156:159], a[112:127]
  ds_read_b64_tr_b16 a[176:177], v13 offset:28672
  ds_read_b64_tr_b16 a[178:179], v13 offset:29184
  buffer_load_dwordx4 v[116:119], v46, s[36:39], s87 offen offset:2048 sc0 sc1
  v_mfma_f32_32x32x16_bf16 a[128:143], a[184:187], v[156:159], a[128:143]
  ds_read_b64_tr_b16 a[180:181], v13 offset:30720
  ds_read_b64_tr_b16 a[182:183], v13 offset:31232
  s_waitcnt lgkmcnt(8)
  buffer_load_dwordx4 v4, s[16:19], s84 offen offset:1024  lds
  v_mfma_f32_32x32x16_bf16 a[144:159], a[188:191], v[156:159], a[144:159]
  ds_read_b64_tr_b16 a[184:185], v14 offset:28672
  ds_read_b64_tr_b16 a[186:187], v14 offset:29184
  buffer_load_dwordx4 v[112:115], v46, s[36:39], s87 offen offset:3072 sc0 sc1
  v_mfma_f32_32x32x16_bf16 a[96:111], a[160:163], v[160:163], a[96:111]
  ds_read_b64_tr_b16 a[188:189], v14 offset:30720
  ds_read_b64_tr_b16 a[190:191], v14 offset:31232
  buffer_load_dwordx4 v[212:215], v20, s[24:27], s96 offen offset:1024 sc0 sc1
  v_mfma_f32_32x32x16_bf16 a[112:127], a[164:167], v[160:163], a[112:127]
  ds_read_b64_tr_b16 a[160:161], v13 offset:32768
  ds_read_b64_tr_b16 a[162:163], v13 offset:33280
  s_waitcnt lgkmcnt(8)
  buffer_load_dwordx4 v3, s[20:23], s84 offen offset:2048  lds
  s_movk_i32 s87, 5120
  buffer_load_dwordx4 v[108:111], v46, s[36:39], s87 offen offset:0 sc0 sc1
  v_mfma_f32_32x32x16_bf16 a[128:143], a[168:171], v[160:163], a[128:143]
  ds_read_b64_tr_b16 a[164:165], v13 offset:34816
  ds_read_b64_tr_b16 a[166:167], v13 offset:35328
  v_mfma_f32_32x32x16_bf16 a[144:159], a[172:175], v[160:163], a[144:159]
  ds_read_b64_tr_b16 a[168:169], v14 offset:32768
  ds_read_b64_tr_b16 a[170:171], v14 offset:33280
  buffer_load_dwordx4 v[104:107], v46, s[36:39], s87 offen offset:1024 sc0 sc1
  v_mfma_f32_32x32x16_bf16 a[96:111], a[176:179], v[164:167], a[96:111]
  ds_read_b64_tr_b16 a[172:173], v14 offset:34816
  ds_read_b64_tr_b16 a[174:175], v14 offset:35328
  s_waitcnt lgkmcnt(8)
  buffer_load_dwordx4 v[216:219], v20, s[24:27], s96 offen offset:2048 sc0 sc1
  v_mfma_f32_32x32x16_bf16 a[112:127], a[180:183], v[164:167], a[112:127]
  ds_read_b64_tr_b16 a[176:177], v13 offset:36864
  ds_read_b64_tr_b16 a[178:179], v13 offset:37376
  buffer_load_dwordx4 v4, s[20:23], s84 offen offset:3072  lds
  s_addk_i32 s35, 128
  s_cmpk_eq_u32 s35, 1280
  s_cselect_b32 s35, 0, s35
  buffer_load_dwordx4 v[100:103], v46, s[36:39], s87 offen offset:2048 sc0 sc1
  v_mfma_f32_32x32x16_bf16 a[128:143], a[184:187], v[164:167], a[128:143]
  ds_read_b64_tr_b16 a[180:181], v13 offset:38912
  ds_read_b64_tr_b16 a[182:183], v13 offset:39424
  buffer_load_dwordx4 v[220:223], v20, s[24:27], s96 offen offset:3072 sc0 sc1
  v_mfma_f32_32x32x16_bf16 a[144:159], a[188:191], v[164:167], a[144:159]
  ds_read_b64_tr_b16 a[184:185], v14 offset:36864
  ds_read_b64_tr_b16 a[186:187], v14 offset:37376
  s_waitcnt lgkmcnt(8)
  buffer_load_dwordx4 v[96:99], v46, s[36:39], s87 offen offset:3072 sc0 sc1
  v_mfma_f32_32x32x16_bf16 a[96:111], a[160:163], v[168:171], a[96:111]
  ds_read_b64_tr_b16 a[188:189], v14 offset:38912
  ds_read_b64_tr_b16 a[190:191], v14 offset:39424
  buffer_load_dwordx4 v[224:227], v94, s[24:27], s96 offen offset:0 sc0 sc1
  v_mfma_f32_32x32x16_bf16 a[112:127], a[164:167], v[168:171], a[112:127]
  v_mfma_f32_32x32x16_bf16 a[128:143], a[168:171], v[168:171], a[128:143]
  s_waitcnt vmcnt(30) lgkmcnt(0)
  s_barrier
  ds_read_b64_tr_b16 a[160:161], v15 offset:0
  ds_read_b64_tr_b16 a[162:163], v15 offset:512
  ds_read_b64_tr_b16 a[164:165], v15 offset:2048
  ds_read_b64_tr_b16 a[166:167], v15 offset:2560
  v_readlane_b32 s82, v21, 11
  v_mfma_f32_32x32x16_bf16 a[144:159], a[172:175], v[168:171], a[144:159]
  s_mul_i32 s84, s35, 1728
  s_add_u32 m0, s3, 24576
  s_add_u32 s84, s84, s94
  ds_read_b64_tr_b16 a[168:169], v16 offset:0
  ds_read_b64_tr_b16 a[170:171], v16 offset:512
  buffer_load_dwordx4 v3, s[16:19], s84 offen offset:0  lds
  v_mfma_f32_32x32x16_bf16 a[96:111], a[176:179], v[172:175], a[96:111]
  ds_read_b64_tr_b16 a[172:173], v16 offset:2048
  ds_read_b64_tr_b16 a[174:175], v16 offset:2560
  buffer_load_dwordx4 v[228:231], v20, s[24:27], s82 offen offset:0 sc0 sc1
  v_mfma_f32_32x32x16_bf16 a[112:127], a[180:183], v[172:175], a[112:127]
  ds_read_b64_tr_b16 a[176:177], v15 offset:4096
  ds_read_b64_tr_b16 a[178:179], v15 offset:4608
  s_waitcnt lgkmcnt(8)
  v_mfma_f32_32x32x16_bf16 a[128:143], a[184:187], v[172:175], a[128:143]
  ds_read_b64_tr_b16 a[180:181], v15 offset:6144
  ds_read_b64_tr_b16 a[182:183], v15 offset:6656
  buffer_load_dwordx4 v4, s[16:19], s84 offen offset:1024  lds
  v_mfma_f32_32x32x16_bf16 a[144:159], a[188:191], v[172:175], a[144:159]
  ds_read_b64_tr_b16 a[184:185], v16 offset:4096
  ds_read_b64_tr_b16 a[186:187], v16 offset:4608
  v_mfma_f32_32x32x16_bf16 a[96:111], a[160:163], v[176:179], a[96:111]
  ds_read_b64_tr_b16 a[188:189], v16 offset:6144
  ds_read_b64_tr_b16 a[190:191], v16 offset:6656
  s_waitcnt lgkmcnt(8)
  buffer_load_dwordx4 v[232:235], v20, s[24:27], s82 offen offset:1024 sc0 sc1
  v_mfma_f32_32x32x16_bf16 a[112:127], a[164:167], v[176:179], a[112:127]
  ds_read_b64_tr_b16 a[160:161], v15 offset:8192
  ds_read_b64_tr_b16 a[162:163], v15 offset:8704
  buffer_load_dwordx4 v3, s[20:23], s84 offen offset:2048  lds
  v_mfma_f32_32x32x16_bf16 a[128:143], a[168:171], v[176:179], a[128:143]
  ds_read_b64_tr_b16 a[164:165], v15 offset:10240
  ds_read_b64_tr_b16 a[166:167], v15 offset:10752
  v_mfma_f32_32x32x16_bf16 a[144:159], a[172:175], v[176:179], a[144:159]
  ds_read_b64_tr_b16 a[168:169], v16 offset:8192
  ds_read_b64_tr_b16 a[170:171], v16 offset:8704
  s_waitcnt lgkmcnt(8)
  buffer_load_dwordx4 v[236:239], v20, s[24:27], s82 offen offset:2048 sc0 sc1
  v_mfma_f32_32x32x16_bf16 a[96:111], a[176:179], v[180:183], a[96:111]
  ds_read_b64_tr_b16 a[172:173], v16 offset:10240
  ds_read_b64_tr_b16 a[174:175], v16 offset:10752
  v_mfma_f32_32x32x16_bf16 a[112:127], a[180:183], v[180:183], a[112:127]
  ds_read_b64_tr_b16 a[176:177], v15 offset:12288
  ds_read_b64_tr_b16 a[178:179], v15 offset:12800
  buffer_load_dwordx4 v4, s[20:23], s84 offen offset:3072  lds
  s_addk_i32 s35, 128
  s_cmpk_eq_u32 s35, 1280
  s_cselect_b32 s35, 0, s35
  v_mfma_f32_32x32x16_bf16 a[128:143], a[184:187], v[180:183], a[128:143]
  ds_read_b64_tr_b16 a[180:181], v15 offset:14336
  ds_read_b64_tr_b16 a[182:183], v15 offset:14848
  s_waitcnt vmcnt(8) lgkmcnt(8)
  buffer_load_dwordx4 v[240:243], v20, s[24:27], s82 offen offset:3072 sc0 sc1
  v_mov_b32_e64 v48, v28
  v_bitop3_b32 v97, v97, v99, s32 bitop3:0x7e
  v_min_u32_e64 v97, 1, v97
  v_bitop3_b32 v101, v101, v103, s32 bitop3:0x7e
  v_min_u32_e64 v101, 1, v101
  v_mfma_f32_32x32x16_bf16 a[144:159], a[188:191], v[180:183], a[144:159]
  ds_read_b64_tr_b16 a[184:185], v16 offset:12288
  ds_read_b64_tr_b16 a[186:187], v16 offset:12800
  v_add3_u32 v48, v48, v101, v97
  v_bitop3_b32 v105, v105, v107, s32 bitop3:0x7e
  v_min_u32_e64 v105, 1, v105
  v_bitop3_b32 v109, v109, v111, s32 bitop3:0x7e
  v_min_u32_e64 v109, 1, v109
  v_add3_u32 v48, v48, v109, v105
  v_bitop3_b32 v113, v113, v115, s32 bitop3:0x7e
  v_mfma_f32_32x32x16_bf16 a[96:111], a[160:163], v[184:187], a[96:111]
  ds_read_b64_tr_b16 a[188:189], v16 offset:14336
  ds_read_b64_tr_b16 a[190:191], v16 offset:14848
  buffer_load_dwordx4 v[244:247], v94, s[24:27], s82 offen offset:0 sc0 sc1
  v_min_u32_e64 v113, 1, v113
  v_bitop3_b32 v117, v117, v119, s32 bitop3:0x7e
  v_min_u32_e64 v117, 1, v117
  v_add3_u32 v48, v48, v117, v113
  v_bitop3_b32 v121, v121, v123, s32 bitop3:0x7e
  v_min_u32_e64 v121, 1, v121
  v_bitop3_b32 v125, v125, v127, s32 bitop3:0x7e
  v_mfma_f32_32x32x16_bf16 a[112:127], a[164:167], v[184:187], a[112:127]
  s_waitcnt lgkmcnt(6)
  v_min_u32_e32 v125, 1, v125
  v_add3_u32 v48, v48, v125, v121
  v_cmp_ne_u32 vcc, 8, v48
  v_mfma_f32_32x32x16_bf16 a[128:143], a[168:171], v[184:187], a[128:143]
  s_waitcnt lgkmcnt(0)
  s_barrier
  ds_read_b64_tr_b16 a[160:161], v15 offset:16384
  ds_read_b64_tr_b16 a[162:163], v15 offset:16896
  ds_read_b64_tr_b16 a[164:165], v15 offset:18432
  ds_read_b64_tr_b16 a[166:167], v15 offset:18944
  s_cbranch_vccnz L_gr1
L_grr1:
  v_readlane_b32 s83, v21, 12
  v_mfma_f32_32x32x16_bf16 a[144:159], a[172:175], v[184:187], a[144:159]
  s_mul_i32 s84, s35, 1728
  s_add_u32 m0, s3, 40960
  s_add_u32 s84, s84, s94
  ds_read_b64_tr_b16 a[168:169], v16 offset:16384
  ds_read_b64_tr_b16 a[170:171], v16 offset:16896
  buffer_load_dwordx4 v3, s[16:19], s84 offen offset:0  lds
  v_xor_b32_e32 v92, 16, v44
  v_xor_b32_e32 v93, 32, v45
  v_fmac_f32_e32 v100, v32, v96
  v_mfma_f32_32x32x16_bf16 a[96:111], a[176:179], v[188:191], a[96:111]
  ds_read_b64_tr_b16 a[172:173], v16 offset:18432
  ds_read_b64_tr_b16 a[174:175], v16 offset:18944
  buffer_load_dwordx4 v[248:251], v20, s[24:27], s83 offen offset:0 sc0 sc1
  v_fmac_f32_e64 v102, v32, v98
  v_fma_f32 v100, -v33, v98, v100
  v_fmac_f32_e32 v102, v33, v96
  v_fmac_f32_e32 v104, v32, v100
  v_fmac_f32_e64 v106, v32, v102
  v_fma_f32 v104, -v33, v102, v104
  v_mfma_f32_32x32x16_bf16 a[112:127], a[180:183], v[188:191], a[112:127]
  ds_read_b64_tr_b16 a[176:177], v15 offset:20480
  ds_read_b64_tr_b16 a[178:179], v15 offset:20992
  v_fmac_f32_e32 v106, v33, v100
  v_fmac_f32_e32 v108, v32, v104
  v_fmac_f32_e64 v110, v32, v106
  v_fma_f32 v108, -v33, v106, v108
  v_fmac_f32_e32 v110, v33, v104
  v_fmac_f32_e32 v112, v32, v108
  v_fmac_f32_e64 v114, v32, v110
  v_mfma_f32_32x32x16_bf16 a[128:143], a[184:187], v[188:191], a[128:143]
  ds_read_b64_tr_b16 a[180:181], v15 offset:22528
  ds_read_b64_tr_b16 a[182:183], v15 offset:23040
  buffer_load_dwordx4 v4, s[16:19], s84 offen offset:1024  lds
  v_fma_f32 v112, -v33, v110, v112
  v_fmac_f32_e32 v114, v33, v108
  v_fmac_f32_e32 v116, v32, v112
  v_fmac_f32_e64 v118, v32, v114
  v_fma_f32 v116, -v33, v114, v116
  v_mfma_f32_32x32x16_bf16 a[144:159], a[188:191], v[188:191], a[144:159]
  ds_read_b64_tr_b16 a[184:185], v16 offset:20480
  ds_read_b64_tr_b16 a[186:187], v16 offset:20992
  s_waitcnt lgkmcnt(8)
  v_fmac_f32_e32 v118, v33, v112
  v_fmac_f32_e32 v120, v32, v116
  v_fmac_f32_e32 v122, v32, v118
  v_fma_f32 v120, -v33, v118, v120
  v_fmac_f32_e32 v122, v33, v116
  v_fmac_f32_e32 v124, v32, v120
  v_mfma_f32_32x32x16_bf16 a[96:111], a[160:163], a[32:35], a[96:111]
  ds_read_b64_tr_b16 a[188:189], v16 offset:22528
  ds_read_b64_tr_b16 a[190:191], v16 offset:23040
  buffer_load_dwordx4 v[252:255], v20, s[24:27], s83 offen offset:1024 sc0 sc1
  v_fmac_f32_e64 v126, v32, v122
  v_fma_f32 v124, -v33, v122, v124
  v_fmac_f32_e32 v126, v33, v120
  v_mov_b32_e32 v125, v124
  v_mov_b32_e32 v127, v126
  s_nop 0
  v_permlane32_swap_b32 v124, v125
  v_permlane32_swap_b32 v126, v127
  v_mfma_f32_32x32x16_bf16 a[112:127], a[164:167], a[32:35], a[112:127]
  ds_read_b64_tr_b16 a[160:161], v15 offset:24576
  ds_read_b64_tr_b16 a[162:163], v15 offset:25088
  buffer_load_dwordx4 v3, s[20:23], s84 offen offset:2048  lds
  v_fmac_f32_e32 v124, v26, v125
  v_fmac_f32_e32 v126, v26, v127
  v_fma_f32 v124, -v27, v127, v124
  v_fmac_f32_e32 v126, v27, v125
  v_fmac_f32_e32 v38, v34, v124
  v_readlane_b32 s96, v21, 8
  v_mfma_f32_32x32x16_bf16 a[128:143], a[168:171], a[32:35], a[128:143]
  ds_read_b64_tr_b16 a[164:165], v15 offset:26624
  ds_read_b64_tr_b16 a[166:167], v15 offset:27136
  s_waitcnt lgkmcnt(8)
  v_fmac_f32_e32 v39, v34, v126
  v_fma_f32 v38, -v35, v126, v38
  v_fmac_f32_e32 v39, v35, v124
  v_fmac_f32_e32 v40, v36, v124
  v_fmac_f32_e64 v41, v36, v126
  v_fma_f32 v40, -v37, v126, v40
  v_mfma_f32_32x32x16_bf16 a[144:159], a[172:175], a[32:35], a[144:159]
  ds_read_b64_tr_b16 a[168:169], v16 offset:24576
  ds_read_b64_tr_b16 a[170:171], v16 offset:25088
  buffer_load_dwordx4 v[168:171], v20, s[24:27], s96 offen offset:0 sc0 sc1
  v_fmac_f32_e32 v41, v37, v124
  v_permlane32_swap_b32 v38, v40
  s_nop 0
  v_permlane32_swap_b32 v39, v41
  v_mfma_f32_32x32x16_bf16 a[96:111], a[176:179], a[36:39], a[96:111]
  ds_read_b64_tr_b16 a[172:173], v16 offset:26624
  ds_read_b64_tr_b16 a[174:175], v16 offset:27136
  v_fma_f32 v48, v22, v38, v56
  v_fma_f32 v49, v22, v39, v72
  v_fma_f32 v48, -v23, v39, v48
  v_fmac_f32_e32 v49, v23, v38
  v_mul_f32_e32 v52, v24, v48
  v_mul_f32_e64 v54, v24, v49
  v_fma_f32 v52, -v25, v49, v52
  v_mfma_f32_32x32x16_bf16 a[112:127], a[180:183], a[36:39], a[112:127]
  ds_read_b64_tr_b16 a[176:177], v15 offset:28672
  ds_read_b64_tr_b16 a[178:179], v15 offset:29184
  s_waitcnt lgkmcnt(8)
  buffer_load_dwordx4 v4, s[20:23], s84 offen offset:3072  lds
  s_addk_i32 s35, 128
  s_cmpk_eq_u32 s35, 1280
  s_cselect_b32 s35, 0, s35
  v_fma_f32 v54, -v25, v48, -v54
  v_mfma_f32_32x32x16_bf16 a[128:143], a[184:187], a[36:39], a[128:143]
  ds_read_b64_tr_b16 a[180:181], v15 offset:30720
  ds_read_b64_tr_b16 a[182:183], v15 offset:31232
  buffer_load_dwordx4 v[172:175], v20, s[24:27], s96 offen offset:1024 sc0 sc1
  v_fma_f32 v50, v22, v48, v57
  v_fma_f32 v51, v22, v49, v73
  v_fma_f32 v50, -v23, v49, v50
  v_fmac_f32_e32 v51, v23, v48
  v_mul_f32_e32 v53, v24, v50
  v_mul_f32_e64 v55, v24, v51
  v_fma_f32 v53, -v25, v51, v53
  v_mfma_f32_32x32x16_bf16 a[144:159], a[188:191], a[36:39], a[144:159]
  ds_read_b64_tr_b16 a[184:185], v16 offset:28672
  ds_read_b64_tr_b16 a[186:187], v16 offset:29184
  v_fma_f32 v55, -v25, v50, -v55
  v_cvt_pk_bf16_f32 v96, v52, v53
  v_cvt_pk_bf16_f32 v104, v54, v55
  v_fma_f32 v48, v22, v50, v58
  v_fma_f32 v49, v22, v51, v74
  v_fma_f32 v48, -v23, v51, v48
  v_fmac_f32_e64 v49, v23, v50
  v_mfma_f32_32x32x16_bf16 a[96:111], a[160:163], a[40:43], a[96:111]
  ds_read_b64_tr_b16 a[188:189], v16 offset:30720
  ds_read_b64_tr_b16 a[190:191], v16 offset:31232
  s_waitcnt lgkmcnt(8)
  s_mul_i32 s95, s34, 160
  s_mul_i32 s72, s33, 81920
  s_add_u32 s72, s72, s95
  s_lshl_b32 s93, s33, 9
  s_add_u32 s93, s93, 12582912
  buffer_load_dwordx4 v[176:179], v20, s[24:27], s96 offen offset:2048 sc0 sc1
  v_lshrrev_b32_e32 v128, 2, v0
  v_and_b32_e64 v129, 3, v0
  v_mul_u32_u24 v130, 1280, v128
  v_lshl_add_u32 v130, v129, 3, v130
  v_lshlrev_b32_e64 v131, 3, v128
  v_lshl_add_u32 v144, v129, 3, s95
  v_mfma_f32_32x32x16_bf16 a[112:127], a[164:167], a[40:43], a[112:127]
  buffer_load_dwordx2 v[132:133], v131, s[24:27], s93 offen sc0 sc1
  v_mul_f32_e32 v52, v24, v48
  v_mul_f32_e32 v54, v24, v49
  v_fma_f32 v52, -v25, v49, v52
  v_fma_f32 v54, -v25, v48, -v54
  v_fma_f32 v50, v22, v48, v59
  v_fma_f32 v51, v22, v49, v75
  v_fma_f32 v50, -v23, v49, v50
  v_fmac_f32_e64 v51, v23, v48
  v_mfma_f32_32x32x16_bf16 a[128:143], a[168:171], a[40:43], a[128:143]
  s_waitcnt lgkmcnt(0)
  s_barrier
  ds_read_b64_tr_b16 a[160:161], v13 offset:0
  ds_read_b64_tr_b16 a[162:163], v13 offset:512
  ds_read_b64_tr_b16 a[164:165], v13 offset:2048
  ds_read_b64_tr_b16 a[166:167], v13 offset:2560
  v_mul_f32_e32 v53, v24, v50
  v_mul_f32_e32 v55, v24, v51
  v_mfma_f32_32x32x16_bf16 a[144:159], a[172:175], a[40:43], a[144:159]
  ds_read_b64_tr_b16 a[168:169], v14 offset:0
  ds_read_b64_tr_b16 a[170:171], v14 offset:512
  buffer_load_dwordx2 v[134:135], v130, s[4:7], s72 offen offset:0
  v_fma_f32 v53, -v25, v51, v53
  v_fma_f32 v55, -v25, v50, -v55
  v_cvt_pk_bf16_f32 v97, v52, v53
  v_cvt_pk_bf16_f32 v105, v54, v55
  v_fma_f32 v48, v22, v50, v60
  v_mfma_f32_32x32x16_bf16 a[96:111], a[176:179], a[44:47], a[96:111]
  ds_read_b64_tr_b16 a[172:173], v14 offset:2048
  ds_read_b64_tr_b16 a[174:175], v14 offset:2560
  global_load_dwordx2 v[150:151], v144, s[52:53] offset:0
  v_fma_f32 v49, v22, v51, v76
  v_fma_f32 v48, -v23, v51, v48
  v_fmac_f32_e32 v49, v23, v50
  v_mul_f32_e32 v52, v24, v48
  v_mul_f32_e64 v54, v24, v49
  v_fma_f32 v52, -v25, v49, v52
  v_mfma_f32_32x32x16_bf16 a[112:127], a[180:183], a[44:47], a[112:127]
  ds_read_b64_tr_b16 a[176:177], v13 offset:4096
  ds_read_b64_tr_b16 a[178:179], v13 offset:4608
  buffer_load_dwordx4 v[180:183], v20, s[24:27], s96 offen offset:3072 sc0 sc1
  v_fma_f32 v54, -v25, v48, -v54
  v_fma_f32 v50, v22, v48, v61
  v_fma_f32 v51, v22, v49, v77
  v_fma_f32 v50, -v23, v49, v50
  v_fmac_f32_e32 v51, v23, v48
  v_mul_f32_e32 v53, v24, v50
  v_mul_f32_e64 v55, v24, v51
  v_mfma_f32_32x32x16_bf16 a[128:143], a[184:187], a[44:47], a[128:143]
  ds_read_b64_tr_b16 a[180:181], v13 offset:6144
  ds_read_b64_tr_b16 a[182:183], v13 offset:6656
  s_waitcnt lgkmcnt(8)
  buffer_load_dwordx2 v[136:137], v130, s[4:7], s72 offen offset:32
  v_fma_f32 v53, -v25, v51, v53
  v_fma_f32 v55, -v25, v50, -v55
  v_cvt_pk_bf16_f32 v98, v52, v53
  v_cvt_pk_bf16_f32 v106, v54, v55
  v_fma_f32 v48, v22, v50, v62
  v_mfma_f32_32x32x16_bf16 a[144:159], a[188:191], a[44:47], a[144:159]
  ds_read_b64_tr_b16 a[184:185], v14 offset:4096
  ds_read_b64_tr_b16 a[186:187], v14 offset:4608
  global_load_dwordx2 v[154:155], v144, s[52:53] offset:32
  v_fma_f32 v49, v22, v51, v78
  v_fma_f32 v48, -v23, v51, v48
  v_fmac_f32_e32 v49, v23, v50
  v_mul_f32_e32 v52, v24, v48
  v_mul_f32_e32 v54, v24, v49
  v_fma_f32 v52, -v25, v49, v52
  v_mfma_f32_32x32x16_bf16 a[96:111], a[160:163], a[48:51], a[96:111]
  ds_read_b64_tr_b16 a[188:189], v14 offset:6144
  ds_read_b64_tr_b16 a[190:191], v14 offset:6656
  buffer_load_dwordx4 v[184:187], v94, s[24:27], s96 offen offset:0 sc0 sc1
  v_fma_f32 v54, -v25, v48, -v54
  v_fma_f32 v50, v22, v48, v63
  v_fma_f32 v51, v22, v49, v79
  v_fma_f32 v50, -v23, v49, v50
  v_fmac_f32_e32 v51, v23, v48
  v_mul_f32_e32 v53, v24, v50
  v_mul_f32_e64 v55, v24, v51
  v_mfma_f32_32x32x16_bf16 a[112:127], a[164:167], a[48:51], a[112:127]
  ds_read_b64_tr_b16 a[160:161], v13 offset:8192
  ds_read_b64_tr_b16 a[162:163], v13 offset:8704
  s_waitcnt lgkmcnt(8)
  buffer_load_dwordx2 v[138:139], v130, s[4:7], s72 offen offset:64
  v_fma_f32 v53, -v25, v51, v53
  v_fma_f32 v55, -v25, v50, -v55
  v_cvt_pk_bf16_f32 v99, v52, v53
  v_cvt_pk_bf16_f32 v107, v54, v55
  v_fma_f32 v48, v22, v50, v64
  v_readlane_b32 s82, v21, 9
  v_mfma_f32_32x32x16_bf16 a[128:143], a[168:171], a[48:51], a[128:143]
  ds_read_b64_tr_b16 a[164:165], v13 offset:10240
  ds_read_b64_tr_b16 a[166:167], v13 offset:10752
  global_load_dwordx2 v[158:159], v144, s[52:53] offset:64
  v_fma_f32 v49, v22, v51, v80
  v_fma_f32 v48, -v23, v51, v48
  v_fmac_f32_e32 v49, v23, v50
  v_mul_f32_e32 v52, v24, v48
  v_mul_f32_e32 v54, v24, v49
  v_fma_f32 v52, -v25, v49, v52
  v_mfma_f32_32x32x16_bf16 a[144:159], a[172:175], a[48:51], a[144:159]
  ds_read_b64_tr_b16 a[168:169], v14 offset:8192
  ds_read_b64_tr_b16 a[170:171], v14 offset:8704
  buffer_load_dwordx4 v[188:191], v20, s[24:27], s82 offen offset:0 sc0 sc1
  v_fma_f32 v54, -v25, v48, -v54
  v_fma_f32 v50, v22, v48, v65
  v_fma_f32 v51, v22, v49, v81
  v_fma_f32 v50, -v23, v49, v50
  v_fmac_f32_e32 v51, v23, v48
  v_mul_f32_e32 v53, v24, v50
  v_mul_f32_e64 v55, v24, v51
  v_mfma_f32_32x32x16_bf16 a[96:111], a[176:179], a[52:55], a[96:111]
  ds_read_b64_tr_b16 a[172:173], v14 offset:10240
  ds_read_b64_tr_b16 a[174:175], v14 offset:10752
  s_waitcnt lgkmcnt(8)
  buffer_load_dwordx2 v[140:141], v130, s[4:7], s72 offen offset:96
  v_fma_f32 v53, -v25, v51, v53
  v_fma_f32 v55, -v25, v50, -v55
  v_cvt_pk_bf16_f32 v100, v52, v53
  v_cvt_pk_bf16_f32 v108, v54, v55
  v_fma_f32 v48, v22, v50, v66
  v_readlane_b32 s83, v21, 18
  v_mfma_f32_32x32x16_bf16 a[112:127], a[180:183], a[52:55], a[112:127]
  ds_read_b64_tr_b16 a[176:177], v13 offset:12288
  ds_read_b64_tr_b16 a[178:179], v13 offset:12800
  global_load_dwordx2 v[162:163], v144, s[52:53] offset:96
  v_fma_f32 v49, v22, v51, v82
  v_fma_f32 v48, -v23, v51, v48
  v_fmac_f32_e32 v49, v23, v50
  v_mul_f32_e32 v52, v24, v48
  v_mul_f32_e32 v54, v24, v49
  v_fma_f32 v52, -v25, v49, v52
  v_mfma_f32_32x32x16_bf16 a[128:143], a[184:187], a[52:55], a[128:143]
  ds_read_b64_tr_b16 a[180:181], v13 offset:14336
  ds_read_b64_tr_b16 a[182:183], v13 offset:14848
  buffer_load_dwordx4 a[32:35], v94, s[24:27], s83 offen offset:0 sc0 sc1
  v_fma_f32 v54, -v25, v48, -v54
  v_fma_f32 v50, v22, v48, v67
  v_fma_f32 v51, v22, v49, v83
  v_fma_f32 v50, -v23, v49, v50
  v_fmac_f32_e32 v51, v23, v48
  v_mul_f32_e32 v53, v24, v50
  v_mul_f32_e64 v55, v24, v51
  v_mfma_f32_32x32x16_bf16 a[144:159], a[188:191], a[52:55], a[144:159]
  ds_read_b64_tr_b16 a[184:185], v14 offset:12288
  ds_read_b64_tr_b16 a[186:187], v14 offset:12800
  s_waitcnt lgkmcnt(8)
  buffer_load_dwordx2 v[142:143], v130, s[4:7], s72 offen offset:128
  v_fma_f32 v53, -v25, v51, v53
  v_fma_f32 v55, -v25, v50, -v55
  v_cvt_pk_bf16_f32 v101, v52, v53
  v_cvt_pk_bf16_f32 v109, v54, v55
  v_fma_f32 v48, v22, v50, v68
  v_readlane_b32 s96, v21, 19
  v_mfma_f32_32x32x16_bf16 a[96:111], a[160:163], a[56:59], a[96:111]
  ds_read_b64_tr_b16 a[188:189], v14 offset:14336
  ds_read_b64_tr_b16 a[190:191], v14 offset:14848
  global_load_dwordx2 v[166:167], v144, s[52:53] offset:128
  v_fma_f32 v49, v22, v51, v84
  v_fma_f32 v48, -v23, v51, v48
  v_fmac_f32_e32 v49, v23, v50
  v_mul_f32_e32 v52, v24, v48
  v_mul_f32_e32 v54, v24, v49
  v_fma_f32 v52, -v25, v49, v52
  v_mfma_f32_32x32x16_bf16 a[112:127], a[164:167], a[56:59], a[112:127]
  buffer_load_dwordx4 a[36:39], v20, s[24:27], s96 offen offset:0 sc0 sc1
  v_fma_f32 v54, -v25, v48, -v54
  v_fma_f32 v50, v22, v48, v69
  v_fma_f32 v51, v22, v49, v85
  v_fma_f32 v50, -v23, v49, v50
  v_fmac_f32_e32 v51, v23, v48
  v_mul_f32_e32 v53, v24, v50
  v_mul_f32_e64 v55, v24, v51
  v_fma_f32 v53, -v25, v51, v53
  v_fma_f32 v55, -v25, v50, -v55
  v_mfma_f32_32x32x16_bf16 a[128:143], a[168:171], a[56:59], a[128:143]
  s_waitcnt vmcnt(27) lgkmcnt(0)
  s_barrier
  ds_read_b64_tr_b16 a[160:161], v13 offset:24576
  ds_read_b64_tr_b16 a[162:163], v13 offset:25088
  ds_read_b64_tr_b16 a[164:165], v13 offset:26624
  ds_read_b64_tr_b16 a[166:167], v13 offset:27136
  v_cvt_pk_bf16_f32 v102, v52, v53
  v_mfma_f32_32x32x16_bf16 a[144:159], a[172:175], a[56:59], a[144:159]
  ds_read_b64_tr_b16 a[168:169], v14 offset:24576
  ds_read_b64_tr_b16 a[170:171], v14 offset:25088
  buffer_load_dwordx4 a[40:43], v20, s[24:27], s96 offen offset:1024 sc0 sc1
  v_cvt_pk_bf16_f32 v110, v54, v55
  v_fma_f32 v48, v22, v50, v70
  v_fma_f32 v49, v22, v51, v86
  v_fma_f32 v48, -v23, v51, v48
  v_fmac_f32_e32 v49, v23, v50
  v_mul_f32_e32 v52, v24, v48
  v_mul_f32_e64 v54, v24, v49
  v_mfma_f32_32x32x16_bf16 a[96:111], a[176:179], a[60:63], a[96:111]
  ds_read_b64_tr_b16 a[172:173], v14 offset:26624
  ds_read_b64_tr_b16 a[174:175], v14 offset:27136
  buffer_load_dwordx4 a[44:47], v20, s[24:27], s96 offen offset:2048 sc0 sc1
  v_fma_f32 v52, -v25, v49, v52
  v_fma_f32 v54, -v25, v48, -v54
  v_fma_f32 v50, v22, v48, v71
  v_fma_f32 v51, v22, v49, v87
  v_fma_f32 v50, -v23, v49, v50
  v_fmac_f32_e32 v51, v23, v48
  v_mul_f32_e32 v53, v24, v50
  v_mfma_f32_32x32x16_bf16 a[112:127], a[180:183], a[60:63], a[112:127]
  ds_read_b64_tr_b16 a[176:177], v13 offset:28672
  ds_read_b64_tr_b16 a[178:179], v13 offset:29184
  s_waitcnt lgkmcnt(8)
  v_mul_f32_e32 v55, v24, v51
  v_fma_f32 v53, -v25, v51, v53
  v_fma_f32 v55, -v25, v50, -v55
  v_cvt_pk_bf16_f32 v103, v52, v53
  v_cvt_pk_bf16_f32 v111, v54, v55
  v_mfma_f32_32x32x16_bf16 a[128:143], a[184:187], a[60:63], a[128:143]
  ds_read_b64_tr_b16 a[180:181], v13 offset:30720
  ds_read_b64_tr_b16 a[182:183], v13 offset:31232
  ds_write_b128 v44, v[96:99]
  buffer_load_dwordx4 a[48:51], v20, s[24:27], s96 offen offset:3072 sc0 sc1
  v_mfma_f32_32x32x16_bf16 a[144:159], a[188:191], a[60:63], a[144:159]
  ds_read_b64_tr_b16 a[184:185], v14 offset:28672
  ds_read_b64_tr_b16 a[186:187], v14 offset:29184
  ds_write_b128 v92, v[100:103]
  v_readlane_b32 s82, v21, 20
  v_mfma_f32_32x32x16_bf16 a[96:111], a[160:163], a[64:67], a[96:111]
  ds_read_b64_tr_b16 a[188:189], v14 offset:30720
  ds_read_b64_tr_b16 a[190:191], v14 offset:31232
  s_waitcnt lgkmcnt(10)
  ds_read_b64_tr_b16 v[112:113], v45 offset:0
  ds_read_b64_tr_b16 v[114:115], v93 offset:256
  ds_read_b64_tr_b16 v[116:117], v93 offset:0
  ds_read_b64_tr_b16 v[118:119], v45 offset:256
  ds_write_b128 v44, v[104:107]
  buffer_load_dwordx4 a[52:55], v94, s[24:27], s96 offen offset:0 sc0 sc1
  v_mfma_f32_32x32x16_bf16 a[112:127], a[164:167], a[64:67], a[112:127]
  ds_read_b64_tr_b16 a[160:161], v13 offset:32768
  ds_read_b64_tr_b16 a[162:163], v13 offset:33280
  ds_write_b128 v92, v[108:111]
  buffer_load_dwordx4 a[56:59], v20, s[24:27], s82 offen offset:0 sc0 sc1
  v_mfma_f32_32x32x16_bf16 a[128:143], a[168:171], a[64:67], a[128:143]
  ds_read_b64_tr_b16 a[164:165], v13 offset:34816
  ds_read_b64_tr_b16 a[166:167], v13 offset:35328
  ds_read_b64_tr_b16 v[120:121], v45 offset:0
  ds_read_b64_tr_b16 v[122:123], v93 offset:256
  ds_read_b64_tr_b16 v[124:125], v93 offset:0
  ds_read_b64_tr_b16 v[126:127], v45 offset:256
  v_mfma_f32_32x32x16_bf16 a[144:159], a[172:175], a[64:67], a[144:159]
  ds_read_b64_tr_b16 a[168:169], v14 offset:32768
  ds_read_b64_tr_b16 a[170:171], v14 offset:33280
  s_waitcnt lgkmcnt(15)
  buffer_load_dwordx4 a[60:63], v20, s[24:27], s82 offen offset:1024 sc0 sc1
  v_mfma_f32_32x32x16_bf16 a[96:111], a[176:179], a[68:71], a[96:111]
  ds_read_b64_tr_b16 a[172:173], v14 offset:34816
  ds_read_b64_tr_b16 a[174:175], v14 offset:35328
  v_mfma_f32_32x32x16_bf16 a[112:127], a[180:183], a[68:71], a[112:127]
  ds_read_b64_tr_b16 a[176:177], v13 offset:36864
  ds_read_b64_tr_b16 a[178:179], v13 offset:37376
  s_waitcnt lgkmcnt(6)
  s_add_u32 s85, s92, 0
  buffer_store_dwordx4 v[112:115], v20, s[24:27], s85 offen offset:0 sc0 sc1
  v_mfma_f32_32x32x16_bf16 a[128:143], a[184:187], a[68:71], a[128:143]
  ds_read_b64_tr_b16 a[180:181], v13 offset:38912
  ds_read_b64_tr_b16 a[182:183], v13 offset:39424
  buffer_store_dwordx4 v[116:119], v20, s[24:27], s85 offen offset:1024 sc0 sc1
  v_mfma_f32_32x32x16_bf16 a[144:159], a[188:191], a[68:71], a[144:159]
  ds_read_b64_tr_b16 a[184:185], v14 offset:36864
  ds_read_b64_tr_b16 a[186:187], v14 offset:37376
  s_add_u32 s85, s92, 8192
  buffer_store_dwordx4 v[120:123], v20, s[24:27], s85 offen offset:0 sc0 sc1
  v_readlane_b32 s83, v21, 15
  v_mfma_f32_32x32x16_bf16 a[96:111], a[160:163], a[72:75], a[96:111]
  ds_read_b64_tr_b16 a[188:189], v14 offset:38912
  ds_read_b64_tr_b16 a[190:191], v14 offset:39424
  buffer_store_dwordx4 v[124:127], v20, s[24:27], s85 offen offset:1024 sc0 sc1
  v_mfma_f32_32x32x16_bf16 a[112:127], a[164:167], a[72:75], a[112:127]
  s_waitcnt lgkmcnt(6)
  buffer_load_dwordx4 a[64:67], v20, s[24:27], s83 offen offset:3072 sc0 sc1
  v_mfma_f32_32x32x16_bf16 a[128:143], a[168:171], a[72:75], a[128:143]
  s_waitcnt vmcnt(29) lgkmcnt(0)
  s_barrier
  ds_read_b64_tr_b16 a[160:161], v15 offset:0
  ds_read_b64_tr_b16 a[162:163], v15 offset:512
  ds_read_b64_tr_b16 a[164:165], v15 offset:2048
  ds_read_b64_tr_b16 a[166:167], v15 offset:2560
  v_readlane_b32 s96, v21, 20
  v_mfma_f32_32x32x16_bf16 a[144:159], a[172:175], a[72:75], a[144:159]
  ds_read_b64_tr_b16 a[168:169], v15 offset:4096
  ds_read_b64_tr_b16 a[170:171], v15 offset:4608
  buffer_load_dwordx4 a[68:71], v94, s[24:27], s83 offen offset:0 sc0 sc1
  v_mfma_f32_32x32x16_bf16 a[96:111], a[176:179], a[76:79], a[96:111]
  ds_read_b64_tr_b16 a[172:173], v15 offset:6144
  ds_read_b64_tr_b16 a[174:175], v15 offset:6656
  buffer_load_dwordx4 v[96:99], v20, s[24:27], s96 offen offset:2048 sc0 sc1
  v_mfma_f32_32x32x16_bf16 a[112:127], a[180:183], a[76:79], a[112:127]
  ds_read_b64_tr_b16 a[176:177], v15 offset:8192
  ds_read_b64_tr_b16 a[178:179], v15 offset:8704
  v_mfma_f32_32x32x16_bf16 a[128:143], a[184:187], a[76:79], a[128:143]
  ds_read_b64_tr_b16 a[180:181], v15 offset:10240
  ds_read_b64_tr_b16 a[182:183], v15 offset:10752
  buffer_load_dwordx4 v[100:103], v20, s[24:27], s96 offen offset:3072 sc0 sc1
  v_mfma_f32_32x32x16_bf16 a[144:159], a[188:191], a[76:79], a[144:159]
  ds_read_b64_tr_b16 a[184:185], v15 offset:12288
  ds_read_b64_tr_b16 a[186:187], v15 offset:12800
  s_waitcnt lgkmcnt(8)
  v_readlane_b32 s82, v21, 21
  v_mfma_f32_32x32x16_bf16 a[96:111], a[160:163], a[80:83], a[96:111]
  ds_read_b64_tr_b16 a[188:189], v15 offset:14336
  ds_read_b64_tr_b16 a[190:191], v15 offset:14848
  buffer_load_dwordx4 v[104:107], v94, s[24:27], s96 offen offset:0 sc0 sc1
  v_mfma_f32_32x32x16_bf16 a[112:127], a[164:167], a[80:83], a[112:127]
  ds_read_b64_tr_b16 a[160:161], v16 offset:0
  ds_read_b64_tr_b16 a[162:163], v16 offset:512
  buffer_load_dwordx4 v[108:111], v20, s[24:27], s82 offen offset:0 sc0 sc1
  v_mfma_f32_32x32x16_bf16 a[96:111], a[168:171], a[84:87], a[96:111]
  ds_read_b64_tr_b16 a[164:165], v16 offset:2048
  ds_read_b64_tr_b16 a[166:167], v16 offset:2560
  s_waitcnt lgkmcnt(8)
  v_mfma_f32_32x32x16_bf16 a[112:127], a[172:175], a[84:87], a[112:127]
  ds_read_b64_tr_b16 a[168:169], v16 offset:4096
  ds_read_b64_tr_b16 a[170:171], v16 offset:4608
  buffer_load_dwordx4 v[112:115], v20, s[24:27], s82 offen offset:1024 sc0 sc1
  v_mfma_f32_32x32x16_bf16 a[96:111], a[176:179], a[88:91], a[96:111]
  ds_read_b64_tr_b16 a[172:173], v16 offset:6144
  ds_read_b64_tr_b16 a[174:175], v16 offset:6656
  v_mfma_f32_32x32x16_bf16 a[112:127], a[180:183], a[88:91], a[112:127]
  ds_read_b64_tr_b16 a[176:177], v16 offset:8192
  ds_read_b64_tr_b16 a[178:179], v16 offset:8704
  s_waitcnt lgkmcnt(8)
  buffer_load_dwordx4 v[116:119], v20, s[24:27], s82 offen offset:2048 sc0 sc1
  v_mfma_f32_32x32x16_bf16 a[96:111], a[184:187], a[92:95], a[96:111]
  ds_read_b64_tr_b16 a[180:181], v16 offset:10240
  ds_read_b64_tr_b16 a[182:183], v16 offset:10752
  buffer_load_dwordx4 v[120:123], v20, s[24:27], s82 offen offset:3072 sc0 sc1
  v_mfma_f32_32x32x16_bf16 a[112:127], a[188:191], a[92:95], a[112:127]
  ds_read_b64_tr_b16 a[184:185], v16 offset:12288
  ds_read_b64_tr_b16 a[186:187], v16 offset:12800
  v_mfma_f32_32x32x16_bf16 a[128:143], a[160:163], a[80:83], a[128:143]
  ds_read_b64_tr_b16 a[188:189], v16 offset:14336
  ds_read_b64_tr_b16 a[190:191], v16 offset:14848
  s_waitcnt lgkmcnt(8)
  buffer_load_dwordx4 v[124:127], v94, s[24:27], s82 offen offset:0 sc0 sc1
  v_mfma_f32_32x32x16_bf16 a[144:159], a[164:167], a[80:83], a[144:159]
  v_mfma_f32_32x32x16_bf16 a[128:143], a[168:171], a[84:87], a[128:143]
  s_waitcnt lgkmcnt(0)
  s_barrier
  v_mfma_f32_32x32x16_bf16 a[144:159], a[172:175], a[84:87], a[144:159]
  s_add_u32 s85, s89, 0
  v_accvgpr_read_b32 v64, a96
  v_accvgpr_read_b32 v65, a97
  v_accvgpr_read_b32 v66, a112
  v_accvgpr_read_b32 v67, a113
  v_max_f32_e64 v64, 0, v64
  v_mfma_f32_32x32x16_bf16 a[128:143], a[176:179], a[88:91], a[128:143]
  v_max_f32_e32 v65, 0, v65
  v_mul_f32_e32 v64, v64, v66
  v_mul_f32_e64 v65, v65, v67
  v_cvt_pk_bf16_f32 v56, v64, v65
  v_accvgpr_read_b32 v68, a98
  v_accvgpr_read_b32 v69, a99
  v_accvgpr_read_b32 v70, a114
  v_mfma_f32_32x32x16_bf16 a[144:159], a[180:183], a[88:91], a[144:159]
  v_accvgpr_read_b32 v71, a115
  v_max_f32_e32 v68, 0, v68
  v_max_f32_e32 v69, 0, v69
  v_mul_f32_e32 v68, v68, v70
  v_mul_f32_e32 v69, v69, v71
  v_cvt_pk_bf16_f32 v57, v68, v69
  v_accvgpr_read_b32 v64, a100
  v_mfma_f32_32x32x16_bf16 a[128:143], a[184:187], a[92:95], a[128:143]
  v_accvgpr_read_b32 v65, a101
  v_accvgpr_read_b32 v66, a116
  v_accvgpr_read_b32 v67, a117
  v_max_f32_e32 v64, 0, v64
  v_max_f32_e32 v65, 0, v65
  v_mul_f32_e64 v64, v64, v66
  v_mfma_f32_32x32x16_bf16 a[144:159], a[188:191], a[92:95], a[144:159]
  v_mul_f32_e64 v65, v65, v67
  v_cvt_pk_bf16_f32 v58, v64, v65
  v_accvgpr_read_b32 v68, a102
  v_accvgpr_read_b32 v69, a103
  v_accvgpr_read_b32 v70, a118
  v_accvgpr_read_b32 v71, a119
  v_max_f32_e32 v68, 0, v68
  v_max_f32_e32 v69, 0, v69
  v_mul_f32_e32 v68, v68, v70
  v_mul_f32_e32 v69, v69, v71
  v_cvt_pk_bf16_f32 v59, v68, v69
  buffer_store_dwordx4 v[56:59], v19, s[24:27], s85 offen offset:0 sc0 sc1
  v_accvgpr_read_b32 v64, a104
  v_accvgpr_read_b32 v65, a105
  v_accvgpr_read_b32 v66, a120
  v_accvgpr_read_b32 v67, a121
  v_max_f32_e32 v64, 0, v64
  v_max_f32_e32 v65, 0, v65
  v_mul_f32_e32 v64, v64, v66
  v_mul_f32_e32 v65, v65, v67
  v_cvt_pk_bf16_f32 v60, v64, v65
  v_accvgpr_read_b32 v68, a106
  v_accvgpr_read_b32 v69, a107
  v_accvgpr_read_b32 v70, a122
  v_accvgpr_read_b32 v71, a123
  v_max_f32_e32 v68, 0, v68
  v_max_f32_e32 v69, 0, v69
  v_mul_f32_e32 v68, v68, v70
  v_mul_f32_e32 v69, v69, v71
  v_cvt_pk_bf16_f32 v61, v68, v69
  v_accvgpr_read_b32 v64, a108
  v_accvgpr_read_b32 v65, a109
  v_accvgpr_read_b32 v66, a124
  v_accvgpr_read_b32 v67, a125
  v_max_f32_e32 v64, 0, v64
  v_max_f32_e32 v65, 0, v65
  v_mul_f32_e32 v64, v64, v66
  v_mul_f32_e32 v65, v65, v67
  v_cvt_pk_bf16_f32 v62, v64, v65
  v_accvgpr_read_b32 v68, a110
  v_accvgpr_read_b32 v69, a111
  v_accvgpr_read_b32 v70, a126
  v_accvgpr_read_b32 v71, a127
  v_max_f32_e32 v68, 0, v68
  v_max_f32_e32 v69, 0, v69
  v_mul_f32_e32 v68, v68, v70
  v_mul_f32_e32 v69, v69, v71
  v_cvt_pk_bf16_f32 v63, v68, v69
  buffer_store_dwordx4 v[60:63], v19, s[24:27], s85 offen offset:512 sc0 sc1
  s_waitcnt vmcnt(12)
  s_barrier
  s_lshl_b32 s84, s29, 11
  s_lshl_b32 s85, s30, 7
  s_add_u32 s84, s84, s85
  s_add_u32 s84, s84, 12943360
  s_cmp_eq_u32 s28, 0
  s_cselect_b32 s84, s84, 0x10000000
  v_mov_b32_e32 v54, 0
  v_mov_b32_e32 v55, s32
  buffer_store_dword v55, v54, s[24:27], s84 offen sc0 sc1
  s_add_u32 s85, s89, 4096
  v_accvgpr_read_b32 v80, a128
  v_accvgpr_read_b32 v81, a129
  v_accvgpr_read_b32 v82, a144
  v_accvgpr_read_b32 v83, a145
  v_max_f32_e32 v80, 0, v80
  v_max_f32_e32 v81, 0, v81
  v_mul_f32_e32 v80, v80, v82
  v_mul_f32_e32 v81, v81, v83
  v_cvt_pk_bf16_f32 v72, v80, v81
  v_accvgpr_read_b32 v84, a130
  v_accvgpr_read_b32 v85, a131
  v_accvgpr_read_b32 v86, a146
  v_accvgpr_read_b32 v87, a147
  v_max_f32_e32 v84, 0, v84
  v_max_f32_e32 v85, 0, v85
  v_mul_f32_e32 v84, v84, v86
  v_mul_f32_e32 v85, v85, v87
  v_cvt_pk_bf16_f32 v73, v84, v85
  v_accvgpr_read_b32 v80, a132
  v_accvgpr_read_b32 v81, a133
  v_accvgpr_read_b32 v82, a148
  v_accvgpr_read_b32 v83, a149
  v_max_f32_e32 v80, 0, v80
  v_max_f32_e32 v81, 0, v81
  v_mul_f32_e32 v80, v80, v82
  v_mul_f32_e32 v81, v81, v83
  v_cvt_pk_bf16_f32 v74, v80, v81
  v_accvgpr_read_b32 v84, a134
  v_accvgpr_read_b32 v85, a135
  v_accvgpr_read_b32 v86, a150
  v_accvgpr_read_b32 v87, a151
  v_max_f32_e32 v84, 0, v84
  v_max_f32_e32 v85, 0, v85
  v_mul_f32_e32 v84, v84, v86
  v_mul_f32_e32 v85, v85, v87
  v_cvt_pk_bf16_f32 v75, v84, v85
  buffer_store_dwordx4 v[72:75], v19, s[24:27], s85 offen offset:0 sc0 sc1
  v_accvgpr_read_b32 v80, a136
  v_accvgpr_read_b32 v81, a137
  v_accvgpr_read_b32 v82, a152
  v_accvgpr_read_b32 v83, a153
  v_max_f32_e32 v80, 0, v80
  v_max_f32_e32 v81, 0, v81
  v_mul_f32_e32 v80, v80, v82
  v_mul_f32_e32 v81, v81, v83
  v_cvt_pk_bf16_f32 v76, v80, v81
  v_accvgpr_read_b32 v84, a138
  v_accvgpr_read_b32 v85, a139
  v_accvgpr_read_b32 v86, a154
  v_accvgpr_read_b32 v87, a155
  v_max_f32_e32 v84, 0, v84
  v_max_f32_e32 v85, 0, v85
  v_mul_f32_e32 v84, v84, v86
  v_mul_f32_e32 v85, v85, v87
  v_cvt_pk_bf16_f32 v77, v84, v85
  v_accvgpr_read_b32 v80, a140
  v_accvgpr_read_b32 v81, a141
  v_accvgpr_read_b32 v82, a156
  v_accvgpr_read_b32 v83, a157
  v_max_f32_e32 v80, 0, v80
  v_max_f32_e32 v81, 0, v81
  v_mul_f32_e32 v80, v80, v82
  v_mul_f32_e32 v81, v81, v83
  v_cvt_pk_bf16_f32 v78, v80, v81
  v_accvgpr_read_b32 v84, a142
  v_accvgpr_read_b32 v85, a143
  v_accvgpr_read_b32 v86, a158
  v_accvgpr_read_b32 v87, a159
  v_max_f32_e32 v84, 0, v84
  v_max_f32_e32 v85, 0, v85
  v_mul_f32_e32 v84, v84, v86
  v_mul_f32_e32 v85, v85, v87
  v_cvt_pk_bf16_f32 v79, v84, v85
  buffer_store_dwordx4 v[76:79], v19, s[24:27], s85 offen offset:512 sc0 sc1
  v_readlane_b32 s83, v21, 16
  s_nop 4
  buffer_load_dwordx4 a[72:75], v20, s[24:27], s83 offen offset:0 sc0 sc1
  buffer_load_dwordx4 a[76:79], v20, s[24:27], s83 offen offset:1024 sc0 sc1
  buffer_load_dwordx4 a[80:83], v20, s[24:27], s83 offen offset:2048 sc0 sc1
  buffer_load_dwordx4 a[84:87], v20, s[24:27], s83 offen offset:3072 sc0 sc1
  v_readlane_b32 s96, v21, 17
  buffer_load_dwordx4 a[88:91], v94, s[24:27], s83 offen offset:0 sc0 sc1
  v_readlane_b32 s82, v21, 4
  s_nop 2
  buffer_load_dwordx4 a[92:95], v20, s[24:27], s96 offen offset:0 sc0 sc1
  s_add_u32 m0, s97, 0
  s_nop 0
  buffer_load_dwordx4 v20, s[24:27], s82 offen offset:0 sc0 sc1 lds
  buffer_load_dwordx4 v20, s[24:27], s82 offen offset:1024 sc0 sc1 lds
  buffer_load_dwordx4 v20, s[24:27], s82 offen offset:2048 sc0 sc1 lds
  buffer_load_dwordx4 v20, s[24:27], s82 offen offset:3072 sc0 sc1 lds
  v_readlane_b32 s83, v21, 5
  s_add_u32 m0, s97, 4096
  s_nop 0
  buffer_load_dwordx4 v94, s[24:27], s82 offen offset:0 sc0 sc1 lds
  s_add_u32 m0, s97, 5120
  s_nop 0
  buffer_load_dwordx4 v20, s[24:27], s83 offen offset:0 sc0 sc1 lds
  buffer_load_dwordx4 v20, s[24:27], s83 offen offset:1024 sc0 sc1 lds
  s_waitcnt vmcnt(13)
  s_barrier
  s_lshl_b32 s84, s29, 11
  s_lshl_b32 s85, s30, 7
  s_add_u32 s84, s84, s85
  s_add_u32 s84, s84, 12976128
  s_cmp_eq_u32 s28, 0
  s_cselect_b32 s84, s84, 0x10000000
  v_mov_b32_e32 v54, 0
  v_mov_b32_e32 v55, s32
  buffer_store_dword v55, v54, s[24:27], s84 offen sc0 sc1
  buffer_load_dwordx4 v20, s[24:27], s83 offen offset:2048 sc0 sc1 lds
  s_branch L_P2
.p2align 3
L_T2:
  s_mov_b32 s80, s35
  s_mov_b32 s8, s42
  s_mov_b32 s9, s43
  s_mov_b32 s10, 819200
  s_mov_b32 s11, 0x20000
  s_sub_u32 s12, s44, 1024
  s_subb_u32 s13, s45, 0
  s_mov_b32 s14, 820224
  s_mov_b32 s15, 0x20000
  s_mov_b32 s16, s56
  s_mov_b32 s17, s57
  s_mov_b32 s18, 2211840
  s_mov_b32 s19, 0x20000
  s_sub_u32 s20, s58, 2048
  s_subb_u32 s21, s59, 0
  s_mov_b32 s22, 2213888
  s_mov_b32 s23, 0x20000
  s_lshl_b32 s84, s29, 2
  s_add_u32 s84, s84, s28
  v_lshl_add_u32 v56, v1, 7, s80
  v_subrev_u32 v57, 1280, v56
  v_min_u32_e32 v56, v56, v57
  s_mul_i32 s85, s84, 3456
  v_mul_u32_u24 v57, 1728, v56
  v_add_u32_e32 v90, s85, v57
  s_lshr_b32 s84, s84, 0
  s_mul_i32 s84, s84, 1280
  v_add_u32_e64 v53, s84, v56
  s_mul_i32 s88, s95, 40960
  s_lshl_b32 s81, s93, 7
  s_lshl_b32 s82, s94, 7
  s_mov_b64 exec, 1023
  buffer_load_dword v91, v53, s[8:11], s88 offen
  buffer_load_dword v91, v53, s[12:15], s88 offen offset:1024
  s_mov_b64 exec, -1
  v_and_b32_e32 v79, 63, v1
  s_lshl_b32 s84, s95, 5
  v_add_u32_e32 v54, s84, v79
  v_lshlrev_b32_e64 v55, 1, v54
  global_load_ushort v60, v55, s[38:39]
  global_load_ushort v61, v55, s[40:41]
  global_load_ushort v62, v55, s[50:51]
  s_sub_u32 s84, 15, s29
  s_lshl_b32 s84, s84, 10
  v_lshl_add_u32 v46, v79, 4, s84
  v_lshlrev_b32_e32 v43, 3, v79
  s_lshl_b32 s84, s28, 10
  s_add_u32 s84, s84, 73728
  v_add_u32_e32 v43, s84, v43
  s_mov_b32 s24, s66
  s_mov_b32 s25, s67
  s_mov_b32 s26, 20447232
  s_mov_b32 s27, 0x20000
  s_mul_i32 s42, s92, 40960
  s_lshl_b32 s84, s87, 7
  s_add_u32 s42, s42, s84
  s_add_u32 s42, s42, 17825792
  s_add_u32 s41, s42, 4096
  s_add_u32 s40, s42, 8192
  v_mov_b32_e32 v68, 0
  v_mov_b32_e32 v69, 0
  v_mov_b32_e32 v70, 0
  v_mov_b32_e64 v71, 0
  v_mov_b32 v72, 0x3f803f80
  v_lshlrev_b32_e64 v66, 3, v51
  v_add_u32 v66, 80896, v66
  v_lshl_add_u32 v67, s28, 6, v66
  v_lshlrev_b32_e32 v20, 4, v1
  v_and_b32_e32 v79, 31, v1
  v_lshrrev_b32_e64 v54, 5, v1
  v_bfe_u32 v55, v1, 1, 3
  v_xor_b32_e32 v55, v55, v54
  v_lshlrev_b32_e32 v55, 4, v55
  v_lshl_add_u32 v56, v79, 7, v55
  v_lshrrev_b32_e64 v57, 3, v79
  v_mul_u32_u24 v57, 3072, v57
  v_add_u32_e32 v5, v57, v56
  v_xor_b32_e32 v6, 32, v5
  v_xor_b32_e64 v7, 64, v5
  v_xor_b32 v8, 0x60, v5
  v_add_u32 v9, 40960, v5
  v_add_u32 v10, 40960, v6
  v_add_u32 v11, 40960, v7
  v_add_u32 v12, 40960, v8
  v_bfe_u32 v56, v1, 2, 2
  v_lshlrev_b32_e64 v56, 7, v56
  v_lshl_add_u32 v56, v54, 10, v56
  v_bfe_u32 v57, v1, 4, 1
  v_lshl_add_u32 v56, v57, 5, v56
  v_and_b32_e64 v57, 3, v1
  v_lshl_add_u32 v56, v57, 3, v56
  v_bfe_u32 v57, v1, 3, 1
  v_lshl_add_u32 v13, v57, 6, v56
  v_xor_b32_e64 v14, 64, v13
  v_add_u32 v15, 40960, v13
  v_add_u32 v16, 40960, v14
  v_and_b32_e32 v56, 7, v1
  s_and_b32 s84, s28, 1
  s_lshl_b32 s84, s84, 2
  v_lshrrev_b32_e32 v57, 1, v52
  v_add_u32_e32 v57, s84, v57
  v_xor_b32_e32 v57, v57, v56
  s_lshl_b32 s84, s28, 3
  v_add_u32_e32 v58, s84, v52
  v_mul_u32_u24 v58, 1280, v58
  v_lshl_add_u32 v2, v57, 4, v58
  v_bfe_u32 v57, v1, 4, 1
  v_lshlrev_b32_e32 v57, 2, v57
  v_xor_b32_e32 v57, v57, v56
  s_lshl_b32 s84, s28, 4
  v_add_u32_e32 v58, s84, v52
  v_mul_u32_u24 v58, 3456, v58
  v_lshl_add_u32 v3, v57, 4, v58
  v_add_u32 v4, 26624, v3
  v_bfe_u32 v56, v1, 2, 1
  v_lshlrev_b32_e64 v56, 10, v56
  v_lshl_add_u32 v56, v54, 8, v56
  v_lshrrev_b32_e64 v57, 3, v79
  v_lshl_add_u32 v56, v57, 6, v56
  v_and_b32_e64 v57, 3, v1
  v_lshl_add_u32 v19, v57, 4, v56
  v_lshlrev_b32_e64 v56, 3, v79
  v_lshl_add_u32 v56, v54, 9, v56
  s_lshl_b32 s84, s28, 10
  s_add_u32 s84, s84, 76800
  v_add_u32_e32 v42, s84, v56
  s_lshl_b32 s84, s28, 11
  s_add_u32 s84, s84, 16384
  v_bfe_u32 v56, v1, 1, 2
  v_bfe_u32 v58, v1, 3, 1
  v_xor_b32_e32 v58, v58, v54
  v_lshlrev_b32_e32 v58, 1, v58
  v_xor_b32_e32 v56, v56, v58
  v_lshlrev_b32_e64 v56, 4, v56
  v_lshl_add_u32 v56, v79, 6, v56
  v_add_u32_e32 v44, s84, v56
  v_lshrrev_b32_e32 v56, 4, v1
  v_lshlrev_b32_e64 v56, 3, v56
  v_bfe_u32 v58, v1, 2, 2
  v_add_u32_e32 v56, v56, v58
  v_lshlrev_b32_e32 v56, 6, v56
  v_and_b32_e32 v58, 2, v58
  v_xor_b32_e32 v58, v58, v57
  v_lshl_add_u32 v56, v58, 3, v56
  v_bfe_u32 v58, v1, 4, 1
  v_lshl_add_u32 v56, v58, 5, v56
  v_add_u32_e32 v45, s84, v56
  v_mov_b32_e32 v58, 0
  v_mov_b32_e32 v59, 0
  v_lshlrev_b32_e32 v56, 3, v1
  s_lshl_b32 s84, s28, 9
  s_add_u32 s84, s84, 73728
  v_add_u32_e32 v56, s84, v56
  ds_write_b64 v56, v[58:59]
  ds_write_b64 v56, v[58:59] offset:1024
  s_mul_i32 s88, s95, 40960
  s_lshl_b32 s84, s29, 1
  s_lshr_b32 s85, s28, 1
  s_add_u32 s84, s84, s85
  s_mul_i32 s84, s84, 385024
  s_and_b32 s85, s28, 1
  s_lshl_b32 s85, s85, 11
  s_add_u32 s84, s84, s85
  s_lshr_b32 s85, s95, 1
  s_lshl_b32 s85, s85, 2
  s_and_b32 s86, s95, 1
  s_add_u32 s85, s85, s86
  s_lshl_b32 s85, s85, 12
  s_add_u32 s92, s84, s85
  s_add_u32 s84, s84, 163840
  s_lshl_b32 s85, s93, 13
  s_add_u32 s91, s84, s85
  s_lshl_b32 s85, s94, 13
  s_add_u32 s89, s84, s85
  s_cmp_eq_u32 s94, 27
  s_cselect_b32 s89, 0x10000000, s89
  s_cselect_b32 s94, 0x200000, s94
  s_lshl_b32 s93, s93, 7
  s_lshl_b32 s94, s94, 7
  s_lshl_b32 s84, s30, 14
  s_add_u32 s84, s84, 12648448
  s_add_u32 s36, s66, s84
  s_addc_u32 s37, s67, 0
  s_mov_b32 s38, 16384
  s_mov_b32 s39, 0x20000
  s_lshl_b32 s84, s2, 2
  s_add_u32 s84, s84, s28
  s_mov_b32 s70, 819200
  s_cmpk_lt_u32 s84, 540
  s_cselect_b32 s77, 1, 0
  s_cselect_b32 s85, 0, 540
  s_cselect_b32 s68, s60, s46
  s_cselect_b32 s69, s61, s47
  s_cselect_b32 s70, 2211840, s70
  s_mov_b32 s71, 0x20000
  s_cmpk_ge_u32 s84, 740
  s_cselect_b32 s85, 740, s85
  s_cselect_b32 s68, s48, s68
  s_cselect_b32 s69, s49, s69
  s_cselect_b32 s96, 2, 0
  s_sub_u32 s84, s84, s85
  s_mul_i32 s85, s84, 6554
  s_lshr_b32 s85, s85, 16
  s_mul_i32 s86, s85, 10
  s_sub_u32 s86, s84, s86
  s_mul_i32 s72, s85, 40960
  s_lshl_b32 s84, s86, 7
  s_add_u32 s72, s72, s84
  v_and_b32_e64 v56, 7, v1
  v_mul_u32_u24 v57, 1280, v52
  v_lshl_add_u32 v88, v56, 4, v57
  s_lshl_b32 s3, s28, 12
  s_mul_i32 s80, s28, 4096
  s_add_u32 s80, s80, 81920
  s_lshl_b32 s84, s86, 2
  s_add_u32 s78, s84, 0
  s_add_u32 s84, s84, s96
  s_add_u32 s84, s84, 0
  s_lshl_b32 s79, s85, 1
  s_add_u32 s79, s79, 0
  s_add_u32 s97, s85, 40
  s_cmp_eq_u32 s77, 1
  s_cselect_b32 s78, s78, s79
  s_cselect_b32 s84, s97, s84
  s_mul_i32 s79, s78, 205
  s_lshr_b32 s79, s79, 10
  s_mul_i32 s79, s79, 465
  s_mul_i32 s84, s84, 5
  s_add_u32 s84, s84, s79
  s_add_u32 s84, s84, s78
  s_lshl_b32 s84, s84, 10
  s_add_u32 s84, s84, 13631488
  s_cmp_ge_u32 s78, 40
  s_cselect_b32 s73, 0x10000000, s84
  s_lshl_b32 s84, s86, 2
  s_add_u32 s78, s84, 1
  s_add_u32 s84, s84, s96
  s_add_u32 s84, s84, 1
  s_lshl_b32 s79, s85, 1
  s_add_u32 s79, s79, 0
  s_add_u32 s97, s85, 40
  s_cmp_eq_u32 s77, 1
  s_cselect_b32 s78, s78, s79
  s_cselect_b32 s84, s97, s84
  s_mul_i32 s79, s78, 205
  s_lshr_b32 s79, s79, 10
  s_mul_i32 s79, s79, 465
  s_mul_i32 s84, s84, 5
  s_add_u32 s84, s84, s79
  s_add_u32 s84, s84, s78
  s_lshl_b32 s84, s84, 10
  s_add_u32 s84, s84, 13631488
  s_cmp_ge_u32 s78, 40
  s_cselect_b32 s74, 0x10000000, s84
  s_lshl_b32 s84, s86, 2
  s_add_u32 s78, s84, 2
  s_add_u32 s84, s84, s96
  s_add_u32 s84, s84, 0
  s_lshl_b32 s79, s85, 1
  s_add_u32 s79, s79, 1
  s_add_u32 s97, s85, 40
  s_cmp_eq_u32 s77, 1
  s_cselect_b32 s78, s78, s79
  s_cselect_b32 s84, s97, s84
  s_mul_i32 s79, s78, 205
  s_lshr_b32 s79, s79, 10
  s_mul_i32 s79, s79, 465
  s_mul_i32 s84, s84, 5
  s_add_u32 s84, s84, s79
  s_add_u32 s84, s84, s78
  s_lshl_b32 s84, s84, 10
  s_add_u32 s84, s84, 13631488
  s_cmp_ge_u32 s78, 40
  s_cselect_b32 s75, 0x10000000, s84
  s_lshl_b32 s84, s86, 2
  s_add_u32 s78, s84, 3
  s_add_u32 s84, s84, s96
  s_add_u32 s84, s84, 1
  s_lshl_b32 s79, s85, 1
  s_add_u32 s79, s79, 1
  s_add_u32 s97, s85, 40
  s_cmp_eq_u32 s77, 1
  s_cselect_b32 s78, s78, s79
  s_cselect_b32 s84, s97, s84
  s_mul_i32 s79, s78, 205
  s_lshr_b32 s79, s79, 10
  s_mul_i32 s79, s79, 465
  s_mul_i32 s84, s84, 5
  s_add_u32 s84, s84, s79
  s_add_u32 s84, s84, s78
  s_lshl_b32 s84, s84, 10
  s_add_u32 s84, s84, 13631488
  s_cmp_ge_u32 s78, 40
  s_cselect_b32 s76, 0x10000000, s84
  s_cmp_eq_u32 s28, 1
  s_cselect_b32 s96, 16, 24
  v_subrev_u32_e32 v57, 12, v1
  v_min_u32_e32 v57, v57, v1
  v_and_b32_e32 v58, 1, v57
  v_lshlrev_b32_e32 v57, 1, v57
  v_sub_u32_e32 v57, v57, v58
  v_add_u32_e32 v58, 2, v57
  v_cmp_gt_u32 vcc, 12, v1
  s_nop 1
  v_cndmask_b32 v57, v57, v58, vcc
  s_cmp_ge_u32 s28, 2
  s_cselect_b64 vcc, -1, 0
  v_cndmask_b32 v56, v1, v57, vcc
  s_mul_i32 s85, s28, 24
  s_and_b32 s86, s28, 2
  s_sub_u32 s85, s85, s86
  v_add_u32_e32 v56, s85, v56
  v_add_u32_e32 v57, 22, v1
  v_mov_b32 v58, 0x8000
  v_cmp_gt_u32 vcc, 18, v1
  s_nop 1
  v_cndmask_b32 v57, v57, v58, vcc
  v_cmp_gt_u32 vcc, s96, v1
  s_nop 1
  v_cndmask_b32 v56, v57, v56, vcc
  s_mul_i32 s84, s34, 481280
  s_add_u32 s84, s84, 13631488
  v_mul_u32_u24 v57, 5120, v56
  v_add_u32_e64 v21, s84, v57
  s_mul_i32 s84, s33, 385024
  v_lshl_add_u32 v47, v56, 12, s84
  v_add_u32 v94, 4096, v20
  s_mul_i32 s97, s28, 10240
  v_and_b32_e32 v56, 15, v1
  v_lshrrev_b32_e32 v57, 4, v1
  v_lshlrev_b32_e64 v58, 7, v56
  v_lshl_add_u32 v58, v57, 4, v58
  v_add_u32_e32 v89, s80, v58
  v_lshrrev_b32_e32 v58, 1, v57
  v_lshlrev_b32_e32 v58, 4, v58
  v_and_b32_e32 v57, 1, v57
  v_lshl_add_u32 v58, v57, 2, v58
  v_lshrrev_b32_e32 v56, 2, v56
  v_add_u32_e32 v58, v58, v56
  v_lshlrev_b32_e32 v58, 7, v58
  v_and_b32_e32 v56, 3, v1
  v_lshl_add_u32 v58, v56, 3, v58
  v_add_u32_e32 v92, s80, v58
  s_cmp_eq_u32 s77, 1
  s_cselect_b64 s[78:79], 0, -1
  s_waitcnt vmcnt(5)
  v_dot2c_f32_bf16 v68, v96, v72
  v_dot2c_f32_bf16 v69, v96, v96
  v_dot2c_f32_bf16 v70, v97, v72
  v_dot2c_f32_bf16 v71, v97, v97
  v_dot2c_f32_bf16 v68, v98, v72
  v_dot2c_f32_bf16 v69, v98, v98
  v_dot2c_f32_bf16 v70, v99, v72
  v_dot2c_f32_bf16 v71, v99, v99
  v_dot2c_f32_bf16 v68, v100, v72
  v_dot2c_f32_bf16 v69, v100, v100
  v_dot2c_f32_bf16 v70, v101, v72
  v_dot2c_f32_bf16 v71, v101, v101
  v_dot2c_f32_bf16 v68, v102, v72
  v_dot2c_f32_bf16 v69, v102, v102
  v_dot2c_f32_bf16 v70, v103, v72
  v_dot2c_f32_bf16 v71, v103, v103
  v_dot2c_f32_bf16 v68, v104, v72
  v_dot2c_f32_bf16 v69, v104, v104
  v_dot2c_f32_bf16 v70, v105, v72
  v_dot2c_f32_bf16 v71, v105, v105
  v_dot2c_f32_bf16 v68, v106, v72
  v_dot2c_f32_bf16 v69, v106, v106
  v_dot2c_f32_bf16 v70, v107, v72
  v_dot2c_f32_bf16 v71, v107, v107
  s_nop 1
  v_add_f32_e32 v68, v68, v70
  v_add_f32_e32 v69, v69, v71
  s_nop 1
  v_add_f32_dpp v68, v68, v68 row_ror:8 row_mask:0xf bank_mask:0xf
  v_add_f32_dpp v69, v69, v69 row_ror:8 row_mask:0xf bank_mask:0xf
  v_mov_b32_e32 v70, v68
  v_mov_b32_e32 v71, v69
  s_nop 0
  v_permlane16_swap_b32 v68, v70
  v_permlane16_swap_b32 v69, v71
  v_add_f32_e32 v68, v68, v70
  v_add_f32_e32 v69, v69, v71
  v_mov_b32_e32 v70, v68
  v_mov_b32_e32 v71, v69
  s_nop 0
  v_permlane32_swap_b32 v68, v70
  v_permlane32_swap_b32 v69, v71
  v_add_f32_e32 v68, v68, v70
  v_add_f32_e32 v69, v69, v71
  ds_write_b64 v67, v[68:69]
  s_waitcnt lgkmcnt(0)
  s_barrier
  ds_read_b64 v[108:109], v66 offset:0
  ds_read_b64 v[110:111], v66 offset:64
  ds_read_b64 v[112:113], v66 offset:128
  ds_read_b64 v[114:115], v66 offset:192
  s_waitcnt lgkmcnt(0)
  v_pk_add_f32 v[68:69], v[108:109], v[110:111]
  v_pk_add_f32 v[70:71], v[112:113], v[114:115]
  v_pk_add_f32 v[68:69], v[68:69], v[70:71]
  v_mul_f32 v68, 0x3acccccd, v68
  v_mul_f32 v69, 0x3acccccd, v69
  v_fma_f32 v69, -v68, v68, v69
  v_max_f32_e32 v69, 0, v69
  v_cvt_pk_bf16_f32 v68, v68, v68
  v_lshlrev_b32_e64 v68, 16, v68
  v_cvt_pk_bf16_f32 v69, v69, v69
  v_lshlrev_b32_e64 v69, 16, v69
  v_add_f32 v69, 0x3727c5ac, v69
  v_cvt_pk_bf16_f32 v69, v69, v69
  v_lshlrev_b32_e32 v69, 16, v69
  v_sqrt_f32_e32 v69, v69
  s_nop 0
  v_cvt_pk_bf16_f32 v69, v69, v69
  v_lshlrev_b32_e32 v69, 16, v69
  v_rcp_f32_e32 v69, v69
  v_lshlrev_b32_e32 v70, 16, v96
  v_and_b32_e64 v71, s31, v96
  v_pk_add_f32 v[70:71], v[70:71], v[68:69] op_sel_hi:[1,0] neg_lo:[0,1] neg_hi:[0,1]
  v_cvt_pk_bf16_f32 v96, v70, v71
  v_lshlrev_b32_e32 v70, 16, v96
  v_and_b32_e32 v71, s31, v96
  v_pk_mul_f32 v[70:71], v[70:71], v[68:69] op_sel:[0,1] op_sel_hi:[1,1]
  v_cvt_pk_bf16_f32 v96, v70, v71
  v_lshlrev_b32_e32 v70, 16, v97
  v_and_b32_e32 v71, s31, v97
  v_pk_add_f32 v[70:71], v[70:71], v[68:69] op_sel_hi:[1,0] neg_lo:[0,1] neg_hi:[0,1]
  v_cvt_pk_bf16_f32 v97, v70, v71
  v_lshlrev_b32_e32 v70, 16, v97
  v_and_b32_e32 v71, s31, v97
  v_pk_mul_f32 v[70:71], v[70:71], v[68:69] op_sel:[0,1] op_sel_hi:[1,1]
  v_cvt_pk_bf16_f32 v97, v70, v71
  v_lshlrev_b32_e32 v70, 16, v98
  v_and_b32_e32 v71, s31, v98
  v_pk_add_f32 v[70:71], v[70:71], v[68:69] op_sel_hi:[1,0] neg_lo:[0,1] neg_hi:[0,1]
  v_cvt_pk_bf16_f32 v98, v70, v71
  v_lshlrev_b32_e32 v70, 16, v98
  v_and_b32_e32 v71, s31, v98
  v_pk_mul_f32 v[70:71], v[70:71], v[68:69] op_sel:[0,1] op_sel_hi:[1,1]
  v_cvt_pk_bf16_f32 v98, v70, v71
  v_lshlrev_b32_e32 v70, 16, v99
  v_and_b32_e32 v71, s31, v99
  v_pk_add_f32 v[70:71], v[70:71], v[68:69] op_sel_hi:[1,0] neg_lo:[0,1] neg_hi:[0,1]
  v_cvt_pk_bf16_f32 v99, v70, v71
  v_lshlrev_b32_e32 v70, 16, v99
  v_and_b32_e32 v71, s31, v99
  v_pk_mul_f32 v[70:71], v[70:71], v[68:69] op_sel:[0,1] op_sel_hi:[1,1]
  v_cvt_pk_bf16_f32 v99, v70, v71
  buffer_store_dwordx4 v[96:99], v64, s[24:27], s42 offen sc0 sc1
  v_lshlrev_b32_e32 v70, 16, v100
  v_and_b32_e32 v71, s31, v100
  v_pk_add_f32 v[70:71], v[70:71], v[68:69] op_sel_hi:[1,0] neg_lo:[0,1] neg_hi:[0,1]
  v_cvt_pk_bf16_f32 v100, v70, v71
  v_lshlrev_b32_e32 v70, 16, v100
  v_and_b32_e32 v71, s31, v100
  v_pk_mul_f32 v[70:71], v[70:71], v[68:69] op_sel:[0,1] op_sel_hi:[1,1]
  v_cvt_pk_bf16_f32 v100, v70, v71
  v_lshlrev_b32_e32 v70, 16, v101
  v_and_b32_e32 v71, s31, v101
  v_pk_add_f32 v[70:71], v[70:71], v[68:69] op_sel_hi:[1,0] neg_lo:[0,1] neg_hi:[0,1]
  v_cvt_pk_bf16_f32 v101, v70, v71
  v_lshlrev_b32_e32 v70, 16, v101
  v_and_b32_e32 v71, s31, v101
  v_pk_mul_f32 v[70:71], v[70:71], v[68:69] op_sel:[0,1] op_sel_hi:[1,1]
  v_cvt_pk_bf16_f32 v101, v70, v71
  v_lshlrev_b32_e32 v70, 16, v102
  v_and_b32_e32 v71, s31, v102
  v_pk_add_f32 v[70:71], v[70:71], v[68:69] op_sel_hi:[1,0] neg_lo:[0,1] neg_hi:[0,1]
  v_cvt_pk_bf16_f32 v102, v70, v71
  v_lshlrev_b32_e32 v70, 16, v102
  v_and_b32_e32 v71, s31, v102
  v_pk_mul_f32 v[70:71], v[70:71], v[68:69] op_sel:[0,1] op_sel_hi:[1,1]
  v_cvt_pk_bf16_f32 v102, v70, v71
  v_lshlrev_b32_e32 v70, 16, v103
  v_and_b32_e32 v71, s31, v103
  v_pk_add_f32 v[70:71], v[70:71], v[68:69] op_sel_hi:[1,0] neg_lo:[0,1] neg_hi:[0,1]
  v_cvt_pk_bf16_f32 v103, v70, v71
  v_lshlrev_b32_e32 v70, 16, v103
  v_and_b32_e32 v71, s31, v103
  v_pk_mul_f32 v[70:71], v[70:71], v[68:69] op_sel:[0,1] op_sel_hi:[1,1]
  v_cvt_pk_bf16_f32 v103, v70, v71
  buffer_store_dwordx4 v[100:103], v64, s[24:27], s41 offen sc0 sc1
  v_lshlrev_b32_e32 v70, 16, v104
  v_and_b32_e32 v71, s31, v104
  v_pk_add_f32 v[70:71], v[70:71], v[68:69] op_sel_hi:[1,0] neg_lo:[0,1] neg_hi:[0,1]
  v_cvt_pk_bf16_f32 v104, v70, v71
  v_lshlrev_b32_e32 v70, 16, v104
  v_and_b32_e32 v71, s31, v104
  v_pk_mul_f32 v[70:71], v[70:71], v[68:69] op_sel:[0,1] op_sel_hi:[1,1]
  v_cvt_pk_bf16_f32 v104, v70, v71
  v_lshlrev_b32_e32 v70, 16, v105
  v_and_b32_e32 v71, s31, v105
  v_pk_add_f32 v[70:71], v[70:71], v[68:69] op_sel_hi:[1,0] neg_lo:[0,1] neg_hi:[0,1]
  v_cvt_pk_bf16_f32 v105, v70, v71
  v_lshlrev_b32_e32 v70, 16, v105
  v_and_b32_e32 v71, s31, v105
  v_pk_mul_f32 v[70:71], v[70:71], v[68:69] op_sel:[0,1] op_sel_hi:[1,1]
  v_cvt_pk_bf16_f32 v105, v70, v71
  v_lshlrev_b32_e32 v70, 16, v106
  v_and_b32_e32 v71, s31, v106
  v_pk_add_f32 v[70:71], v[70:71], v[68:69] op_sel_hi:[1,0] neg_lo:[0,1] neg_hi:[0,1]
  v_cvt_pk_bf16_f32 v106, v70, v71
  v_lshlrev_b32_e32 v70, 16, v106
  v_and_b32_e32 v71, s31, v106
  v_pk_mul_f32 v[70:71], v[70:71], v[68:69] op_sel:[0,1] op_sel_hi:[1,1]
  v_cvt_pk_bf16_f32 v106, v70, v71
  v_lshlrev_b32_e32 v70, 16, v107
  v_and_b32_e32 v71, s31, v107
  v_pk_add_f32 v[70:71], v[70:71], v[68:69] op_sel_hi:[1,0] neg_lo:[0,1] neg_hi:[0,1]
  v_cvt_pk_bf16_f32 v107, v70, v71
  v_lshlrev_b32_e32 v70, 16, v107
  v_and_b32_e32 v71, s31, v107
  v_pk_mul_f32 v[70:71], v[70:71], v[68:69] op_sel:[0,1] op_sel_hi:[1,1]
  v_cvt_pk_bf16_f32 v107, v70, v71
  buffer_store_dwordx4 v[104:107], v65, s[24:27], s40 offen sc0 sc1
  v_lshlrev_b32_e64 v50, 3, v50
  s_mov_b32 s43, 12582912
  s_cmp_eq_u32 s28, 0
  s_cselect_b32 s43, s43, 0x10000000
  buffer_store_dwordx2 v[68:69], v50, s[24:27], s43 offen sc0 sc1
  s_add_u32 s32, s32, 0x9e3779b9
  s_cmp_eq_u32 s32, 0
  s_cselect_b32 s32, 0x9e3779b9, s32
  s_mul_i32 s90, s28, 6144
  s_lshl2_add_u32 s84, s29, s28
  s_mul_i32 s41, s84, 40960
  s_add_u32 s41, s41, 17825792
  s_add_u32 s42, s41, 40960
  s_lshl_b32 s40, s35, 5
  s_add_u32 s40, s40, s41
  v_add_u32 v48, 98304, v5
  v_add_u32 v49, 98304, v6
  v_add_u32 v50, 98304, v7
  v_add_u32 v51, 98304, v8
  v_add_u32 v17, 98304, v13
  v_add_u32 v18, 98304, v14
  s_mov_b32 m0, s80
  s_add_u32 s81, s72, 0
  buffer_load_dwordx4 v88, s[68:71], s81 offen offset:0  lds
  s_add_u32 s81, s72, 9216
  buffer_load_dwordx4 v88, s[68:71], s81 offen offset:1024  lds
  s_add_u32 s81, s72, 18432
  buffer_load_dwordx4 v88, s[68:71], s81 offen offset:2048  lds
  s_add_u32 s81, s72, 27648
  buffer_load_dwordx4 v88, s[68:71], s81 offen offset:3072  lds
  s_mov_b32 s43, s84
  s_waitcnt vmcnt(4)
  s_barrier
  s_lshl_b32 s84, s29, 11
  s_lshl_b32 s85, s30, 7
  s_add_u32 s84, s84, s85
  s_add_u32 s84, s84, 12910592
  s_cmp_eq_u32 s28, 0
  s_cselect_b32 s84, s84, 0x10000000
  v_mov_b32_e32 v54, 0
  v_mov_b32_e32 v55, s32
  buffer_store_dword v55, v54, s[24:27], s84 offen sc0 sc1
  s_mov_b32 s84, s43
  s_add_u32 m0, s3, 40960
  s_add_u32 s84, s88, s35
  buffer_load_dwordx4 v2, s[8:11], s84 offen offset:0  lds
  v_lshlrev_b32_e32 v60, 16, v60
  v_lshlrev_b32_e32 v61, 16, v61
  v_lshlrev_b32_e64 v62, 16, v62
  v_mul_f32 v62, 0x3fb8aa3b, v62
  v_exp_f32_e64 v62, v62
  buffer_load_dwordx4 v2, s[12:15], s84 offen offset:1024  lds
  v_cvt_pk_bf16_f32 v62, v62, v62
  v_lshlrev_b32_e32 v62, 16, v62
  v_mul_f32_e32 v63, v62, v60
  v_mul_f32_e64 v73, v62, v61
  v_mul_f32 v63, 0x3fb8aa3b, v63
  v_mul_f32 v73, 0x3e22f983, v73
  s_add_u32 m0, s3, 43008
  s_add_u32 s84, s84, 40960
  buffer_load_dwordx4 v2, s[8:11], s84 offen offset:0  lds
  v_exp_f32_e32 v63, v63
  v_fract_f32_e32 v73, v73
  v_cos_f32_e32 v74, v73
  v_sin_f32_e32 v75, v73
  v_mul_f32_e32 v22, v63, v74
  v_mul_f32_e32 v23, v63, v75
  buffer_load_dwordx4 v2, s[12:15], s84 offen offset:1024  lds
  s_addk_i32 s35, 128
  s_cmpk_eq_u32 s35, 1280
  s_cselect_b32 s35, 0, s35
  v_add_f32_e32 v74, -1.0, v22
  v_mul_f32_e32 v75, v60, v60
  v_fmac_f32_e32 v75, v61, v61
  v_rcp_f32_e32 v75, v75
  v_mul_f32_e32 v24, v74, v60
  v_fmac_f32_e64 v24, v23, v61
  s_add_u32 m0, s3, 57344
  s_add_u32 s84, s88, s35
  buffer_load_dwordx4 v2, s[8:11], s84 offen offset:0  lds
  v_mul_f32_e32 v25, v23, v60
  v_fma_f32 v25, -v74, v61, v25
  v_add_f32_e32 v75, v75, v75
  v_mul_f32_e32 v24, v24, v75
  v_mul_f32_e64 v25, v25, v75
  buffer_load_dwordx4 v2, s[12:15], s84 offen offset:1024  lds
  v_mul_f32_e32 v74, v22, v22
  v_mul_f32_e32 v75, v22, v23
  v_fma_f32 v74, -v23, v23, v74
  v_fmac_f32_e32 v75, v23, v22
  v_mul_f32_e32 v76, v74, v74
  v_mul_f32_e64 v77, v74, v75
  s_add_u32 m0, s3, 59392
  s_add_u32 s84, s84, 40960
  buffer_load_dwordx4 v2, s[8:11], s84 offen offset:0  lds
  v_fma_f32 v76, -v75, v75, v76
  v_fmac_f32_e32 v77, v75, v74
  v_mul_f32_e32 v74, v76, v76
  v_mul_f32_e64 v75, v76, v77
  v_fma_f32 v74, -v77, v77, v74
  v_fmac_f32_e64 v75, v77, v76
  buffer_load_dwordx4 v2, s[12:15], s84 offen offset:1024  lds
  s_addk_i32 s35, 128
  s_cmpk_eq_u32 s35, 1280
  s_cselect_b32 s35, 0, s35
  v_mul_f32_e32 v30, v74, v74
  v_mul_f32_e64 v31, v74, v75
  v_fma_f32 v30, -v75, v75, v30
  v_fmac_f32_e32 v31, v75, v74
  v_mul_f32_e32 v74, v30, v30
  v_mul_f32_e32 v75, v30, v31
  s_add_u32 m0, s3, 0
  s_add_u32 s84, s88, s35
  buffer_load_dwordx4 v2, s[8:11], s84 offen offset:0  lds
  v_fma_f32 v74, -v31, v31, v74
  v_fmac_f32_e32 v75, v31, v30
  v_mul_f32_e32 v76, v74, v74
  v_mul_f32_e32 v77, v74, v75
  v_fma_f32 v76, -v75, v75, v76
  v_fmac_f32_e64 v77, v75, v74
  buffer_load_dwordx4 v2, s[12:15], s84 offen offset:1024  lds
  v_mul_f32_e32 v32, v76, v76
  v_mul_f32_e32 v33, v76, v77
  v_fma_f32 v32, -v77, v77, v32
  v_fmac_f32_e32 v33, v77, v76
  s_bitcmp1_b32 s28, 0
  s_cselect_b64 vcc, -1, 0
  s_add_u32 m0, s3, 2048
  s_add_u32 s84, s84, 40960
  buffer_load_dwordx4 v2, s[8:11], s84 offen offset:0  lds
  v_cndmask_b32 v74, 1.0, v74, vcc
  v_cndmask_b32 v75, 0, v75, vcc
  s_bitcmp1_b32 s28, 1
  s_cselect_b64 vcc, -1, 0
  v_cndmask_b32 v76, 1.0, v76, vcc
  buffer_load_dwordx4 v2, s[12:15], s84 offen offset:1024  lds
  s_addk_i32 s35, 128
  s_cmpk_eq_u32 s35, 1280
  s_cselect_b32 s35, 0, s35
  v_cndmask_b32 v77, 0, v77, vcc
  v_mul_f32_e32 v34, v74, v76
  v_mul_f32_e32 v35, v74, v77
  v_fma_f32 v34, -v75, v77, v34
  v_fmac_f32_e32 v35, v75, v76
  v_mul_f32_e32 v36, v34, v30
  s_add_u32 m0, s3, 24576
  s_add_u32 s84, s88, s35
  buffer_load_dwordx4 v2, s[8:11], s84 offen offset:0  lds
  v_mul_f32_e32 v37, v34, v31
  v_fma_f32 v36, -v35, v31, v36
  v_fmac_f32_e32 v37, v35, v30
  v_mov_b32_e32 v26, v22
  s_nop 1
  v_permlane32_swap_b32 v22, v26
  v_mov_b32_e64 v27, v23
  buffer_load_dwordx4 v2, s[12:15], s84 offen offset:1024  lds
  s_nop 0
  v_permlane32_swap_b32 v23, v27
  v_mov_b32_e32 v28, v24
  s_nop 1
  v_permlane32_swap_b32 v24, v28
  v_mov_b32_e32 v29, v25
  s_nop 1
  v_permlane32_swap_b32 v25, v29
  s_waitcnt vmcnt(15)
  ds_read_b64_tr_b16 a[192:193], v92 offset:0
  ds_read_b64_tr_b16 a[194:195], v92 offset:1024
  ds_read_b64_tr_b16 a[196:197], v92 offset:32
  ds_read_b64_tr_b16 a[198:199], v92 offset:1056
  ds_read_b64_tr_b16 a[200:201], v92 offset:64
  ds_read_b64_tr_b16 a[202:203], v92 offset:1088
  ds_read_b64_tr_b16 a[204:205], v92 offset:96
  ds_read_b64_tr_b16 a[206:207], v92 offset:1120
  s_mov_b64 exec, s[78:79]
  ds_read_b128 a[192:195], v89 offset:0
  ds_read_b128 a[196:199], v89 offset:64
  ds_read_b128 a[200:203], v89 offset:2048
  ds_read_b128 a[204:207], v89 offset:2112
  s_mov_b64 exec, -1
  s_add_u32 m0, s3, 26624
  s_add_u32 s84, s84, 40960
  buffer_load_dwordx4 v2, s[8:11], s84 offen offset:0  lds
  buffer_load_dwordx4 v2, s[12:15], s84 offen offset:1024  lds
  s_addk_i32 s35, 128
  s_cmpk_eq_u32 s35, 1280
  s_cselect_b32 s35, 0, s35
  s_waitcnt lgkmcnt(0)
  buffer_store_dwordx4 a[192:195], v20, s[24:27], s73 offen sc0 sc1
  buffer_store_dwordx4 a[196:199], v20, s[24:27], s74 offen sc0 sc1
  buffer_store_dwordx4 a[200:203], v20, s[24:27], s75 offen sc0 sc1
  buffer_store_dwordx4 a[204:207], v20, s[24:27], s76 offen sc0 sc1
  s_add_u32 m0, s3, 98304
  s_add_u32 s84, s88, s35
  buffer_load_dwordx4 v2, s[8:11], s84 offen offset:0  lds
  buffer_load_dwordx4 v2, s[12:15], s84 offen offset:1024  lds
  s_lshl_b32 s43, s29, 11
  s_add_u32 s43, s43, 12910592
  s_cmp_eq_u32 s28, 0
  s_cselect_b32 s43, s43, 0x10000000
  s_cselect_b32 s44, s32, 0
  v_and_b32_e32 v54, 15, v1
  v_lshlrev_b32_e64 v54, 7, v54
  buffer_load_dword v55, v54, s[24:27], s43 offen sc0 sc1
  s_add_u32 m0, s3, 100352
  s_add_u32 s84, s84, 40960
  buffer_load_dwordx4 v2, s[8:11], s84 offen offset:0  lds
  buffer_load_dwordx4 v2, s[12:15], s84 offen offset:1024  lds
  s_addk_i32 s35, 128
  s_cmpk_eq_u32 s35, 1280
  s_cselect_b32 s35, 0, s35
  s_add_u32 m0, s3, 114688
  s_add_u32 s84, s88, s35
  buffer_load_dwordx4 v2, s[8:11], s84 offen offset:0  lds
  buffer_load_dwordx4 v2, s[12:15], s84 offen offset:1024  lds
  s_add_u32 m0, s3, 116736
  s_add_u32 s84, s84, 40960
  buffer_load_dwordx4 v2, s[8:11], s84 offen offset:0  lds
  buffer_load_dwordx4 v2, s[12:15], s84 offen offset:1024  lds
  s_addk_i32 s35, 128
  s_cmpk_eq_u32 s35, 1280
  s_cselect_b32 s35, 0, s35
  s_add_u32 m0, s3, 131072
  s_add_u32 s84, s88, s35
  buffer_load_dwordx4 v2, s[8:11], s84 offen offset:0  lds
  buffer_load_dwordx4 v2, s[12:15], s84 offen offset:1024  lds
  s_add_u32 m0, s3, 133120
  s_add_u32 s84, s84, 40960
  buffer_load_dwordx4 v2, s[8:11], s84 offen offset:0  lds
  buffer_load_dwordx4 v2, s[12:15], s84 offen offset:1024  lds
  s_addk_i32 s35, 128
  s_cmpk_eq_u32 s35, 1280
  s_cselect_b32 s35, 0, s35
  s_waitcnt vmcnt(10)
  v_cmp_ne_u32 vcc, s44, v55
  s_cbranch_vccnz L_p32
L_p3r2:
  s_barrier
  buffer_load_dwordx4 v[96:99], v20, s[24:27], s40 offen offset:0 sc0 sc1
  buffer_load_dwordx4 v[100:103], v20, s[24:27], s40 offen offset:1024 sc0 sc1
  buffer_load_dwordx4 v[104:107], v20, s[24:27], s40 offen offset:2048 sc0 sc1
  buffer_load_dwordx4 v[108:111], v20, s[24:27], s40 offen offset:3072 sc0 sc1
  s_add_u32 s40, s40, 4096
  s_cmp_eq_u32 s40, s42
  s_cselect_b32 s40, s41, s40
  buffer_load_dwordx4 v[112:115], v20, s[24:27], s40 offen offset:0 sc0 sc1
  buffer_load_dwordx4 v[116:119], v20, s[24:27], s40 offen offset:1024 sc0 sc1
  buffer_load_dwordx4 v[120:123], v20, s[24:27], s40 offen offset:2048 sc0 sc1
  buffer_load_dwordx4 v[124:127], v20, s[24:27], s40 offen offset:3072 sc0 sc1
  s_add_u32 s40, s40, 4096
  s_cmp_eq_u32 s40, s42
  s_cselect_b32 s40, s41, s40
.p2align 3
  s_barrier
  ds_read_b128 a[160:163], v9 offset:0
  ds_read_b128 a[164:167], v9 offset:1024
  ds_read_b128 a[168:171], v9 offset:2048
  ds_read_b128 a[172:175], v9 offset:3072
  ds_read_b128 a[176:179], v10 offset:0
  ds_read_b128 a[180:183], v10 offset:1024
  ds_read_b128 a[184:187], v10 offset:2048
  s_waitcnt vmcnt(7) lgkmcnt(4)
  v_mfma_f32_32x32x16_bf16 a[0:15], v[96:99], a[160:163], 0
  ds_read_b128 a[188:191], v10 offset:3072
  buffer_load_dwordx4 v[128:131], v20, s[24:27], s40 offen offset:0 sc0 sc1
  v_mfma_f32_32x32x16_bf16 a[16:31], v[96:99], a[164:167], 0
  ds_read_b128 a[160:163], v11 offset:0
  buffer_load_dwordx4 v[132:135], v20, s[24:27], s40 offen offset:1024 sc0 sc1
  v_mfma_f32_32x32x16_bf16 a[32:47], v[96:99], a[168:171], 0
  ds_read_b128 a[164:167], v11 offset:1024
  s_waitcnt lgkmcnt(4)
  buffer_load_dwordx4 v[136:139], v20, s[24:27], s40 offen offset:2048 sc0 sc1
  v_mfma_f32_32x32x16_bf16 a[48:63], v[96:99], a[172:175], 0
  s_waitcnt vmcnt(9)
  ds_read_b128 a[168:171], v11 offset:2048
  buffer_load_dwordx4 v[140:143], v20, s[24:27], s40 offen offset:3072 sc0 sc1
  s_add_u32 s40, s40, 4096
  s_cmp_eq_u32 s40, s42
  s_cselect_b32 s40, s41, s40
  v_mfma_f32_32x32x16_bf16 a[0:15], v[100:103], a[176:179], a[0:15]
  ds_read_b128 a[172:175], v11 offset:3072
  buffer_load_dwordx4 v[144:147], v20, s[24:27], s40 offen offset:0 sc0 sc1
  v_mfma_f32_32x32x16_bf16 a[16:31], v[100:103], a[180:183], a[16:31]
  ds_read_b128 a[176:179], v12 offset:0
  s_waitcnt lgkmcnt(4)
  buffer_load_dwordx4 v[148:151], v20, s[24:27], s40 offen offset:1024 sc0 sc1
  v_mfma_f32_32x32x16_bf16 a[32:47], v[100:103], a[184:187], a[32:47]
  ds_read_b128 a[180:183], v12 offset:1024
  buffer_load_dwordx4 v[152:155], v20, s[24:27], s40 offen offset:2048 sc0 sc1
  v_mfma_f32_32x32x16_bf16 a[48:63], v[100:103], a[188:191], a[48:63]
  s_waitcnt vmcnt(12)
  ds_read_b128 a[184:187], v12 offset:2048
  buffer_load_dwordx4 v[156:159], v20, s[24:27], s40 offen offset:3072 sc0 sc1
  s_add_u32 s40, s40, 4096
  s_cmp_eq_u32 s40, s42
  s_cselect_b32 s40, s41, s40
  v_mfma_f32_32x32x16_bf16 a[0:15], v[104:107], a[160:163], a[0:15]
  ds_read_b128 a[188:191], v12 offset:3072
  s_waitcnt lgkmcnt(4)
  buffer_load_dwordx4 v[160:163], v20, s[24:27], s40 offen offset:0 sc0 sc1
  s_lshr_b32 s85, s2, 2
  s_mul_i32 s85, s85, 112
  s_lshl2_add_u32 s85, s2, s85
  s_add_u32 s85, s85, 13008896
  s_cmp_eq_u32 s28, 0
  s_cselect_b32 s85, s85, 0x10000000
  v_mov_b32_e32 v56, 0
  v_mov_b32_e32 v57, s32
  v_mfma_f32_32x32x16_bf16 a[16:31], v[104:107], a[164:167], a[16:31]
  buffer_load_dwordx4 v[164:167], v20, s[24:27], s40 offen offset:1024 sc0 sc1
  v_mfma_f32_32x32x16_bf16 a[32:47], v[104:107], a[168:171], a[32:47]
  s_waitcnt lgkmcnt(0)
  s_barrier
  ds_read_b128 a[160:163], v9 offset:16384
  ds_read_b128 a[164:167], v9 offset:17408
  buffer_store_dword v57, v56, s[24:27], s85 offen sc0 sc1
  v_mfma_f32_32x32x16_bf16 a[48:63], v[104:107], a[172:175], a[48:63]
  s_add_u32 m0, s3, 40960
  s_add_u32 s84, s88, s35
  s_waitcnt vmcnt(15)
  ds_read_b128 a[168:171], v9 offset:18432
  buffer_load_dwordx4 v2, s[8:11], s84 offen offset:0  lds
  v_mfma_f32_32x32x16_bf16 a[0:15], v[108:111], a[176:179], a[0:15]
  ds_read_b128 a[172:175], v9 offset:19456
  buffer_load_dwordx4 v[168:171], v20, s[24:27], s40 offen offset:2048 sc0 sc1
  v_mfma_f32_32x32x16_bf16 a[16:31], v[108:111], a[180:183], a[16:31]
  ds_read_b128 a[176:179], v10 offset:16384
  v_mfma_f32_32x32x16_bf16 a[32:47], v[108:111], a[184:187], a[32:47]
  ds_read_b128 a[180:183], v10 offset:17408
  s_waitcnt lgkmcnt(4)
  buffer_load_dwordx4 v2, s[12:15], s84 offen offset:1024  lds
  v_mfma_f32_32x32x16_bf16 a[48:63], v[108:111], a[188:191], a[48:63]
  s_waitcnt vmcnt(17)
  ds_read_b128 a[184:187], v10 offset:18432
  v_mfma_f32_32x32x16_bf16 a[0:15], v[112:115], a[160:163], a[0:15]
  ds_read_b128 a[188:191], v10 offset:19456
  buffer_load_dwordx4 v[172:175], v20, s[24:27], s40 offen offset:3072 sc0 sc1
  s_add_u32 s40, s40, 4096
  s_cmp_eq_u32 s40, s42
  s_cselect_b32 s40, s41, s40
  v_mfma_f32_32x32x16_bf16 a[16:31], v[112:115], a[164:167], a[16:31]
  s_add_u32 m0, s3, 43008
  s_add_u32 s84, s84, 40960
  ds_read_b128 a[160:163], v11 offset:16384
  s_waitcnt lgkmcnt(4)
  buffer_load_dwordx4 v2, s[8:11], s84 offen offset:0  lds
  v_mfma_f32_32x32x16_bf16 a[32:47], v[112:115], a[168:171], a[32:47]
  ds_read_b128 a[164:167], v11 offset:17408
  v_mfma_f32_32x32x16_bf16 a[48:63], v[112:115], a[172:175], a[48:63]
  s_waitcnt vmcnt(18)
  ds_read_b128 a[168:171], v11 offset:18432
  buffer_load_dwordx4 v[176:179], v20, s[24:27], s40 offen offset:0 sc0 sc1
  v_mfma_f32_32x32x16_bf16 a[0:15], v[116:119], a[176:179], a[0:15]
  ds_read_b128 a[172:175], v11 offset:19456
  s_waitcnt lgkmcnt(4)
  v_mfma_f32_32x32x16_bf16 a[16:31], v[116:119], a[180:183], a[16:31]
  ds_read_b128 a[176:179], v12 offset:16384
  buffer_load_dwordx4 v2, s[12:15], s84 offen offset:1024  lds
  s_addk_i32 s35, 128
  s_cmpk_eq_u32 s35, 1280
  s_cselect_b32 s35, 0, s35
  v_mfma_f32_32x32x16_bf16 a[32:47], v[116:119], a[184:187], a[32:47]
  ds_read_b128 a[180:183], v12 offset:17408
  buffer_load_dwordx4 v[180:183], v20, s[24:27], s40 offen offset:1024 sc0 sc1
  v_mfma_f32_32x32x16_bf16 a[48:63], v[116:119], a[188:191], a[48:63]
  s_waitcnt vmcnt(20)
  ds_read_b128 a[184:187], v12 offset:18432
  s_waitcnt lgkmcnt(4)
  v_mfma_f32_32x32x16_bf16 a[0:15], v[120:123], a[160:163], a[0:15]
  ds_read_b128 a[188:191], v12 offset:19456
  buffer_load_dwordx4 v[184:187], v20, s[24:27], s40 offen offset:2048 sc0 sc1
  v_mfma_f32_32x32x16_bf16 a[16:31], v[120:123], a[164:167], a[16:31]
  v_mfma_f32_32x32x16_bf16 a[32:47], v[120:123], a[168:171], a[32:47]
  s_waitcnt lgkmcnt(0)
  s_barrier
  ds_read_b128 a[160:163], v5 offset:0
  ds_read_b128 a[164:167], v5 offset:1024
  v_mfma_f32_32x32x16_bf16 a[48:63], v[120:123], a[172:175], a[48:63]
  s_add_u32 m0, s3, 57344
  s_add_u32 s84, s88, s35
  s_waitcnt vmcnt(20)
  ds_read_b128 a[168:171], v5 offset:2048
  buffer_load_dwordx4 v2, s[8:11], s84 offen offset:0  lds
  v_mfma_f32_32x32x16_bf16 a[0:15], v[124:127], a[176:179], a[0:15]
  ds_read_b128 a[172:175], v5 offset:3072
  buffer_load_dwordx4 v[188:191], v20, s[24:27], s40 offen offset:3072 sc0 sc1
  s_add_u32 s40, s40, 4096
  s_cmp_eq_u32 s40, s42
  s_cselect_b32 s40, s41, s40
  v_mfma_f32_32x32x16_bf16 a[16:31], v[124:127], a[180:183], a[16:31]
  ds_read_b128 a[176:179], v6 offset:0
  s_waitcnt lgkmcnt(4)
  v_mfma_f32_32x32x16_bf16 a[32:47], v[124:127], a[184:187], a[32:47]
  ds_read_b128 a[180:183], v6 offset:1024
  buffer_load_dwordx4 v2, s[12:15], s84 offen offset:1024  lds
  v_mfma_f32_32x32x16_bf16 a[48:63], v[124:127], a[188:191], a[48:63]
  s_waitcnt vmcnt(22)
  ds_read_b128 a[184:187], v6 offset:2048
  v_mfma_f32_32x32x16_bf16 a[0:15], v[128:131], a[160:163], a[0:15]
  ds_read_b128 a[188:191], v6 offset:3072
  s_waitcnt lgkmcnt(4)
  buffer_load_dwordx4 v[192:195], v20, s[24:27], s40 offen offset:0 sc0 sc1
  v_mfma_f32_32x32x16_bf16 a[16:31], v[128:131], a[164:167], a[16:31]
  s_add_u32 m0, s3, 59392
  s_add_u32 s84, s84, 40960
  ds_read_b128 a[160:163], v7 offset:0
  buffer_load_dwordx4 v2, s[8:11], s84 offen offset:0  lds
  v_mfma_f32_32x32x16_bf16 a[32:47], v[128:131], a[168:171], a[32:47]
  ds_read_b128 a[164:167], v7 offset:1024
  v_mfma_f32_32x32x16_bf16 a[48:63], v[128:131], a[172:175], a[48:63]
  s_waitcnt vmcnt(23)
  ds_read_b128 a[168:171], v7 offset:2048
  s_waitcnt lgkmcnt(4)
  buffer_load_dwordx4 v[196:199], v20, s[24:27], s40 offen offset:1024 sc0 sc1
  v_mfma_f32_32x32x16_bf16 a[0:15], v[132:135], a[176:179], a[0:15]
  ds_read_b128 a[172:175], v7 offset:3072
  v_mfma_f32_32x32x16_bf16 a[16:31], v[132:135], a[180:183], a[16:31]
  ds_read_b128 a[176:179], v8 offset:0
  buffer_load_dwordx4 v2, s[12:15], s84 offen offset:1024  lds
  s_addk_i32 s35, 128
  s_cmpk_eq_u32 s35, 1280
  s_cselect_b32 s35, 0, s35
  v_mfma_f32_32x32x16_bf16 a[32:47], v[132:135], a[184:187], a[32:47]
  ds_read_b128 a[180:183], v8 offset:1024
  s_waitcnt lgkmcnt(4)
  buffer_load_dwordx4 v[200:203], v20, s[24:27], s40 offen offset:2048 sc0 sc1
  v_mfma_f32_32x32x16_bf16 a[48:63], v[132:135], a[188:191], a[48:63]
  s_waitcnt vmcnt(25)
  ds_read_b128 a[184:187], v8 offset:2048
  v_mfma_f32_32x32x16_bf16 a[0:15], v[136:139], a[160:163], a[0:15]
  ds_read_b128 a[188:191], v8 offset:3072
  buffer_load_dwordx4 v[204:207], v20, s[24:27], s40 offen offset:3072 sc0 sc1
  s_add_u32 s40, s40, 4096
  s_cmp_eq_u32 s40, s42
  s_cselect_b32 s40, s41, s40
  v_mfma_f32_32x32x16_bf16 a[16:31], v[136:139], a[164:167], a[16:31]
  s_waitcnt lgkmcnt(3)
  v_mfma_f32_32x32x16_bf16 a[32:47], v[136:139], a[168:171], a[32:47]
  s_waitcnt lgkmcnt(0)
  s_barrier
  ds_read_b128 a[160:163], v5 offset:24576
  ds_read_b128 a[164:167], v5 offset:25600
  v_mfma_f32_32x32x16_bf16 a[48:63], v[136:139], a[172:175], a[48:63]
  s_add_u32 m0, s3, 0
  s_add_u32 s84, s88, s35
  s_waitcnt vmcnt(25)
  ds_read_b128 a[168:171], v5 offset:26624
  buffer_load_dwordx4 v2, s[8:11], s84 offen offset:0  lds
  v_mfma_f32_32x32x16_bf16 a[0:15], v[140:143], a[176:179], a[0:15]
  ds_read_b128 a[172:175], v5 offset:27648
  buffer_load_dwordx4 v[208:211], v20, s[24:27], s40 offen offset:0 sc0 sc1
  v_mfma_f32_32x32x16_bf16 a[16:31], v[140:143], a[180:183], a[16:31]
  ds_read_b128 a[176:179], v6 offset:24576
  v_mfma_f32_32x32x16_bf16 a[32:47], v[140:143], a[184:187], a[32:47]
  ds_read_b128 a[180:183], v6 offset:25600
  buffer_load_dwordx4 v2, s[12:15], s84 offen offset:1024  lds
  v_mfma_f32_32x32x16_bf16 a[48:63], v[140:143], a[188:191], a[48:63]
  s_waitcnt vmcnt(27)
  ds_read_b128 a[184:187], v6 offset:26624
  s_waitcnt lgkmcnt(4)
  v_mfma_f32_32x32x16_bf16 a[0:15], v[144:147], a[160:163], a[0:15]
  ds_read_b128 a[188:191], v6 offset:27648
  buffer_load_dwordx4 v[212:215], v20, s[24:27], s40 offen offset:1024 sc0 sc1
  v_mfma_f32_32x32x16_bf16 a[16:31], v[144:147], a[164:167], a[16:31]
  s_add_u32 m0, s3, 2048
  s_add_u32 s84, s84, 40960
  ds_read_b128 a[160:163], v7 offset:24576
  buffer_load_dwordx4 v2, s[8:11], s84 offen offset:0  lds
  v_mfma_f32_32x32x16_bf16 a[32:47], v[144:147], a[168:171], a[32:47]
  ds_read_b128 a[164:167], v7 offset:25600
  s_waitcnt lgkmcnt(4)
  v_mfma_f32_32x32x16_bf16 a[48:63], v[144:147], a[172:175], a[48:63]
  s_waitcnt vmcnt(28)
  ds_read_b128 a[168:171], v7 offset:26624
  buffer_load_dwordx4 v[216:219], v20, s[24:27], s40 offen offset:2048 sc0 sc1
  v_mfma_f32_32x32x16_bf16 a[0:15], v[148:151], a[176:179], a[0:15]
  ds_read_b128 a[172:175], v7 offset:27648
  v_mfma_f32_32x32x16_bf16 a[16:31], v[148:151], a[180:183], a[16:31]
  ds_read_b128 a[176:179], v8 offset:24576
  s_waitcnt lgkmcnt(4)
  buffer_load_dwordx4 v2, s[12:15], s84 offen offset:1024  lds
  s_addk_i32 s35, 128
  s_cmpk_eq_u32 s35, 1280
  s_cselect_b32 s35, 0, s35
  v_mfma_f32_32x32x16_bf16 a[32:47], v[148:151], a[184:187], a[32:47]
  ds_read_b128 a[180:183], v8 offset:25600
  buffer_load_dwordx4 v[220:223], v20, s[24:27], s40 offen offset:3072 sc0 sc1
  s_add_u32 s40, s40, 4096
  s_cmp_eq_u32 s40, s42
  s_cselect_b32 s40, s41, s40
  v_mfma_f32_32x32x16_bf16 a[48:63], v[148:151], a[188:191], a[48:63]
  s_waitcnt vmcnt(30)
  ds_read_b128 a[184:187], v8 offset:26624
  v_mfma_f32_32x32x16_bf16 a[0:15], v[152:155], a[160:163], a[0:15]
  ds_read_b128 a[188:191], v8 offset:27648
  s_waitcnt lgkmcnt(4)
  buffer_load_dwordx4 v[224:227], v20, s[24:27], s40 offen offset:0 sc0 sc1
  v_mfma_f32_32x32x16_bf16 a[16:31], v[152:155], a[164:167], a[16:31]
  v_mfma_f32_32x32x16_bf16 a[32:47], v[152:155], a[168:171], a[32:47]
  s_waitcnt lgkmcnt(0)
  s_barrier
  ds_read_b128 a[160:163], v48 offset:0
  ds_read_b128 a[164:167], v48 offset:1024
  v_mfma_f32_32x32x16_bf16 a[48:63], v[152:155], a[172:175], a[48:63]
  s_mul_i32 s84, s35, 1728
  s_add_u32 m0, s3, 24576
  s_add_u32 s84, s84, s94
  s_waitcnt vmcnt(30)
  ds_read_b128 a[168:171], v48 offset:2048
  buffer_load_dwordx4 v3, s[16:19], s84 offen offset:0  lds
  v_mfma_f32_32x32x16_bf16 a[0:15], v[156:159], a[176:179], a[0:15]
  ds_read_b128 a[172:175], v48 offset:3072
  s_mov_b64 exec, 1023
  buffer_load_dword v91, v90, s[16:19], s94 offen
  buffer_load_dword v91, v90, s[20:23], s94 offen offset:2048
  s_mov_b64 exec, -1
  buffer_load_dwordx4 v[228:231], v20, s[24:27], s40 offen offset:1024 sc0 sc1
  v_mfma_f32_32x32x16_bf16 a[16:31], v[156:159], a[180:183], a[16:31]
  ds_read_b128 a[176:179], v49 offset:0
  v_mfma_f32_32x32x16_bf16 a[32:47], v[156:159], a[184:187], a[32:47]
  ds_read_b128 a[180:183], v49 offset:1024
  s_waitcnt lgkmcnt(4)
  buffer_load_dwordx4 v4, s[16:19], s84 offen offset:1024  lds
  v_mfma_f32_32x32x16_bf16 a[48:63], v[156:159], a[188:191], a[48:63]
  s_waitcnt vmcnt(34)
  ds_read_b128 a[184:187], v49 offset:2048
  v_mfma_f32_32x32x16_bf16 a[0:15], v[160:163], a[160:163], a[0:15]
  ds_read_b128 a[188:191], v49 offset:3072
  buffer_load_dwordx4 v[232:235], v20, s[24:27], s40 offen offset:2048 sc0 sc1
  v_mfma_f32_32x32x16_bf16 a[16:31], v[160:163], a[164:167], a[16:31]
  ds_read_b128 a[160:163], v50 offset:0
  s_waitcnt lgkmcnt(4)
  buffer_load_dwordx4 v3, s[20:23], s84 offen offset:2048  lds
  v_mfma_f32_32x32x16_bf16 a[32:47], v[160:163], a[168:171], a[32:47]
  ds_read_b128 a[164:167], v50 offset:1024
  v_mfma_f32_32x32x16_bf16 a[48:63], v[160:163], a[172:175], a[48:63]
  s_waitcnt vmcnt(35)
  ds_read_b128 a[168:171], v50 offset:2048
  buffer_load_dwordx4 v[236:239], v20, s[24:27], s40 offen offset:3072 sc0 sc1
  s_add_u32 s40, s40, 4096
  s_cmp_eq_u32 s40, s42
  s_cselect_b32 s40, s41, s40
  v_mfma_f32_32x32x16_bf16 a[0:15], v[164:167], a[176:179], a[0:15]
  ds_read_b128 a[172:175], v50 offset:3072
  s_waitcnt lgkmcnt(4)
  v_mfma_f32_32x32x16_bf16 a[16:31], v[164:167], a[180:183], a[16:31]
  ds_read_b128 a[176:179], v51 offset:0
  buffer_load_dwordx4 v4, s[20:23], s84 offen offset:3072  lds
  s_addk_i32 s35, 128
  s_cmpk_eq_u32 s35, 1280
  s_cselect_b32 s35, 0, s35
  v_mfma_f32_32x32x16_bf16 a[32:47], v[164:167], a[184:187], a[32:47]
  ds_read_b128 a[180:183], v51 offset:1024
  buffer_load_dwordx4 v[240:243], v20, s[24:27], s40 offen offset:0 sc0 sc1
  v_mfma_f32_32x32x16_bf16 a[48:63], v[164:167], a[188:191], a[48:63]
  s_waitcnt vmcnt(35)
  ds_read_b128 a[184:187], v51 offset:2048
  s_waitcnt lgkmcnt(4)
  v_mfma_f32_32x32x16_bf16 a[0:15], v[168:171], a[160:163], a[0:15]
  ds_read_b128 a[188:191], v51 offset:3072
  buffer_load_dwordx4 v[244:247], v20, s[24:27], s40 offen offset:1024 sc0 sc1
  v_mfma_f32_32x32x16_bf16 a[16:31], v[168:171], a[164:167], a[16:31]
  v_mfma_f32_32x32x16_bf16 a[32:47], v[168:171], a[168:171], a[32:47]
  s_waitcnt lgkmcnt(0)
  s_barrier
  ds_read_b128 a[160:163], v48 offset:16384
  ds_read_b128 a[164:167], v48 offset:17408
  v_mfma_f32_32x32x16_bf16 a[48:63], v[168:171], a[172:175], a[48:63]
  s_waitcnt vmcnt(34)
  ds_read_b128 a[168:171], v48 offset:18432
  buffer_load_dwordx4 v[248:251], v20, s[24:27], s40 offen offset:2048 sc0 sc1
  v_mfma_f32_32x32x16_bf16 a[0:15], v[172:175], a[176:179], a[0:15]
  ds_read_b128 a[172:175], v48 offset:19456
  v_mfma_f32_32x32x16_bf16 a[16:31], v[172:175], a[180:183], a[16:31]
  ds_read_b128 a[176:179], v49 offset:16384
  s_waitcnt lgkmcnt(4)
  v_mfma_f32_32x32x16_bf16 a[32:47], v[172:175], a[184:187], a[32:47]
  ds_read_b128 a[180:183], v49 offset:17408
  v_mfma_f32_32x32x16_bf16 a[48:63], v[172:175], a[188:191], a[48:63]
  s_waitcnt vmcnt(33)
  ds_read_b128 a[184:187], v49 offset:18432
  v_mfma_f32_32x32x16_bf16 a[0:15], v[176:179], a[160:163], a[0:15]
  ds_read_b128 a[188:191], v49 offset:19456
  s_waitcnt lgkmcnt(4)
  v_mfma_f32_32x32x16_bf16 a[16:31], v[176:179], a[164:167], a[16:31]
  ds_read_b128 a[160:163], v50 offset:16384
  v_mfma_f32_32x32x16_bf16 a[32:47], v[176:179], a[168:171], a[32:47]
  ds_read_b128 a[164:167], v50 offset:17408
  buffer_load_dwordx4 v[252:255], v20, s[24:27], s40 offen offset:3072 sc0 sc1
  v_mfma_f32_32x32x16_bf16 a[48:63], v[176:179], a[172:175], a[48:63]
  s_waitcnt vmcnt(32)
  ds_read_b128 a[168:171], v50 offset:18432
  s_waitcnt lgkmcnt(4)
  v_mfma_f32_32x32x16_bf16 a[0:15], v[180:183], a[176:179], a[0:15]
  ds_read_b128 a[172:175], v50 offset:19456
  v_mfma_f32_32x32x16_bf16 a[16:31], v[180:183], a[180:183], a[16:31]
  ds_read_b128 a[176:179], v51 offset:16384
  v_mfma_f32_32x32x16_bf16 a[32:47], v[180:183], a[184:187], a[32:47]
  ds_read_b128 a[180:183], v51 offset:17408
  s_waitcnt lgkmcnt(4)
  v_mfma_f32_32x32x16_bf16 a[48:63], v[180:183], a[188:191], a[48:63]
  s_waitcnt vmcnt(31)
  ds_read_b128 a[184:187], v51 offset:18432
  v_mfma_f32_32x32x16_bf16 a[0:15], v[184:187], a[160:163], a[0:15]
  ds_read_b128 a[188:191], v51 offset:19456
  v_mfma_f32_32x32x16_bf16 a[16:31], v[184:187], a[164:167], a[16:31]
  s_waitcnt lgkmcnt(3)
  v_mfma_f32_32x32x16_bf16 a[32:47], v[184:187], a[168:171], a[32:47]
  s_waitcnt lgkmcnt(0)
  s_barrier
  ds_read_b128 a[160:163], v48 offset:32768
  ds_read_b128 a[164:167], v48 offset:33792
  v_mfma_f32_32x32x16_bf16 a[48:63], v[184:187], a[172:175], a[48:63]
  s_waitcnt vmcnt(29)
  ds_read_b128 a[168:171], v48 offset:34816
  v_mfma_f32_32x32x16_bf16 a[0:15], v[188:191], a[176:179], a[0:15]
  ds_read_b128 a[172:175], v48 offset:35840
  v_mfma_f32_32x32x16_bf16 a[16:31], v[188:191], a[180:183], a[16:31]
  ds_read_b128 a[176:179], v49 offset:32768
  v_mfma_f32_32x32x16_bf16 a[32:47], v[188:191], a[184:187], a[32:47]
  ds_read_b128 a[180:183], v49 offset:33792
  v_mfma_f32_32x32x16_bf16 a[48:63], v[188:191], a[188:191], a[48:63]
  s_waitcnt vmcnt(27)
  ds_read_b128 a[184:187], v49 offset:34816
  s_waitcnt lgkmcnt(4)
  v_mfma_f32_32x32x16_bf16 a[0:15], v[192:195], a[160:163], a[0:15]
  ds_read_b128 a[188:191], v49 offset:35840
  v_mfma_f32_32x32x16_bf16 a[16:31], v[192:195], a[164:167], a[16:31]
  ds_read_b128 a[160:163], v50 offset:32768
  v_mfma_f32_32x32x16_bf16 a[32:47], v[192:195], a[168:171], a[32:47]
  ds_read_b128 a[164:167], v50 offset:33792
  s_waitcnt lgkmcnt(4)
  v_mfma_f32_32x32x16_bf16 a[48:63], v[192:195], a[172:175], a[48:63]
  s_waitcnt vmcnt(25)
  ds_read_b128 a[168:171], v50 offset:34816
  v_mfma_f32_32x32x16_bf16 a[0:15], v[196:199], a[176:179], a[0:15]
  ds_read_b128 a[172:175], v50 offset:35840
  v_mfma_f32_32x32x16_bf16 a[16:31], v[196:199], a[180:183], a[16:31]
  ds_read_b128 a[176:179], v51 offset:32768
  s_waitcnt lgkmcnt(4)
  v_mfma_f32_32x32x16_bf16 a[32:47], v[196:199], a[184:187], a[32:47]
  ds_read_b128 a[180:183], v51 offset:33792
  s_mov_b32 s87, 13008896
  s_cmp_eq_u32 s28, 0
  s_cselect_b32 s87, s87, 0x10000000
  s_cselect_b32 s77, s32, 0
  v_lshlrev_b32_e64 v58, 7, v1
  v_mfma_f32_32x32x16_bf16 a[48:63], v[196:199], a[188:191], a[48:63]
  s_waitcnt vmcnt(23)
  ds_read_b128 a[184:187], v51 offset:34816
  v_mfma_f32_32x32x16_bf16 a[0:15], v[200:203], a[160:163], a[0:15]
  ds_read_b128 a[188:191], v51 offset:35840
  s_waitcnt lgkmcnt(4)
  buffer_load_dwordx4 v[60:63], v58, s[24:27], s87 offen sc0 sc1
  v_mfma_f32_32x32x16_bf16 a[16:31], v[200:203], a[164:167], a[16:31]
  v_mfma_f32_32x32x16_bf16 a[32:47], v[200:203], a[168:171], a[32:47]
  s_waitcnt lgkmcnt(0)
  s_barrier
  ds_read_b128 a[160:163], v9 offset:0
  ds_read_b128 a[164:167], v9 offset:1024
  v_mfma_f32_32x32x16_bf16 a[48:63], v[200:203], a[172:175], a[48:63]
  s_waitcnt vmcnt(23)
  ds_read_b128 a[168:171], v9 offset:2048
  v_mfma_f32_32x32x16_bf16 a[0:15], v[204:207], a[176:179], a[0:15]
  ds_read_b128 a[172:175], v9 offset:3072
  v_mfma_f32_32x32x16_bf16 a[16:31], v[204:207], a[180:183], a[16:31]
  ds_read_b128 a[176:179], v10 offset:0
  v_mfma_f32_32x32x16_bf16 a[32:47], v[204:207], a[184:187], a[32:47]
  ds_read_b128 a[180:183], v10 offset:1024
  s_waitcnt lgkmcnt(4)
  v_mfma_f32_32x32x16_bf16 a[48:63], v[204:207], a[188:191], a[48:63]
  s_waitcnt vmcnt(21)
  ds_read_b128 a[184:187], v10 offset:2048
  v_mfma_f32_32x32x16_bf16 a[0:15], v[208:211], a[160:163], a[0:15]
  ds_read_b128 a[188:191], v10 offset:3072
  v_mfma_f32_32x32x16_bf16 a[16:31], v[208:211], a[164:167], a[16:31]
  ds_read_b128 a[160:163], v11 offset:0
  s_waitcnt lgkmcnt(4)
  v_mfma_f32_32x32x16_bf16 a[32:47], v[208:211], a[168:171], a[32:47]
  ds_read_b128 a[164:167], v11 offset:1024
  v_mfma_f32_32x32x16_bf16 a[48:63], v[208:211], a[172:175], a[48:63]
  s_waitcnt vmcnt(19)
  ds_read_b128 a[168:171], v11 offset:2048
  v_mfma_f32_32x32x16_bf16 a[0:15], v[212:215], a[176:179], a[0:15]
  ds_read_b128 a[172:175], v11 offset:3072
  s_waitcnt lgkmcnt(4)
  v_mfma_f32_32x32x16_bf16 a[16:31], v[212:215], a[180:183], a[16:31]
  ds_read_b128 a[176:179], v12 offset:0
  v_mfma_f32_32x32x16_bf16 a[32:47], v[212:215], a[184:187], a[32:47]
  ds_read_b128 a[180:183], v12 offset:1024
  v_mfma_f32_32x32x16_bf16 a[48:63], v[212:215], a[188:191], a[48:63]
  s_waitcnt vmcnt(17)
  ds_read_b128 a[184:187], v12 offset:2048
  s_waitcnt vmcnt(0) lgkmcnt(4)
  v_bitop3_b32 v60, v60, v61, s77 bitop3:0x7e
  v_bitop3_b32 v62, v62, v63, s77 bitop3:0x7e
  v_or_b32_e32 v60, v60, v62
  v_cmp_ne_u32 vcc, 0, v60
  v_mfma_f32_32x32x16_bf16 a[0:15], v[216:219], a[160:163], a[0:15]
  ds_read_b128 a[188:191], v12 offset:3072
  v_mfma_f32_32x32x16_bf16 a[16:31], v[216:219], a[164:167], a[16:31]
  s_cbranch_vccnz L_f22
L_f2r2:
  v_mfma_f32_32x32x16_bf16 a[32:47], v[216:219], a[168:171], a[32:47]
  s_waitcnt lgkmcnt(0)
  s_barrier
  ds_read_b128 a[160:163], v9 offset:16384
  ds_read_b128 a[164:167], v9 offset:17408
  v_readlane_b32 s96, v21, 0
  v_mfma_f32_32x32x16_bf16 a[48:63], v[216:219], a[172:175], a[48:63]
  s_mul_i32 s84, s35, 1728
  s_add_u32 m0, s3, 40960
  s_add_u32 s84, s84, s94
  ds_read_b128 a[168:171], v9 offset:18432
  buffer_load_dwordx4 v3, s[16:19], s84 offen offset:0  lds
  v_mfma_f32_32x32x16_bf16 a[0:15], v[220:223], a[176:179], a[0:15]
  s_add_u32 m0, s97, 81920
  ds_read_b128 a[172:175], v9 offset:19456
  buffer_load_dwordx4 v20, s[24:27], s96 offen offset:0 sc0 sc1 lds
  v_mfma_f32_32x32x16_bf16 a[16:31], v[220:223], a[180:183], a[16:31]
  s_add_u32 m0, s3, 40960
  ds_read_b128 a[176:179], v10 offset:16384
  s_waitcnt lgkmcnt(4)
  buffer_load_dwordx4 v4, s[16:19], s84 offen offset:1024  lds
  v_mfma_f32_32x32x16_bf16 a[32:47], v[220:223], a[184:187], a[32:47]
  ds_read_b128 a[180:183], v10 offset:17408
  v_mfma_f32_32x32x16_bf16 a[48:63], v[220:223], a[188:191], a[48:63]
  s_add_u32 m0, s97, 81920
  ds_read_b128 a[184:187], v10 offset:18432
  buffer_load_dwordx4 v20, s[24:27], s96 offen offset:1024 sc0 sc1 lds
  v_mfma_f32_32x32x16_bf16 a[0:15], v[224:227], a[160:163], a[0:15]
  ds_read_b128 a[188:191], v10 offset:19456
  s_waitcnt lgkmcnt(4)
  buffer_load_dwordx4 v20, s[24:27], s96 offen offset:2048 sc0 sc1 lds
  v_mfma_f32_32x32x16_bf16 a[16:31], v[224:227], a[164:167], a[16:31]
  s_add_u32 m0, s3, 40960
  ds_read_b128 a[160:163], v11 offset:16384
  buffer_load_dwordx4 v3, s[20:23], s84 offen offset:2048  lds
  v_mfma_f32_32x32x16_bf16 a[32:47], v[224:227], a[168:171], a[32:47]
  ds_read_b128 a[164:167], v11 offset:17408
  v_mfma_f32_32x32x16_bf16 a[48:63], v[224:227], a[172:175], a[48:63]
  s_add_u32 m0, s97, 81920
  ds_read_b128 a[168:171], v11 offset:18432
  s_waitcnt lgkmcnt(4)
  buffer_load_dwordx4 v20, s[24:27], s96 offen offset:3072 sc0 sc1 lds
  v_mfma_f32_32x32x16_bf16 a[0:15], v[228:231], a[176:179], a[0:15]
  s_add_u32 m0, s97, 86016
  ds_read_b128 a[172:175], v11 offset:19456
  buffer_load_dwordx4 v94, s[24:27], s96 offen offset:0 sc0 sc1 lds
  v_mfma_f32_32x32x16_bf16 a[16:31], v[228:231], a[180:183], a[16:31]
  s_add_u32 m0, s3, 40960
  ds_read_b128 a[176:179], v12 offset:16384
  buffer_load_dwordx4 v4, s[20:23], s84 offen offset:3072  lds
  s_addk_i32 s35, 128
  s_cmpk_eq_u32 s35, 1280
  s_cselect_b32 s35, 0, s35
  v_readlane_b32 s82, v21, 1
  v_mfma_f32_32x32x16_bf16 a[32:47], v[228:231], a[184:187], a[32:47]
  ds_read_b128 a[180:183], v12 offset:17408
  s_waitcnt lgkmcnt(4)
  v_mfma_f32_32x32x16_bf16 a[48:63], v[228:231], a[188:191], a[48:63]
  s_add_u32 m0, s97, 87040
  ds_read_b128 a[184:187], v12 offset:18432
  buffer_load_dwordx4 v20, s[24:27], s82 offen offset:0 sc0 sc1 lds
  v_mfma_f32_32x32x16_bf16 a[0:15], v[232:235], a[160:163], a[0:15]
  ds_read_b128 a[188:191], v12 offset:19456
  buffer_load_dwordx4 v20, s[24:27], s82 offen offset:1024 sc0 sc1 lds
  v_mfma_f32_32x32x16_bf16 a[16:31], v[232:235], a[164:167], a[16:31]
  s_waitcnt lgkmcnt(3)
  v_mfma_f32_32x32x16_bf16 a[32:47], v[232:235], a[168:171], a[32:47]
  s_waitcnt lgkmcnt(0)
  s_barrier
  ds_read_b128 a[160:163], v5 offset:0
  ds_read_b128 a[164:167], v5 offset:1024
  v_mfma_f32_32x32x16_bf16 a[48:63], v[232:235], a[172:175], a[48:63]
  s_mul_i32 s84, s35, 1728
  s_add_u32 m0, s3, 57344
  s_add_u32 s84, s84, s94
  ds_read_b128 a[168:171], v5 offset:2048
  buffer_load_dwordx4 v3, s[16:19], s84 offen offset:0  lds
  v_mfma_f32_32x32x16_bf16 a[0:15], v[236:239], a[176:179], a[0:15]
  s_add_u32 m0, s97, 87040
  ds_read_b128 a[172:175], v5 offset:3072
  buffer_load_dwordx4 v20, s[24:27], s82 offen offset:2048 sc0 sc1 lds
  v_mfma_f32_32x32x16_bf16 a[16:31], v[236:239], a[180:183], a[16:31]
  s_add_u32 m0, s3, 57344
  ds_read_b128 a[176:179], v6 offset:0
  buffer_load_dwordx4 v4, s[16:19], s84 offen offset:1024  lds
  v_mfma_f32_32x32x16_bf16 a[32:47], v[236:239], a[184:187], a[32:47]
  ds_read_b128 a[180:183], v6 offset:1024
  v_mfma_f32_32x32x16_bf16 a[48:63], v[236:239], a[188:191], a[48:63]
  s_add_u32 m0, s97, 87040
  ds_read_b128 a[184:187], v6 offset:2048
  s_waitcnt lgkmcnt(4)
  buffer_load_dwordx4 v20, s[24:27], s82 offen offset:3072 sc0 sc1 lds
  v_mfma_f32_32x32x16_bf16 a[0:15], v[240:243], a[160:163], a[0:15]
  s_add_u32 m0, s97, 91136
  ds_read_b128 a[188:191], v6 offset:3072
  buffer_load_dwordx4 v94, s[24:27], s82 offen offset:0 sc0 sc1 lds
  v_mfma_f32_32x32x16_bf16 a[16:31], v[240:243], a[164:167], a[16:31]
  s_add_u32 m0, s3, 57344
  ds_read_b128 a[160:163], v7 offset:0
  buffer_load_dwordx4 v3, s[20:23], s84 offen offset:2048  lds
  v_readlane_b32 s83, v21, 2
  v_mfma_f32_32x32x16_bf16 a[32:47], v[240:243], a[168:171], a[32:47]
  ds_read_b128 a[164:167], v7 offset:1024
  s_waitcnt lgkmcnt(4)
  v_mfma_f32_32x32x16_bf16 a[48:63], v[240:243], a[172:175], a[48:63]
  s_add_u32 m0, s97, 122880
  ds_read_b128 a[168:171], v7 offset:2048
  buffer_load_dwordx4 v20, s[24:27], s83 offen offset:0 sc0 sc1 lds
  v_mfma_f32_32x32x16_bf16 a[0:15], v[244:247], a[176:179], a[0:15]
  ds_read_b128 a[172:175], v7 offset:3072
  buffer_load_dwordx4 v20, s[24:27], s83 offen offset:1024 sc0 sc1 lds
  v_mfma_f32_32x32x16_bf16 a[16:31], v[244:247], a[180:183], a[16:31]
  s_add_u32 m0, s3, 57344
  ds_read_b128 a[176:179], v8 offset:0
  s_waitcnt lgkmcnt(4)
  buffer_load_dwordx4 v4, s[20:23], s84 offen offset:3072  lds
  s_addk_i32 s35, 128
  s_cmpk_eq_u32 s35, 1280
  s_cselect_b32 s35, 0, s35
  v_mfma_f32_32x32x16_bf16 a[32:47], v[244:247], a[184:187], a[32:47]
  ds_read_b128 a[180:183], v8 offset:1024
  v_mfma_f32_32x32x16_bf16 a[48:63], v[244:247], a[188:191], a[48:63]
  s_add_u32 m0, s97, 122880
  ds_read_b128 a[184:187], v8 offset:2048
  buffer_load_dwordx4 v20, s[24:27], s83 offen offset:2048 sc0 sc1 lds
  v_mfma_f32_32x32x16_bf16 a[0:15], v[248:251], a[160:163], a[0:15]
  ds_read_b128 a[188:191], v8 offset:3072
  s_waitcnt lgkmcnt(4)
  buffer_load_dwordx4 v20, s[24:27], s83 offen offset:3072 sc0 sc1 lds
  v_mfma_f32_32x32x16_bf16 a[16:31], v[248:251], a[164:167], a[16:31]
  v_mfma_f32_32x32x16_bf16 a[32:47], v[248:251], a[168:171], a[32:47]
  s_waitcnt lgkmcnt(0)
  s_barrier
  ds_read_b64_tr_b16 a[160:161], v13 offset:24576
  ds_read_b64_tr_b16 a[162:163], v13 offset:25088
  ds_read_b64_tr_b16 a[164:165], v13 offset:26624
  ds_read_b64_tr_b16 a[166:167], v13 offset:27136
  v_mfma_f32_32x32x16_bf16 a[48:63], v[248:251], a[172:175], a[48:63]
  s_mul_i32 s84, s35, 1728
  s_add_u32 m0, s3, 0
  s_add_u32 s84, s84, s94
  ds_read_b64_tr_b16 a[168:169], v14 offset:24576
  ds_read_b64_tr_b16 a[170:171], v14 offset:25088
  buffer_load_dwordx4 v3, s[16:19], s84 offen offset:0  lds
  v_mfma_f32_32x32x16_bf16 a[0:15], v[252:255], a[176:179], a[0:15]
  s_add_u32 m0, s97, 126976
  ds_read_b64_tr_b16 a[172:173], v14 offset:26624
  ds_read_b64_tr_b16 a[174:175], v14 offset:27136
  buffer_load_dwordx4 v94, s[24:27], s83 offen offset:0 sc0 sc1 lds
  v_mfma_f32_32x32x16_bf16 a[16:31], v[252:255], a[180:183], a[16:31]
  s_add_u32 m0, s3, 0
  ds_read_b64_tr_b16 a[176:177], v13 offset:28672
  ds_read_b64_tr_b16 a[178:179], v13 offset:29184
  buffer_load_dwordx4 v4, s[16:19], s84 offen offset:1024  lds
  v_readlane_b32 s96, v21, 3
  v_mfma_f32_32x32x16_bf16 a[32:47], v[252:255], a[184:187], a[32:47]
  ds_read_b64_tr_b16 a[180:181], v13 offset:30720
  ds_read_b64_tr_b16 a[182:183], v13 offset:31232
  s_waitcnt lgkmcnt(8)
  v_mfma_f32_32x32x16_bf16 a[48:63], v[252:255], a[188:191], a[48:63]
  s_add_u32 m0, s97, 128000
  ds_read_b64_tr_b16 a[184:185], v14 offset:28672
  ds_read_b64_tr_b16 a[186:187], v14 offset:29184
  buffer_load_dwordx4 v20, s[24:27], s96 offen offset:0 sc0 sc1 lds
  v_mfma_f32_32x32x16_bf16 a[96:111], a[160:163], v[96:99], 0
  ds_read_b64_tr_b16 a[188:189], v14 offset:30720
  ds_read_b64_tr_b16 a[190:191], v14 offset:31232
  buffer_load_dwordx4 v20, s[24:27], s96 offen offset:1024 sc0 sc1 lds
  v_mfma_f32_32x32x16_bf16 a[112:127], a[164:167], v[96:99], 0
  s_add_u32 m0, s3, 0
  ds_read_b64_tr_b16 a[160:161], v13 offset:32768
  ds_read_b64_tr_b16 a[162:163], v13 offset:33280
  s_waitcnt lgkmcnt(8)
  buffer_load_dwordx4 v3, s[20:23], s84 offen offset:2048  lds
  v_mfma_f32_32x32x16_bf16 a[128:143], a[168:171], v[96:99], 0
  ds_read_b64_tr_b16 a[164:165], v13 offset:34816
  ds_read_b64_tr_b16 a[166:167], v13 offset:35328
  v_accvgpr_read_b32 v48, a0
  v_accvgpr_read_b32 v49, a16
  v_accvgpr_read_b32 v52, a32
  v_accvgpr_read_b32 v53, a48
  v_accvgpr_read_b32 v50, a1
  v_accvgpr_read_b32 v51, a17
  v_fmac_f32_e32 v50, v22, v48
  v_fmac_f32_e32 v51, v22, v49
  v_fma_f32 v50, -v23, v49, v50
  v_fmac_f32_e64 v51, v23, v48
  v_accvgpr_read_b32 v54, a33
  v_mfma_f32_32x32x16_bf16 a[144:159], a[172:175], v[96:99], 0
  s_add_u32 m0, s97, 128000
  ds_read_b64_tr_b16 a[168:169], v14 offset:32768
  ds_read_b64_tr_b16 a[170:171], v14 offset:33280
  buffer_load_dwordx4 v20, s[24:27], s96 offen offset:2048 sc0 sc1 lds
  v_accvgpr_read_b32 v55, a49
  v_fmac_f32_e32 v54, v26, v52
  v_fmac_f32_e32 v55, v26, v53
  v_fma_f32 v54, -v27, v53, v54
  v_fmac_f32_e64 v55, v27, v52
  v_accvgpr_read_b32 v48, a2
  v_accvgpr_read_b32 v49, a18
  v_fmac_f32_e32 v48, v22, v50
  v_fmac_f32_e32 v49, v22, v51
  v_fma_f32 v48, -v23, v51, v48
  v_fmac_f32_e64 v49, v23, v50
  v_mfma_f32_32x32x16_bf16 a[96:111], a[176:179], v[100:103], a[96:111]
  ds_read_b64_tr_b16 a[172:173], v14 offset:34816
  ds_read_b64_tr_b16 a[174:175], v14 offset:35328
  s_waitcnt lgkmcnt(8)
  buffer_load_dwordx4 v20, s[24:27], s96 offen offset:3072 sc0 sc1 lds
  v_accvgpr_read_b32 v52, a34
  v_accvgpr_read_b32 v53, a50
  v_fmac_f32_e32 v52, v26, v54
  v_fmac_f32_e64 v53, v26, v55
  v_fma_f32 v52, -v27, v55, v52
  v_fmac_f32_e64 v53, v27, v54
  v_accvgpr_read_b32 v50, a3
  v_accvgpr_read_b32 v51, a19
  v_fmac_f32_e32 v50, v22, v48
  v_fmac_f32_e32 v51, v22, v49
  v_mfma_f32_32x32x16_bf16 a[112:127], a[180:183], v[100:103], a[112:127]
  s_add_u32 m0, s3, 0
  ds_read_b64_tr_b16 a[176:177], v13 offset:36864
  ds_read_b64_tr_b16 a[178:179], v13 offset:37376
  buffer_load_dwordx4 v4, s[20:23], s84 offen offset:3072  lds
  s_addk_i32 s35, 128
  s_cmpk_eq_u32 s35, 1280
  s_cselect_b32 s35, 0, s35
  v_fma_f32 v50, -v23, v49, v50
  v_fmac_f32_e64 v51, v23, v48
  v_accvgpr_read_b32 v54, a35
  v_accvgpr_read_b32 v55, a51
  v_fmac_f32_e32 v54, v26, v52
  v_fmac_f32_e32 v55, v26, v53
  v_mfma_f32_32x32x16_bf16 a[128:143], a[184:187], v[100:103], a[128:143]
  ds_read_b64_tr_b16 a[180:181], v13 offset:38912
  ds_read_b64_tr_b16 a[182:183], v13 offset:39424
  v_fma_f32 v54, -v27, v53, v54
  v_fmac_f32_e64 v55, v27, v52
  v_accvgpr_read_b32 v48, a4
  v_accvgpr_read_b32 v49, a20
  v_fmac_f32_e32 v48, v22, v50
  v_fmac_f32_e32 v49, v22, v51
  v_fma_f32 v48, -v23, v51, v48
  v_fmac_f32_e64 v49, v23, v50
  v_accvgpr_read_b32 v52, a36
  v_accvgpr_read_b32 v53, a52
  v_fmac_f32_e64 v52, v26, v54
  v_readlane_b32 s82, v21, 12
  v_mfma_f32_32x32x16_bf16 a[144:159], a[188:191], v[100:103], a[144:159]
  s_add_u32 m0, s97, 132096
  ds_read_b64_tr_b16 a[184:185], v14 offset:36864
  ds_read_b64_tr_b16 a[186:187], v14 offset:37376
  s_waitcnt lgkmcnt(8)
  buffer_load_dwordx4 v94, s[24:27], s96 offen offset:0 sc0 sc1 lds
  v_fmac_f32_e32 v53, v26, v55
  v_fma_f32 v52, -v27, v55, v52
  v_fmac_f32_e64 v53, v27, v54
  v_accvgpr_read_b32 v50, a5
  v_accvgpr_read_b32 v51, a21
  v_fmac_f32_e32 v50, v22, v48
  v_fmac_f32_e32 v51, v22, v49
  v_fma_f32 v50, -v23, v49, v50
  v_fmac_f32_e64 v51, v23, v48
  v_accvgpr_read_b32 v54, a37
  v_mfma_f32_32x32x16_bf16 a[96:111], a[160:163], v[104:107], a[96:111]
  ds_read_b64_tr_b16 a[188:189], v14 offset:38912
  ds_read_b64_tr_b16 a[190:191], v14 offset:39424
  buffer_load_dwordx4 a[192:195], v20, s[24:27], s82 offen offset:2048 sc0 sc1
  v_accvgpr_read_b32 v55, a53
  v_fmac_f32_e32 v54, v26, v52
  v_fmac_f32_e32 v55, v26, v53
  v_fma_f32 v54, -v27, v53, v54
  v_fmac_f32_e64 v55, v27, v52
  v_accvgpr_read_b32 v48, a6
  v_accvgpr_read_b32 v49, a22
  v_fmac_f32_e32 v48, v22, v50
  v_fmac_f32_e32 v49, v22, v51
  v_fma_f32 v48, -v23, v51, v48
  v_fmac_f32_e64 v49, v23, v50
  v_mfma_f32_32x32x16_bf16 a[112:127], a[164:167], v[104:107], a[112:127]
  v_accvgpr_read_b32 v52, a38
  v_accvgpr_read_b32 v53, a54
  v_fmac_f32_e32 v52, v26, v54
  v_fmac_f32_e32 v53, v26, v55
  v_fma_f32 v52, -v27, v55, v52
  v_fmac_f32_e64 v53, v27, v54
  v_accvgpr_read_b32 v50, a7
  v_accvgpr_read_b32 v51, a23
  v_fmac_f32_e32 v50, v22, v48
  v_fmac_f32_e32 v51, v22, v49
  v_fma_f32 v50, -v23, v49, v50
  v_fmac_f32_e64 v51, v23, v48
  v_accvgpr_read_b32 v54, a39
  v_mfma_f32_32x32x16_bf16 a[128:143], a[168:171], v[104:107], a[128:143]
  s_waitcnt vmcnt(24) lgkmcnt(0)
  s_barrier
  ds_read_b64_tr_b16 a[160:161], v15 offset:0
  ds_read_b64_tr_b16 a[162:163], v15 offset:512
  ds_read_b64_tr_b16 a[164:165], v15 offset:2048
  ds_read_b64_tr_b16 a[166:167], v15 offset:2560
  v_accvgpr_read_b32 v55, a55
  v_fmac_f32_e32 v54, v26, v52
  v_fmac_f32_e32 v55, v26, v53
  v_fma_f32 v54, -v27, v53, v54
  v_fmac_f32_e64 v55, v27, v52
  v_mfma_f32_32x32x16_bf16 a[144:159], a[172:175], v[104:107], a[144:159]
  s_mul_i32 s84, s35, 1728
  s_add_u32 m0, s3, 24576
  s_add_u32 s84, s84, s94
  ds_read_b64_tr_b16 a[168:169], v16 offset:0
  ds_read_b64_tr_b16 a[170:171], v16 offset:512
  buffer_load_dwordx4 v3, s[16:19], s84 offen offset:0  lds
  v_accvgpr_read_b32 v48, a8
  v_accvgpr_read_b32 v49, a24
  v_fmac_f32_e32 v48, v22, v50
  v_fmac_f32_e64 v49, v22, v51
  v_fma_f32 v48, -v23, v51, v48
  v_fmac_f32_e64 v49, v23, v50
  v_accvgpr_read_b32 v52, a40
  v_mfma_f32_32x32x16_bf16 a[96:111], a[176:179], v[108:111], a[96:111]
  ds_read_b64_tr_b16 a[172:173], v16 offset:2048
  ds_read_b64_tr_b16 a[174:175], v16 offset:2560
  buffer_load_dwordx4 a[196:199], v20, s[24:27], s82 offen offset:3072 sc0 sc1
  v_accvgpr_read_b32 v53, a56
  v_fmac_f32_e32 v52, v26, v54
  v_fmac_f32_e32 v53, v26, v55
  v_fma_f32 v52, -v27, v55, v52
  v_fmac_f32_e64 v53, v27, v54
  v_accvgpr_read_b32 v50, a9
  v_accvgpr_read_b32 v51, a25
  v_fmac_f32_e32 v50, v22, v48
  v_fmac_f32_e32 v51, v22, v49
  v_fma_f32 v50, -v23, v49, v50
  v_fmac_f32_e64 v51, v23, v48
  v_mfma_f32_32x32x16_bf16 a[112:127], a[180:183], v[108:111], a[112:127]
  ds_read_b64_tr_b16 a[176:177], v15 offset:4096
  ds_read_b64_tr_b16 a[178:179], v15 offset:4608
  s_waitcnt lgkmcnt(8)
  buffer_load_dwordx4 v4, s[16:19], s84 offen offset:1024  lds
  v_accvgpr_read_b32 v54, a41
  v_accvgpr_read_b32 v55, a57
  v_fmac_f32_e32 v54, v26, v52
  v_fmac_f32_e64 v55, v26, v53
  v_fma_f32 v54, -v27, v53, v54
  v_fmac_f32_e64 v55, v27, v52
  v_accvgpr_read_b32 v48, a10
  v_accvgpr_read_b32 v49, a26
  v_mfma_f32_32x32x16_bf16 a[128:143], a[184:187], v[108:111], a[128:143]
  ds_read_b64_tr_b16 a[180:181], v15 offset:6144
  ds_read_b64_tr_b16 a[182:183], v15 offset:6656
  v_fmac_f32_e32 v48, v22, v50
  v_fmac_f32_e32 v49, v22, v51
  v_fma_f32 v48, -v23, v51, v48
  v_fmac_f32_e64 v49, v23, v50
  v_accvgpr_read_b32 v52, a42
  v_accvgpr_read_b32 v53, a58
  v_fmac_f32_e32 v52, v26, v54
  v_fmac_f32_e32 v53, v26, v55
  v_fma_f32 v52, -v27, v55, v52
  v_fmac_f32_e64 v53, v27, v54
  v_accvgpr_read_b32 v50, a11
  v_readlane_b32 s83, v21, 13
  v_mfma_f32_32x32x16_bf16 a[144:159], a[188:191], v[108:111], a[144:159]
  ds_read_b64_tr_b16 a[184:185], v16 offset:4096
  ds_read_b64_tr_b16 a[186:187], v16 offset:4608
  buffer_load_dwordx4 a[200:203], v94, s[24:27], s82 offen offset:0 sc0 sc1
  v_accvgpr_read_b32 v51, a27
  v_fmac_f32_e32 v50, v22, v48
  v_fmac_f32_e32 v51, v22, v49
  v_fma_f32 v50, -v23, v49, v50
  v_fmac_f32_e64 v51, v23, v48
  v_accvgpr_read_b32 v54, a43
  v_accvgpr_read_b32 v55, a59
  v_fmac_f32_e32 v54, v26, v52
  v_fmac_f32_e32 v55, v26, v53
  v_fma_f32 v54, -v27, v53, v54
  v_fmac_f32_e64 v55, v27, v52
  v_mfma_f32_32x32x16_bf16 a[96:111], a[160:163], v[112:115], a[96:111]
  ds_read_b64_tr_b16 a[188:189], v16 offset:6144
  ds_read_b64_tr_b16 a[190:191], v16 offset:6656
  s_waitcnt lgkmcnt(8)
  buffer_load_dwordx4 a[204:207], v20, s[24:27], s83 offen offset:0 sc0 sc1
  v_accvgpr_read_b32 v48, a12
  v_accvgpr_read_b32 v49, a28
  v_fmac_f32_e32 v48, v22, v50
  v_fmac_f32_e64 v49, v22, v51
  v_fma_f32 v48, -v23, v51, v48
  v_fmac_f32_e64 v49, v23, v50
  v_accvgpr_read_b32 v52, a44
  v_accvgpr_read_b32 v53, a60
  v_fmac_f32_e32 v52, v26, v54
  v_fmac_f32_e32 v53, v26, v55
  v_mfma_f32_32x32x16_bf16 a[112:127], a[164:167], v[112:115], a[112:127]
  ds_read_b64_tr_b16 a[160:161], v15 offset:8192
  ds_read_b64_tr_b16 a[162:163], v15 offset:8704
  buffer_load_dwordx4 v3, s[20:23], s84 offen offset:2048  lds
  v_fma_f32 v52, -v27, v55, v52
  v_fmac_f32_e64 v53, v27, v54
  v_accvgpr_read_b32 v50, a13
  v_accvgpr_read_b32 v51, a29
  v_fmac_f32_e32 v50, v22, v48
  v_fmac_f32_e32 v51, v22, v49
  v_fma_f32 v50, -v23, v49, v50
  v_fmac_f32_e64 v51, v23, v48
  v_accvgpr_read_b32 v54, a45
  v_mfma_f32_32x32x16_bf16 a[128:143], a[168:171], v[112:115], a[128:143]
  ds_read_b64_tr_b16 a[164:165], v15 offset:10240
  ds_read_b64_tr_b16 a[166:167], v15 offset:10752
  v_accvgpr_read_b32 v55, a61
  v_fmac_f32_e32 v54, v26, v52
  v_fmac_f32_e32 v55, v26, v53
  v_fma_f32 v54, -v27, v53, v54
  v_fmac_f32_e64 v55, v27, v52
  v_accvgpr_read_b32 v48, a14
  v_accvgpr_read_b32 v49, a30
  v_fmac_f32_e32 v48, v22, v50
  v_fmac_f32_e32 v49, v22, v51
  v_fma_f32 v48, -v23, v51, v48
  v_fmac_f32_e64 v49, v23, v50
  v_mfma_f32_32x32x16_bf16 a[144:159], a[172:175], v[112:115], a[144:159]
  ds_read_b64_tr_b16 a[168:169], v16 offset:8192
  ds_read_b64_tr_b16 a[170:171], v16 offset:8704
  s_waitcnt lgkmcnt(8)
  buffer_load_dwordx4 a[208:211], v20, s[24:27], s83 offen offset:1024 sc0 sc1
  v_accvgpr_read_b32 v52, a46
  v_accvgpr_read_b32 v53, a62
  v_fmac_f32_e32 v52, v26, v54
  v_fmac_f32_e64 v53, v26, v55
  v_fma_f32 v52, -v27, v55, v52
  v_fmac_f32_e64 v53, v27, v54
  v_accvgpr_read_b32 v50, a15
  v_accvgpr_read_b32 v51, a31
  v_fmac_f32_e32 v50, v22, v48
  v_fmac_f32_e32 v51, v22, v49
  v_mfma_f32_32x32x16_bf16 a[96:111], a[176:179], v[116:119], a[96:111]
  ds_read_b64_tr_b16 a[172:173], v16 offset:10240
  ds_read_b64_tr_b16 a[174:175], v16 offset:10752
  buffer_load_dwordx4 a[212:215], v20, s[24:27], s83 offen offset:2048 sc0 sc1
  v_fma_f32 v50, -v23, v49, v50
  v_fmac_f32_e64 v51, v23, v48
  v_accvgpr_read_b32 v54, a47
  v_accvgpr_read_b32 v55, a63
  v_fmac_f32_e32 v54, v26, v52
  v_fmac_f32_e32 v55, v26, v53
  v_fma_f32 v54, -v27, v53, v54
  v_fmac_f32_e64 v55, v27, v52
  v_mfma_f32_32x32x16_bf16 a[112:127], a[180:183], v[116:119], a[112:127]
  ds_read_b64_tr_b16 a[176:177], v15 offset:12288
  ds_read_b64_tr_b16 a[178:179], v15 offset:12800
  buffer_load_dwordx4 v4, s[20:23], s84 offen offset:3072  lds
  s_addk_i32 s35, 128
  s_cmpk_eq_u32 s35, 1280
  s_cselect_b32 s35, 0, s35
  ds_write_b64 v42, v[50:51] offset:0
  ds_write_b64 v42, v[54:55] offset:256
  v_mfma_f32_32x32x16_bf16 a[128:143], a[184:187], v[116:119], a[128:143]
  ds_read_b64_tr_b16 a[180:181], v15 offset:14336
  ds_read_b64_tr_b16 a[182:183], v15 offset:14848
  s_waitcnt lgkmcnt(10)
  v_mfma_f32_32x32x16_bf16 a[144:159], a[188:191], v[116:119], a[144:159]
  ds_read_b64_tr_b16 a[184:185], v16 offset:12288
  ds_read_b64_tr_b16 a[186:187], v16 offset:12800
  buffer_load_dwordx4 a[216:219], v20, s[24:27], s83 offen offset:3072 sc0 sc1
  v_mfma_f32_32x32x16_bf16 a[96:111], a[160:163], v[120:123], a[96:111]
  ds_read_b64_tr_b16 a[188:189], v16 offset:14336
  ds_read_b64_tr_b16 a[190:191], v16 offset:14848
  buffer_load_dwordx4 a[220:223], v94, s[24:27], s83 offen offset:0 sc0 sc1
  v_mfma_f32_32x32x16_bf16 a[112:127], a[164:167], v[120:123], a[112:127]
  s_waitcnt lgkmcnt(8)
  v_mfma_f32_32x32x16_bf16 a[128:143], a[168:171], v[120:123], a[128:143]
  s_waitcnt lgkmcnt(6)
  s_waitcnt vmcnt(24) lgkmcnt(0)
  s_barrier
  ds_read_b64_tr_b16 a[160:161], v15 offset:16384
  ds_read_b64_tr_b16 a[162:163], v15 offset:16896
  ds_read_b64_tr_b16 a[164:165], v15 offset:18432
  ds_read_b64_tr_b16 a[166:167], v15 offset:18944
  v_readlane_b32 s96, v21, 14
  v_mfma_f32_32x32x16_bf16 a[144:159], a[172:175], v[120:123], a[144:159]
  s_mul_i32 s84, s35, 1728
  s_add_u32 m0, s3, 40960
  s_add_u32 s84, s84, s94
  ds_read_b64_tr_b16 a[168:169], v16 offset:16384
  ds_read_b64_tr_b16 a[170:171], v16 offset:16896
  buffer_load_dwordx4 v3, s[16:19], s84 offen offset:0  lds
  ds_read_b64 v[96:97], v43 offset:0
  ds_read_b64 v[98:99], v43 offset:512
  ds_read_b64 v[100:101], v43 offset:1024
  ds_read_b64 v[102:103], v43 offset:1536
  ds_read_b64 v[104:105], v43 offset:2048
  ds_read_b64 v[38:39], v43 offset:2560
  ds_read_b64 v[40:41], v43 offset:3072
  v_mfma_f32_32x32x16_bf16 a[96:111], a[176:179], v[124:127], a[96:111]
  ds_read_b64_tr_b16 a[172:173], v16 offset:18432
  ds_read_b64_tr_b16 a[174:175], v16 offset:18944
  ds_read_b64 v[88:89], v43 offset:3584
  buffer_load_dwordx4 a[224:227], v20, s[24:27], s96 offen offset:0 sc0 sc1
  v_mfma_f32_32x32x16_bf16 a[112:127], a[180:183], v[124:127], a[112:127]
  ds_read_b64_tr_b16 a[176:177], v15 offset:20480
  ds_read_b64_tr_b16 a[178:179], v15 offset:20992
  buffer_load_dwordx4 v4, s[16:19], s84 offen offset:1024  lds
  v_mfma_f32_32x32x16_bf16 a[128:143], a[184:187], v[124:127], a[128:143]
  ds_read_b64_tr_b16 a[180:181], v15 offset:22528
  ds_read_b64_tr_b16 a[182:183], v15 offset:23040
  s_waitcnt lgkmcnt(4)
  v_fmac_f32_e32 v98, v30, v96
  v_fmac_f32_e32 v99, v30, v97
  v_fma_f32 v98, -v31, v97, v98
  v_fmac_f32_e32 v99, v31, v96
  v_fmac_f32_e32 v100, v30, v98
  v_fmac_f32_e64 v101, v30, v99
  v_fma_f32 v100, -v31, v99, v100
  v_fmac_f32_e32 v101, v31, v98
  v_fmac_f32_e32 v102, v30, v100
  v_fmac_f32_e64 v103, v30, v101
  v_mfma_f32_32x32x16_bf16 a[144:159], a[188:191], v[124:127], a[144:159]
  ds_read_b64_tr_b16 a[184:185], v16 offset:20480
  ds_read_b64_tr_b16 a[186:187], v16 offset:20992
  buffer_load_dwordx4 a[228:231], v20, s[24:27], s96 offen offset:1024 sc0 sc1
  v_fma_f32 v102, -v31, v101, v102
  v_fmac_f32_e32 v103, v31, v100
  v_fmac_f32_e32 v104, v30, v102
  v_fmac_f32_e64 v105, v30, v103
  v_fma_f32 v104, -v31, v103, v104
  v_fmac_f32_e32 v105, v31, v102
  v_fmac_f32_e32 v38, v30, v104
  v_fmac_f32_e64 v39, v30, v105
  v_fma_f32 v38, -v31, v105, v38
  v_fmac_f32_e64 v39, v31, v104
  v_mfma_f32_32x32x16_bf16 a[96:111], a[160:163], v[128:131], a[96:111]
  ds_read_b64_tr_b16 a[188:189], v16 offset:22528
  ds_read_b64_tr_b16 a[190:191], v16 offset:23040
  buffer_load_dwordx4 a[232:235], v20, s[24:27], s96 offen offset:2048 sc0 sc1
  v_fmac_f32_e32 v40, v30, v38
  v_fmac_f32_e32 v41, v30, v39
  v_fma_f32 v40, -v31, v39, v40
  v_fmac_f32_e32 v41, v31, v38
  v_fmac_f32_e32 v88, v30, v40
  v_fmac_f32_e64 v89, v30, v41
  v_fma_f32 v88, -v31, v41, v88
  v_fmac_f32_e32 v89, v31, v40
  v_mov_b32_e32 v90, v89
  v_mov_b32_e32 v89, s32
  v_mov_b32_e32 v91, s32
  v_mfma_f32_32x32x16_bf16 a[112:127], a[164:167], v[128:131], a[112:127]
  ds_read_b64_tr_b16 a[160:161], v15 offset:24576
  ds_read_b64_tr_b16 a[162:163], v15 offset:25088
  buffer_load_dwordx4 v3, s[20:23], s84 offen offset:2048  lds
  s_cmp_eq_u32 s28, 3
  s_cselect_b32 s85, 0, 0x10000000
  buffer_store_dwordx4 v[88:91], v46, s[36:39], s85 offen sc0 sc1
  v_mfma_f32_32x32x16_bf16 a[128:143], a[168:171], v[128:131], a[128:143]
  ds_read_b64_tr_b16 a[164:165], v15 offset:26624
  ds_read_b64_tr_b16 a[166:167], v15 offset:27136
  s_waitcnt lgkmcnt(8)
  v_mfma_f32_32x32x16_bf16 a[144:159], a[172:175], v[128:131], a[144:159]
  ds_read_b64_tr_b16 a[168:169], v16 offset:24576
  ds_read_b64_tr_b16 a[170:171], v16 offset:25088
  buffer_load_dwordx4 a[236:239], v20, s[24:27], s96 offen offset:3072 sc0 sc1
  v_mfma_f32_32x32x16_bf16 a[96:111], a[176:179], v[132:135], a[96:111]
  ds_read_b64_tr_b16 a[172:173], v16 offset:26624
  ds_read_b64_tr_b16 a[174:175], v16 offset:27136
  buffer_load_dwordx4 a[240:243], v94, s[24:27], s96 offen offset:0 sc0 sc1
  v_mfma_f32_32x32x16_bf16 a[112:127], a[180:183], v[132:135], a[112:127]
  ds_read_b64_tr_b16 a[176:177], v15 offset:28672
  ds_read_b64_tr_b16 a[178:179], v15 offset:29184
  s_waitcnt lgkmcnt(8)
  buffer_load_dwordx4 v4, s[20:23], s84 offen offset:3072  lds
  s_addk_i32 s35, 128
  s_cmpk_eq_u32 s35, 1280
  s_cselect_b32 s35, 0, s35
  v_readlane_b32 s82, v21, 15
  v_mfma_f32_32x32x16_bf16 a[128:143], a[184:187], v[132:135], a[128:143]
  ds_read_b64_tr_b16 a[180:181], v15 offset:30720
  ds_read_b64_tr_b16 a[182:183], v15 offset:31232
  v_mfma_f32_32x32x16_bf16 a[144:159], a[188:191], v[132:135], a[144:159]
  ds_read_b64_tr_b16 a[184:185], v16 offset:28672
  ds_read_b64_tr_b16 a[186:187], v16 offset:29184
  buffer_load_dwordx4 a[244:247], v20, s[24:27], s82 offen offset:0 sc0 sc1
  v_mfma_f32_32x32x16_bf16 a[96:111], a[160:163], v[136:139], a[96:111]
  ds_read_b64_tr_b16 a[188:189], v16 offset:30720
  ds_read_b64_tr_b16 a[190:191], v16 offset:31232
  s_waitcnt lgkmcnt(8)
  buffer_load_dwordx4 a[248:251], v20, s[24:27], s82 offen offset:1024 sc0 sc1
  v_mfma_f32_32x32x16_bf16 a[112:127], a[164:167], v[136:139], a[112:127]
  v_mfma_f32_32x32x16_bf16 a[128:143], a[168:171], v[136:139], a[128:143]
  s_waitcnt vmcnt(25) lgkmcnt(0)
  s_barrier
  ds_read_b64_tr_b16 a[160:161], v13 offset:0
  ds_read_b64_tr_b16 a[162:163], v13 offset:512
  ds_read_b64_tr_b16 a[164:165], v13 offset:2048
  ds_read_b64_tr_b16 a[166:167], v13 offset:2560
  v_mfma_f32_32x32x16_bf16 a[144:159], a[172:175], v[136:139], a[144:159]
  s_mul_i32 s84, s35, 1728
  s_add_u32 m0, s3, 57344
  s_add_u32 s84, s84, s94
  ds_read_b64_tr_b16 a[168:169], v14 offset:0
  ds_read_b64_tr_b16 a[170:171], v14 offset:512
  buffer_load_dwordx4 v3, s[16:19], s84 offen offset:0  lds
  v_mfma_f32_32x32x16_bf16 a[96:111], a[176:179], v[140:143], a[96:111]
  ds_read_b64_tr_b16 a[172:173], v14 offset:2048
  ds_read_b64_tr_b16 a[174:175], v14 offset:2560
  buffer_load_dwordx4 a[252:255], v20, s[24:27], s82 offen offset:2048 sc0 sc1
  v_mfma_f32_32x32x16_bf16 a[112:127], a[180:183], v[140:143], a[112:127]
  ds_read_b64_tr_b16 a[176:177], v13 offset:4096
  ds_read_b64_tr_b16 a[178:179], v13 offset:4608
  buffer_load_dwordx4 v4, s[16:19], s84 offen offset:1024  lds
  v_mfma_f32_32x32x16_bf16 a[128:143], a[184:187], v[140:143], a[128:143]
  ds_read_b64_tr_b16 a[180:181], v13 offset:6144
  ds_read_b64_tr_b16 a[182:183], v13 offset:6656
  s_waitcnt lgkmcnt(8)
  v_mfma_f32_32x32x16_bf16 a[144:159], a[188:191], v[140:143], a[144:159]
  ds_read_b64_tr_b16 a[184:185], v14 offset:4096
  ds_read_b64_tr_b16 a[186:187], v14 offset:4608
  buffer_load_dwordx4 a[64:67], v20, s[24:27], s82 offen offset:3072 sc0 sc1
  v_mfma_f32_32x32x16_bf16 a[96:111], a[160:163], v[144:147], a[96:111]
  ds_read_b64_tr_b16 a[188:189], v14 offset:6144
  ds_read_b64_tr_b16 a[190:191], v14 offset:6656
  buffer_load_dwordx4 a[68:71], v94, s[24:27], s82 offen offset:0 sc0 sc1
  v_mfma_f32_32x32x16_bf16 a[112:127], a[164:167], v[144:147], a[112:127]
  ds_read_b64_tr_b16 a[160:161], v13 offset:8192
  ds_read_b64_tr_b16 a[162:163], v13 offset:8704
  s_waitcnt lgkmcnt(8)
  buffer_load_dwordx4 v3, s[20:23], s84 offen offset:2048  lds
  v_readlane_b32 s83, v21, 16
  v_mfma_f32_32x32x16_bf16 a[128:143], a[168:171], v[144:147], a[128:143]
  ds_read_b64_tr_b16 a[164:165], v13 offset:10240
  ds_read_b64_tr_b16 a[166:167], v13 offset:10752
  v_mfma_f32_32x32x16_bf16 a[144:159], a[172:175], v[144:147], a[144:159]
  ds_read_b64_tr_b16 a[168:169], v14 offset:8192
  ds_read_b64_tr_b16 a[170:171], v14 offset:8704
  buffer_load_dwordx4 a[72:75], v20, s[24:27], s83 offen offset:0 sc0 sc1
  v_mfma_f32_32x32x16_bf16 a[96:111], a[176:179], v[148:151], a[96:111]
  ds_read_b64_tr_b16 a[172:173], v14 offset:10240
  ds_read_b64_tr_b16 a[174:175], v14 offset:10752
  s_waitcnt lgkmcnt(8)
  buffer_load_dwordx4 a[76:79], v20, s[24:27], s83 offen offset:1024 sc0 sc1
  v_mfma_f32_32x32x16_bf16 a[112:127], a[180:183], v[148:151], a[112:127]
  ds_read_b64_tr_b16 a[176:177], v13 offset:12288
  ds_read_b64_tr_b16 a[178:179], v13 offset:12800
  buffer_load_dwordx4 v4, s[20:23], s84 offen offset:3072  lds
  s_addk_i32 s35, 128
  s_cmpk_eq_u32 s35, 1280
  s_cselect_b32 s35, 0, s35
  v_mfma_f32_32x32x16_bf16 a[128:143], a[184:187], v[148:151], a[128:143]
  ds_read_b64_tr_b16 a[180:181], v13 offset:14336
  ds_read_b64_tr_b16 a[182:183], v13 offset:14848
  v_mfma_f32_32x32x16_bf16 a[144:159], a[188:191], v[148:151], a[144:159]
  ds_read_b64_tr_b16 a[184:185], v14 offset:12288
  ds_read_b64_tr_b16 a[186:187], v14 offset:12800
  s_waitcnt lgkmcnt(8)
  buffer_load_dwordx4 a[80:83], v20, s[24:27], s83 offen offset:2048 sc0 sc1
  v_mfma_f32_32x32x16_bf16 a[96:111], a[160:163], v[152:155], a[96:111]
  ds_read_b64_tr_b16 a[188:189], v14 offset:14336
  ds_read_b64_tr_b16 a[190:191], v14 offset:14848
  buffer_load_dwordx4 a[84:87], v20, s[24:27], s83 offen offset:3072 sc0 sc1
  v_mfma_f32_32x32x16_bf16 a[112:127], a[164:167], v[152:155], a[112:127]
  v_mfma_f32_32x32x16_bf16 a[128:143], a[168:171], v[152:155], a[128:143]
  s_waitcnt vmcnt(25) lgkmcnt(0)
  s_barrier
  ds_read_b64_tr_b16 a[160:161], v13 offset:24576
  ds_read_b64_tr_b16 a[162:163], v13 offset:25088
  ds_read_b64_tr_b16 a[164:165], v13 offset:26624
  ds_read_b64_tr_b16 a[166:167], v13 offset:27136
  v_mfma_f32_32x32x16_bf16 a[144:159], a[172:175], v[152:155], a[144:159]
  s_mul_i32 s84, s35, 1728
  s_add_u32 m0, s3, 0
  s_add_u32 s84, s84, s94
  ds_read_b64_tr_b16 a[168:169], v14 offset:24576
  ds_read_b64_tr_b16 a[170:171], v14 offset:25088
  buffer_load_dwordx4 v3, s[16:19], s84 offen offset:0  lds
  v_mfma_f32_32x32x16_bf16 a[96:111], a[176:179], v[156:159], a[96:111]
  ds_read_b64_tr_b16 a[172:173], v14 offset:26624
  ds_read_b64_tr_b16 a[174:175], v14 offset:27136
  buffer_load_dwordx4 a[88:91], v94, s[24:27], s83 offen offset:0 sc0 sc1
  v_mfma_f32_32x32x16_bf16 a[112:127], a[180:183], v[156:159], a[112:127]
  ds_read_b64_tr_b16 a[176:177], v13 offset:28672
  ds_read_b64_tr_b16 a[178:179], v13 offset:29184
  s_waitcnt lgkmcnt(8)
  buffer_load_dwordx4 v4, s[16:19], s84 offen offset:1024  lds
  v_readlane_b32 s96, v21, 17
  v_mfma_f32_32x32x16_bf16 a[128:143], a[184:187], v[156:159], a[128:143]
  ds_read_b64_tr_b16 a[180:181], v13 offset:30720
  ds_read_b64_tr_b16 a[182:183], v13 offset:31232
  v_mfma_f32_32x32x16_bf16 a[144:159], a[188:191], v[156:159], a[144:159]
  ds_read_b64_tr_b16 a[184:185], v14 offset:28672
  ds_read_b64_tr_b16 a[186:187], v14 offset:29184
  buffer_load_dwordx4 a[92:95], v20, s[24:27], s96 offen offset:0 sc0 sc1
  v_mfma_f32_32x32x16_bf16 a[96:111], a[160:163], v[160:163], a[96:111]
  ds_read_b64_tr_b16 a[188:189], v14 offset:30720
  ds_read_b64_tr_b16 a[190:191], v14 offset:31232
  s_waitcnt lgkmcnt(8)
  v_mfma_f32_32x32x16_bf16 a[112:127], a[164:167], v[160:163], a[112:127]
  ds_read_b64_tr_b16 a[160:161], v13 offset:32768
  ds_read_b64_tr_b16 a[162:163], v13 offset:33280
  buffer_load_dwordx4 v3, s[20:23], s84 offen offset:2048  lds
  v_mfma_f32_32x32x16_bf16 a[128:143], a[168:171], v[160:163], a[128:143]
  ds_read_b64_tr_b16 a[164:165], v13 offset:34816
  ds_read_b64_tr_b16 a[166:167], v13 offset:35328
  s_movk_i32 s87, 1024
  buffer_load_dwordx4 v[152:155], v46, s[36:39], s87 offen offset:0 sc0 sc1
  v_mfma_f32_32x32x16_bf16 a[144:159], a[172:175], v[160:163], a[144:159]
  ds_read_b64_tr_b16 a[168:169], v14 offset:32768
  ds_read_b64_tr_b16 a[170:171], v14 offset:33280
  s_waitcnt lgkmcnt(8)
  buffer_load_dwordx4 v[148:151], v46, s[36:39], s87 offen offset:1024 sc0 sc1
  v_mfma_f32_32x32x16_bf16 a[96:111], a[176:179], v[164:167], a[96:111]
  ds_read_b64_tr_b16 a[172:173], v14 offset:34816
  ds_read_b64_tr_b16 a[174:175], v14 offset:35328
  buffer_load_dwordx4 v[144:147], v46, s[36:39], s87 offen offset:2048 sc0 sc1
  v_mfma_f32_32x32x16_bf16 a[112:127], a[180:183], v[164:167], a[112:127]
  ds_read_b64_tr_b16 a[176:177], v13 offset:36864
  ds_read_b64_tr_b16 a[178:179], v13 offset:37376
  buffer_load_dwordx4 v4, s[20:23], s84 offen offset:3072  lds
  s_addk_i32 s35, 128
  s_cmpk_eq_u32 s35, 1280
  s_cselect_b32 s35, 0, s35
  buffer_load_dwordx4 v[140:143], v46, s[36:39], s87 offen offset:3072 sc0 sc1
  v_mfma_f32_32x32x16_bf16 a[128:143], a[184:187], v[164:167], a[128:143]
  ds_read_b64_tr_b16 a[180:181], v13 offset:38912
  ds_read_b64_tr_b16 a[182:183], v13 offset:39424
  s_waitcnt lgkmcnt(8)
  s_movk_i32 s87, 5120
  buffer_load_dwordx4 v[136:139], v46, s[36:39], s87 offen offset:0 sc0 sc1
  v_mfma_f32_32x32x16_bf16 a[144:159], a[188:191], v[164:167], a[144:159]
  ds_read_b64_tr_b16 a[184:185], v14 offset:36864
  ds_read_b64_tr_b16 a[186:187], v14 offset:37376
  buffer_load_dwordx4 v[132:135], v46, s[36:39], s87 offen offset:1024 sc0 sc1
  v_mfma_f32_32x32x16_bf16 a[96:111], a[160:163], v[168:171], a[96:111]
  ds_read_b64_tr_b16 a[188:189], v14 offset:38912
  ds_read_b64_tr_b16 a[190:191], v14 offset:39424
  buffer_load_dwordx4 v[128:131], v46, s[36:39], s87 offen offset:2048 sc0 sc1
  v_mfma_f32_32x32x16_bf16 a[112:127], a[164:167], v[168:171], a[112:127]
  s_waitcnt lgkmcnt(6)
  buffer_load_dwordx4 v[124:127], v46, s[36:39], s87 offen offset:3072 sc0 sc1
  v_mfma_f32_32x32x16_bf16 a[128:143], a[168:171], v[168:171], a[128:143]
  s_waitcnt vmcnt(27) lgkmcnt(0)
  s_barrier
  ds_read_b64_tr_b16 a[160:161], v15 offset:0
  ds_read_b64_tr_b16 a[162:163], v15 offset:512
  ds_read_b64_tr_b16 a[164:165], v15 offset:2048
  ds_read_b64_tr_b16 a[166:167], v15 offset:2560
  s_movk_i32 s87, 9216
  buffer_load_dwordx4 v[120:123], v46, s[36:39], s87 offen offset:0 sc0 sc1
  v_mfma_f32_32x32x16_bf16 a[144:159], a[172:175], v[168:171], a[144:159]
  s_mul_i32 s84, s35, 1728
  s_add_u32 m0, s3, 24576
  s_add_u32 s84, s84, s94
  ds_read_b64_tr_b16 a[168:169], v16 offset:0
  ds_read_b64_tr_b16 a[170:171], v16 offset:512
  buffer_load_dwordx4 v3, s[16:19], s84 offen offset:0  lds
  buffer_load_dwordx4 v[116:119], v46, s[36:39], s87 offen offset:1024 sc0 sc1
  v_mfma_f32_32x32x16_bf16 a[96:111], a[176:179], v[172:175], a[96:111]
  ds_read_b64_tr_b16 a[172:173], v16 offset:2048
  ds_read_b64_tr_b16 a[174:175], v16 offset:2560
  buffer_load_dwordx4 v[112:115], v46, s[36:39], s87 offen offset:2048 sc0 sc1
  v_mfma_f32_32x32x16_bf16 a[112:127], a[180:183], v[172:175], a[112:127]
  ds_read_b64_tr_b16 a[176:177], v15 offset:4096
  ds_read_b64_tr_b16 a[178:179], v15 offset:4608
  buffer_load_dwordx4 v4, s[16:19], s84 offen offset:1024  lds
  buffer_load_dwordx4 v[108:111], v46, s[36:39], s87 offen offset:3072 sc0 sc1
  v_mfma_f32_32x32x16_bf16 a[128:143], a[184:187], v[172:175], a[128:143]
  ds_read_b64_tr_b16 a[180:181], v15 offset:6144
  ds_read_b64_tr_b16 a[182:183], v15 offset:6656
  s_movk_i32 s87, 13312
  buffer_load_dwordx4 v[104:107], v46, s[36:39], s87 offen offset:0 sc0 sc1
  v_mfma_f32_32x32x16_bf16 a[144:159], a[188:191], v[172:175], a[144:159]
  ds_read_b64_tr_b16 a[184:185], v16 offset:4096
  ds_read_b64_tr_b16 a[186:187], v16 offset:4608
  s_waitcnt lgkmcnt(8)
  buffer_load_dwordx4 v[100:103], v46, s[36:39], s87 offen offset:1024 sc0 sc1
  v_mfma_f32_32x32x16_bf16 a[96:111], a[160:163], v[176:179], a[96:111]
  ds_read_b64_tr_b16 a[188:189], v16 offset:6144
  ds_read_b64_tr_b16 a[190:191], v16 offset:6656
  buffer_load_dwordx4 v[96:99], v46, s[36:39], s87 offen offset:2048 sc0 sc1
  v_mfma_f32_32x32x16_bf16 a[112:127], a[164:167], v[176:179], a[112:127]
  ds_read_b64_tr_b16 a[160:161], v15 offset:8192
  ds_read_b64_tr_b16 a[162:163], v15 offset:8704
  buffer_load_dwordx4 v3, s[20:23], s84 offen offset:2048  lds
  v_readlane_b32 s82, v21, 8
  v_mfma_f32_32x32x16_bf16 a[128:143], a[168:171], v[176:179], a[128:143]
  ds_read_b64_tr_b16 a[164:165], v15 offset:10240
  ds_read_b64_tr_b16 a[166:167], v15 offset:10752
  s_waitcnt lgkmcnt(8)
  v_mfma_f32_32x32x16_bf16 a[144:159], a[172:175], v[176:179], a[144:159]
  ds_read_b64_tr_b16 a[168:169], v16 offset:8192
  ds_read_b64_tr_b16 a[170:171], v16 offset:8704
  buffer_load_dwordx4 v[168:171], v20, s[24:27], s82 offen offset:0 sc0 sc1
  v_mfma_f32_32x32x16_bf16 a[96:111], a[176:179], v[180:183], a[96:111]
  ds_read_b64_tr_b16 a[172:173], v16 offset:10240
  ds_read_b64_tr_b16 a[174:175], v16 offset:10752
  buffer_load_dwordx4 v[172:175], v20, s[24:27], s82 offen offset:1024 sc0 sc1
  v_mfma_f32_32x32x16_bf16 a[112:127], a[180:183], v[180:183], a[112:127]
  ds_read_b64_tr_b16 a[176:177], v15 offset:12288
  ds_read_b64_tr_b16 a[178:179], v15 offset:12800
  s_waitcnt lgkmcnt(8)
  buffer_load_dwordx4 v4, s[20:23], s84 offen offset:3072  lds
  s_addk_i32 s35, 128
  s_cmpk_eq_u32 s35, 1280
  s_cselect_b32 s35, 0, s35
  v_mfma_f32_32x32x16_bf16 a[128:143], a[184:187], v[180:183], a[128:143]
  ds_read_b64_tr_b16 a[180:181], v15 offset:14336
  ds_read_b64_tr_b16 a[182:183], v15 offset:14848
  v_mfma_f32_32x32x16_bf16 a[144:159], a[188:191], v[180:183], a[144:159]
  ds_read_b64_tr_b16 a[184:185], v16 offset:12288
  ds_read_b64_tr_b16 a[186:187], v16 offset:12800
  buffer_load_dwordx4 v[176:179], v20, s[24:27], s82 offen offset:2048 sc0 sc1
  v_mfma_f32_32x32x16_bf16 a[96:111], a[160:163], v[184:187], a[96:111]
  ds_read_b64_tr_b16 a[188:189], v16 offset:14336
  ds_read_b64_tr_b16 a[190:191], v16 offset:14848
  s_waitcnt lgkmcnt(8)
  buffer_load_dwordx4 v[180:183], v20, s[24:27], s82 offen offset:3072 sc0 sc1
  v_mfma_f32_32x32x16_bf16 a[112:127], a[164:167], v[184:187], a[112:127]
  v_mfma_f32_32x32x16_bf16 a[128:143], a[168:171], v[184:187], a[128:143]
  s_waitcnt vmcnt(31) lgkmcnt(0)
  s_barrier
  ds_read_b64_tr_b16 a[160:161], v15 offset:16384
  ds_read_b64_tr_b16 a[162:163], v15 offset:16896
  ds_read_b64_tr_b16 a[164:165], v15 offset:18432
  ds_read_b64_tr_b16 a[166:167], v15 offset:18944
  s_waitcnt vmcnt(6)
  v_mov_b32_e64 v48, s29
  v_bitop3_b32 v97, v97, v99, s32 bitop3:0x7e
  v_min_u32_e64 v97, 1, v97
  v_bitop3_b32 v101, v101, v103, s32 bitop3:0x7e
  v_min_u32_e64 v101, 1, v101
  v_add3_u32 v48, v48, v101, v97
  v_bitop3_b32 v105, v105, v107, s32 bitop3:0x7e
  v_min_u32_e64 v105, 1, v105
  v_bitop3_b32 v109, v109, v111, s32 bitop3:0x7e
  v_mfma_f32_32x32x16_bf16 a[144:159], a[172:175], v[184:187], a[144:159]
  s_mul_i32 s84, s35, 1728
  s_add_u32 m0, s3, 40960
  s_add_u32 s84, s84, s94
  ds_read_b64_tr_b16 a[168:169], v16 offset:16384
  ds_read_b64_tr_b16 a[170:171], v16 offset:16896
  buffer_load_dwordx4 v3, s[16:19], s84 offen offset:0  lds
  v_min_u32_e32 v109, 1, v109
  v_add3_u32 v48, v48, v109, v105
  v_bitop3_b32 v113, v113, v115, s32 bitop3:0x7e
  v_min_u32_e64 v113, 1, v113
  v_bitop3_b32 v117, v117, v119, s32 bitop3:0x7e
  v_min_u32_e64 v117, 1, v117
  v_add3_u32 v48, v48, v117, v113
  v_bitop3_b32 v121, v121, v123, s32 bitop3:0x7e
  v_min_u32_e64 v121, 1, v121
  v_bitop3_b32 v125, v125, v127, s32 bitop3:0x7e
  v_mfma_f32_32x32x16_bf16 a[96:111], a[176:179], v[188:191], a[96:111]
  ds_read_b64_tr_b16 a[172:173], v16 offset:18432
  ds_read_b64_tr_b16 a[174:175], v16 offset:18944
  buffer_load_dwordx4 v[184:187], v94, s[24:27], s82 offen offset:0 sc0 sc1
  v_min_u32_e64 v125, 1, v125
  v_add3_u32 v48, v48, v125, v121
  v_bitop3_b32 v129, v129, v131, s32 bitop3:0x7e
  v_min_u32_e64 v129, 1, v129
  v_bitop3_b32 v133, v133, v135, s32 bitop3:0x7e
  v_min_u32_e64 v133, 1, v133
  v_add3_u32 v48, v48, v133, v129
  v_bitop3_b32 v137, v137, v139, s32 bitop3:0x7e
  v_min_u32_e64 v137, 1, v137
  v_bitop3_b32 v141, v141, v143, s32 bitop3:0x7e
  v_min_u32_e64 v141, 1, v141
  v_add3_u32 v48, v48, v141, v137
  v_bitop3_b32 v145, v145, v147, s32 bitop3:0x7e
  v_min_u32_e64 v145, 1, v145
  v_bitop3_b32 v149, v149, v151, s32 bitop3:0x7e
  v_mfma_f32_32x32x16_bf16 a[112:127], a[180:183], v[188:191], a[112:127]
  ds_read_b64_tr_b16 a[176:177], v15 offset:20480
  ds_read_b64_tr_b16 a[178:179], v15 offset:20992
  buffer_load_dwordx4 v4, s[16:19], s84 offen offset:1024  lds
  v_min_u32_e64 v149, 1, v149
  v_add3_u32 v48, v48, v149, v145
  v_bitop3_b32 v153, v153, v155, s32 bitop3:0x7e
  v_min_u32_e32 v153, 1, v153
  v_add_u32_e32 v48, v48, v153
  v_cmp_ne_u32 vcc, 15, v48
  v_mfma_f32_32x32x16_bf16 a[128:143], a[184:187], v[188:191], a[128:143]
  ds_read_b64_tr_b16 a[180:181], v15 offset:22528
  ds_read_b64_tr_b16 a[182:183], v15 offset:23040
  s_waitcnt lgkmcnt(8)
  s_cbranch_vccnz L_gr2
L_grr2:
  v_xor_b32_e32 v92, 16, v44
  v_xor_b32_e32 v93, 32, v45
  v_fmac_f32_e32 v100, v32, v96
  v_fmac_f32_e64 v102, v32, v98
  v_fma_f32 v100, -v33, v98, v100
  v_fmac_f32_e32 v102, v33, v96
  v_fmac_f32_e32 v104, v32, v100
  v_fmac_f32_e64 v106, v32, v102
  v_fma_f32 v104, -v33, v102, v104
  v_fmac_f32_e32 v106, v33, v100
  v_fmac_f32_e32 v108, v32, v104
  v_fmac_f32_e64 v110, v32, v106
  v_readlane_b32 s83, v21, 9
  v_mfma_f32_32x32x16_bf16 a[144:159], a[188:191], v[188:191], a[144:159]
  ds_read_b64_tr_b16 a[184:185], v16 offset:20480
  ds_read_b64_tr_b16 a[186:187], v16 offset:20992
  v_fma_f32 v108, -v33, v106, v108
  v_fmac_f32_e32 v110, v33, v104
  v_fmac_f32_e32 v112, v32, v108
  v_fmac_f32_e64 v114, v32, v110
  v_fma_f32 v112, -v33, v110, v112
  v_fmac_f32_e32 v114, v33, v108
  v_fmac_f32_e32 v116, v32, v112
  v_fmac_f32_e64 v118, v32, v114
  v_fma_f32 v116, -v33, v114, v116
  v_fmac_f32_e32 v118, v33, v112
  v_fmac_f32_e32 v120, v32, v116
  v_fmac_f32_e64 v122, v32, v118
  v_fma_f32 v120, -v33, v118, v120
  v_fmac_f32_e32 v122, v33, v116
  v_fmac_f32_e32 v124, v32, v120
  v_mfma_f32_32x32x16_bf16 a[96:111], a[160:163], v[192:195], a[96:111]
  ds_read_b64_tr_b16 a[188:189], v16 offset:22528
  ds_read_b64_tr_b16 a[190:191], v16 offset:23040
  buffer_load_dwordx4 v[188:191], v20, s[24:27], s83 offen offset:0 sc0 sc1
  v_fmac_f32_e64 v126, v32, v122
  v_fma_f32 v124, -v33, v122, v124
  v_fmac_f32_e32 v126, v33, v120
  v_fmac_f32_e32 v128, v32, v124
  v_fmac_f32_e64 v130, v32, v126
  v_fma_f32 v128, -v33, v126, v128
  v_fmac_f32_e32 v130, v33, v124
  v_fmac_f32_e32 v132, v32, v128
  v_fmac_f32_e64 v134, v32, v130
  v_fma_f32 v132, -v33, v130, v132
  v_fmac_f32_e32 v134, v33, v128
  v_fmac_f32_e32 v136, v32, v132
  v_fmac_f32_e64 v138, v32, v134
  v_fma_f32 v136, -v33, v134, v136
  v_fmac_f32_e64 v138, v33, v132
  v_mfma_f32_32x32x16_bf16 a[112:127], a[164:167], v[192:195], a[112:127]
  s_add_u32 m0, s3, 40960
  ds_read_b64_tr_b16 a[160:161], v15 offset:24576
  ds_read_b64_tr_b16 a[162:163], v15 offset:25088
  s_waitcnt lgkmcnt(8)
  buffer_load_dwordx4 v3, s[20:23], s84 offen offset:2048  lds
  v_fmac_f32_e32 v140, v32, v136
  v_fmac_f32_e64 v142, v32, v138
  v_fma_f32 v140, -v33, v138, v140
  v_fmac_f32_e32 v142, v33, v136
  v_fmac_f32_e32 v144, v32, v140
  v_fmac_f32_e64 v146, v32, v142
  v_fma_f32 v144, -v33, v142, v144
  v_fmac_f32_e32 v146, v33, v140
  v_fmac_f32_e32 v148, v32, v144
  v_fmac_f32_e64 v150, v32, v146
  v_fma_f32 v148, -v33, v146, v148
  v_fmac_f32_e64 v150, v33, v144
  v_mfma_f32_32x32x16_bf16 a[128:143], a[168:171], v[192:195], a[128:143]
  ds_read_b64_tr_b16 a[164:165], v15 offset:26624
  ds_read_b64_tr_b16 a[166:167], v15 offset:27136
  v_fmac_f32_e32 v152, v32, v148
  v_fmac_f32_e32 v154, v32, v150
  v_fma_f32 v152, -v33, v150, v152
  v_fmac_f32_e32 v154, v33, v148
  v_fmac_f32_e32 v38, v34, v152
  v_fmac_f32_e64 v39, v34, v154
  v_fma_f32 v38, -v35, v154, v38
  v_fmac_f32_e32 v39, v35, v152
  v_fmac_f32_e32 v40, v36, v152
  v_fmac_f32_e64 v41, v36, v154
  v_fma_f32 v40, -v37, v154, v40
  v_fmac_f32_e32 v41, v37, v152
  s_nop 0
  v_permlane32_swap_b32 v38, v40
  v_permlane32_swap_b32 v39, v41
  v_mfma_f32_32x32x16_bf16 a[144:159], a[172:175], v[192:195], a[144:159]
  ds_read_b64_tr_b16 a[168:169], v16 offset:24576
  ds_read_b64_tr_b16 a[170:171], v16 offset:25088
  s_mul_i32 s95, s34, 160
  s_mul_i32 s72, s33, 81920
  s_add_u32 s72, s72, s95
  s_lshl_b32 s93, s33, 9
  s_add_u32 s93, s93, 12582912
  v_lshrrev_b32_e32 v128, 2, v0
  v_and_b32_e32 v129, 3, v0
  v_mul_u32_u24 v130, 1280, v128
  v_lshl_add_u32 v130, v129, 3, v130
  v_lshlrev_b32_e64 v131, 3, v128
  v_lshl_add_u32 v144, v129, 3, s95
  v_accvgpr_read_b32 v48, a0
  v_accvgpr_read_b32 v49, a16
  v_fmac_f32_e32 v48, v22, v38
  v_fmac_f32_e32 v49, v22, v39
  v_mfma_f32_32x32x16_bf16 a[96:111], a[176:179], v[196:199], a[96:111]
  ds_read_b64_tr_b16 a[172:173], v16 offset:26624
  ds_read_b64_tr_b16 a[174:175], v16 offset:27136
  s_waitcnt lgkmcnt(8)
  buffer_load_dwordx2 v[132:133], v131, s[24:27], s93 offen sc0 sc1
  v_fma_f32 v48, -v23, v39, v48
  v_fmac_f32_e32 v49, v23, v38
  v_mul_f32_e32 v52, v24, v48
  v_mul_f32_e32 v54, v24, v49
  v_fma_f32 v52, -v25, v49, v52
  v_fma_f32 v54, -v25, v48, -v54
  v_accvgpr_read_b32 v50, a1
  v_accvgpr_read_b32 v51, a17
  v_fmac_f32_e32 v50, v22, v48
  v_fmac_f32_e32 v51, v22, v49
  v_fma_f32 v50, -v23, v49, v50
  v_fmac_f32_e32 v51, v23, v48
  v_mul_f32_e32 v53, v24, v50
  v_mfma_f32_32x32x16_bf16 a[112:127], a[180:183], v[196:199], a[112:127]
  ds_read_b64_tr_b16 a[176:177], v15 offset:28672
  ds_read_b64_tr_b16 a[178:179], v15 offset:29184
  buffer_load_dwordx4 v4, s[20:23], s84 offen offset:3072  lds
  s_addk_i32 s35, 128
  s_cmpk_eq_u32 s35, 1280
  s_cselect_b32 s35, 0, s35
  v_mul_f32_e32 v55, v24, v51
  v_fma_f32 v53, -v25, v51, v53
  v_fma_f32 v55, -v25, v50, -v55
  v_cvt_pk_bf16_f32 v96, v52, v53
  v_cvt_pk_bf16_f32 v104, v54, v55
  v_accvgpr_read_b32 v48, a2
  v_accvgpr_read_b32 v49, a18
  v_fmac_f32_e32 v48, v22, v50
  v_fmac_f32_e32 v49, v22, v51
  v_fma_f32 v48, -v23, v51, v48
  v_mfma_f32_32x32x16_bf16 a[128:143], a[184:187], v[196:199], a[128:143]
  ds_read_b64_tr_b16 a[180:181], v15 offset:30720
  ds_read_b64_tr_b16 a[182:183], v15 offset:31232
  buffer_load_dwordx2 v[134:135], v130, s[4:7], s72 offen offset:0
  v_fmac_f32_e32 v49, v23, v50
  v_mul_f32_e32 v52, v24, v48
  v_mul_f32_e64 v54, v24, v49
  v_fma_f32 v52, -v25, v49, v52
  v_fma_f32 v54, -v25, v48, -v54
  v_accvgpr_read_b32 v50, a3
  v_accvgpr_read_b32 v51, a19
  v_fmac_f32_e32 v50, v22, v48
  v_fmac_f32_e32 v51, v22, v49
  v_fma_f32 v50, -v23, v49, v50
  v_fmac_f32_e32 v51, v23, v48
  v_mul_f32_e32 v53, v24, v50
  v_mul_f32_e64 v55, v24, v51
  v_fma_f32 v53, -v25, v51, v53
  v_mfma_f32_32x32x16_bf16 a[144:159], a[188:191], v[196:199], a[144:159]
  ds_read_b64_tr_b16 a[184:185], v16 offset:28672
  ds_read_b64_tr_b16 a[186:187], v16 offset:29184
  s_waitcnt lgkmcnt(8)
  global_load_dwordx2 v[150:151], v144, s[52:53] offset:0
  v_fma_f32 v55, -v25, v50, -v55
  v_cvt_pk_bf16_f32 v97, v52, v53
  v_cvt_pk_bf16_f32 v105, v54, v55
  v_accvgpr_read_b32 v48, a4
  v_accvgpr_read_b32 v49, a20
  v_fmac_f32_e32 v48, v22, v50
  v_fmac_f32_e64 v49, v22, v51
  v_fma_f32 v48, -v23, v51, v48
  v_fmac_f32_e32 v49, v23, v50
  v_mul_f32_e32 v52, v24, v48
  v_mul_f32_e64 v54, v24, v49
  v_fma_f32 v52, -v25, v49, v52
  v_fma_f32 v54, -v25, v48, -v54
  v_mfma_f32_32x32x16_bf16 a[96:111], a[160:163], v[200:203], a[96:111]
  ds_read_b64_tr_b16 a[188:189], v16 offset:30720
  ds_read_b64_tr_b16 a[190:191], v16 offset:31232
  buffer_load_dwordx4 v[192:195], v20, s[24:27], s83 offen offset:1024 sc0 sc1
  v_accvgpr_read_b32 v50, a5
  v_accvgpr_read_b32 v51, a21
  v_fmac_f32_e32 v50, v22, v48
  v_fmac_f32_e32 v51, v22, v49
  v_fma_f32 v50, -v23, v49, v50
  v_fmac_f32_e32 v51, v23, v48
  v_mul_f32_e32 v53, v24, v50
  v_mul_f32_e64 v55, v24, v51
  v_fma_f32 v53, -v25, v51, v53
  v_fma_f32 v55, -v25, v50, -v55
  v_cvt_pk_bf16_f32 v98, v52, v53
  v_cvt_pk_bf16_f32 v106, v54, v55
  v_accvgpr_read_b32 v48, a6
  v_accvgpr_read_b32 v49, a22
  v_fmac_f32_e64 v48, v22, v50
  v_mfma_f32_32x32x16_bf16 a[112:127], a[164:167], v[200:203], a[112:127]
  buffer_load_dwordx2 v[136:137], v130, s[4:7], s72 offen offset:32
  v_fmac_f32_e64 v49, v22, v51
  v_fma_f32 v48, -v23, v51, v48
  v_fmac_f32_e32 v49, v23, v50
  v_mul_f32_e32 v52, v24, v48
  v_mul_f32_e64 v54, v24, v49
  v_fma_f32 v52, -v25, v49, v52
  v_fma_f32 v54, -v25, v48, -v54
  v_accvgpr_read_b32 v50, a7
  v_accvgpr_read_b32 v51, a23
  v_fmac_f32_e32 v50, v22, v48
  v_fmac_f32_e32 v51, v22, v49
  v_fma_f32 v50, -v23, v49, v50
  v_fmac_f32_e32 v51, v23, v48
  v_mul_f32_e32 v53, v24, v50
  v_mul_f32_e64 v55, v24, v51
  v_fma_f32 v53, -v25, v51, v53
  v_mfma_f32_32x32x16_bf16 a[128:143], a[168:171], v[200:203], a[128:143]
  s_waitcnt lgkmcnt(0)
  s_barrier
  ds_read_b64_tr_b16 a[160:161], v13 offset:0
  ds_read_b64_tr_b16 a[162:163], v13 offset:512
  ds_read_b64_tr_b16 a[164:165], v13 offset:2048
  ds_read_b64_tr_b16 a[166:167], v13 offset:2560
  global_load_dwordx2 v[154:155], v144, s[52:53] offset:32
  v_fma_f32 v55, -v25, v50, -v55
  v_cvt_pk_bf16_f32 v99, v52, v53
  v_cvt_pk_bf16_f32 v107, v54, v55
  v_accvgpr_read_b32 v48, a8
  v_accvgpr_read_b32 v49, a24
  v_fmac_f32_e32 v48, v22, v50
  v_fmac_f32_e32 v49, v22, v51
  v_fma_f32 v48, -v23, v51, v48
  v_mfma_f32_32x32x16_bf16 a[144:159], a[172:175], v[200:203], a[144:159]
  ds_read_b64_tr_b16 a[168:169], v14 offset:0
  ds_read_b64_tr_b16 a[170:171], v14 offset:512
  buffer_load_dwordx4 v[196:199], v20, s[24:27], s83 offen offset:2048 sc0 sc1
  v_fmac_f32_e32 v49, v23, v50
  v_mul_f32_e32 v52, v24, v48
  v_mul_f32_e64 v54, v24, v49
  v_fma_f32 v52, -v25, v49, v52
  v_fma_f32 v54, -v25, v48, -v54
  v_accvgpr_read_b32 v50, a9
  v_accvgpr_read_b32 v51, a25
  v_fmac_f32_e32 v50, v22, v48
  v_fmac_f32_e32 v51, v22, v49
  v_fma_f32 v50, -v23, v49, v50
  v_fmac_f32_e32 v51, v23, v48
  v_mul_f32_e32 v53, v24, v50
  v_mul_f32_e64 v55, v24, v51
  v_fma_f32 v53, -v25, v51, v53
  v_fma_f32 v55, -v25, v50, -v55
  v_mfma_f32_32x32x16_bf16 a[96:111], a[176:179], v[204:207], a[96:111]
  ds_read_b64_tr_b16 a[172:173], v14 offset:2048
  ds_read_b64_tr_b16 a[174:175], v14 offset:2560
  buffer_load_dwordx2 v[138:139], v130, s[4:7], s72 offen offset:64
  v_cvt_pk_bf16_f32 v100, v52, v53
  v_cvt_pk_bf16_f32 v108, v54, v55
  v_accvgpr_read_b32 v48, a10
  v_accvgpr_read_b32 v49, a26
  v_fmac_f32_e32 v48, v22, v50
  v_fmac_f32_e32 v49, v22, v51
  v_fma_f32 v48, -v23, v51, v48
  v_fmac_f32_e32 v49, v23, v50
  v_mul_f32_e32 v52, v24, v48
  v_mul_f32_e64 v54, v24, v49
  v_fma_f32 v52, -v25, v49, v52
  v_fma_f32 v54, -v25, v48, -v54
  v_accvgpr_read_b32 v50, a11
  v_accvgpr_read_b32 v51, a27
  v_mfma_f32_32x32x16_bf16 a[112:127], a[180:183], v[204:207], a[112:127]
  ds_read_b64_tr_b16 a[176:177], v13 offset:4096
  ds_read_b64_tr_b16 a[178:179], v13 offset:4608
  s_waitcnt lgkmcnt(8)
  global_load_dwordx2 v[158:159], v144, s[52:53] offset:64
  v_fmac_f32_e32 v50, v22, v48
  v_fmac_f32_e64 v51, v22, v49
  v_fma_f32 v50, -v23, v49, v50
  v_fmac_f32_e32 v51, v23, v48
  v_mul_f32_e32 v53, v24, v50
  v_mul_f32_e64 v55, v24, v51
  v_fma_f32 v53, -v25, v51, v53
  v_fma_f32 v55, -v25, v50, -v55
  v_cvt_pk_bf16_f32 v101, v52, v53
  v_cvt_pk_bf16_f32 v109, v54, v55
  v_accvgpr_read_b32 v48, a12
  v_accvgpr_read_b32 v49, a28
  v_fmac_f32_e64 v48, v22, v50
  v_mfma_f32_32x32x16_bf16 a[128:143], a[184:187], v[204:207], a[128:143]
  ds_read_b64_tr_b16 a[180:181], v13 offset:6144
  ds_read_b64_tr_b16 a[182:183], v13 offset:6656
  buffer_load_dwordx4 v[200:203], v20, s[24:27], s83 offen offset:3072 sc0 sc1
  v_fmac_f32_e64 v49, v22, v51
  v_fma_f32 v48, -v23, v51, v48
  v_fmac_f32_e32 v49, v23, v50
  v_mul_f32_e32 v52, v24, v48
  v_mul_f32_e64 v54, v24, v49
  v_fma_f32 v52, -v25, v49, v52
  v_fma_f32 v54, -v25, v48, -v54
  v_accvgpr_read_b32 v50, a13
  v_accvgpr_read_b32 v51, a29
  v_fmac_f32_e32 v50, v22, v48
  v_fmac_f32_e32 v51, v22, v49
  v_fma_f32 v50, -v23, v49, v50
  v_fmac_f32_e32 v51, v23, v48
  v_mul_f32_e32 v53, v24, v50
  v_mul_f32_e64 v55, v24, v51
  v_mfma_f32_32x32x16_bf16 a[144:159], a[188:191], v[204:207], a[144:159]
  ds_read_b64_tr_b16 a[184:185], v14 offset:4096
  ds_read_b64_tr_b16 a[186:187], v14 offset:4608
  buffer_load_dwordx2 v[140:141], v130, s[4:7], s72 offen offset:96
  v_fma_f32 v53, -v25, v51, v53
  v_fma_f32 v55, -v25, v50, -v55
  v_cvt_pk_bf16_f32 v102, v52, v53
  v_cvt_pk_bf16_f32 v110, v54, v55
  v_accvgpr_read_b32 v48, a14
  v_accvgpr_read_b32 v49, a30
  v_fmac_f32_e32 v48, v22, v50
  v_fmac_f32_e32 v49, v22, v51
  v_fma_f32 v48, -v23, v51, v48
  v_fmac_f32_e32 v49, v23, v50
  v_mul_f32_e32 v52, v24, v48
  v_mul_f32_e64 v54, v24, v49
  v_fma_f32 v52, -v25, v49, v52
  v_fma_f32 v54, -v25, v48, -v54
  v_mfma_f32_32x32x16_bf16 a[96:111], a[160:163], v[208:211], a[96:111]
  ds_read_b64_tr_b16 a[188:189], v14 offset:6144
  ds_read_b64_tr_b16 a[190:191], v14 offset:6656
  s_waitcnt lgkmcnt(8)
  global_load_dwordx2 v[162:163], v144, s[52:53] offset:96
  v_accvgpr_read_b32 v50, a15
  v_accvgpr_read_b32 v51, a31
  v_fmac_f32_e32 v50, v22, v48
  v_fmac_f32_e64 v51, v22, v49
  v_fma_f32 v50, -v23, v49, v50
  v_fmac_f32_e32 v51, v23, v48
  v_mul_f32_e32 v53, v24, v50
  v_mul_f32_e64 v55, v24, v51
  v_fma_f32 v53, -v25, v51, v53
  v_fma_f32 v55, -v25, v50, -v55
  v_cvt_pk_bf16_f32 v103, v52, v53
  v_cvt_pk_bf16_f32 v111, v54, v55
  v_mfma_f32_32x32x16_bf16 a[112:127], a[164:167], v[208:211], a[112:127]
  ds_read_b64_tr_b16 a[160:161], v13 offset:8192
  ds_read_b64_tr_b16 a[162:163], v13 offset:8704
  ds_write_b128 v44, v[96:99]
  buffer_load_dwordx4 v[204:207], v94, s[24:27], s83 offen offset:0 sc0 sc1
  v_mfma_f32_32x32x16_bf16 a[128:143], a[168:171], v[208:211], a[128:143]
  ds_read_b64_tr_b16 a[164:165], v13 offset:10240
  ds_read_b64_tr_b16 a[166:167], v13 offset:10752
  buffer_load_dwordx2 v[142:143], v130, s[4:7], s72 offen offset:128
  ds_write_b128 v92, v[100:103]
  v_readlane_b32 s96, v21, 10
  v_mfma_f32_32x32x16_bf16 a[144:159], a[172:175], v[208:211], a[144:159]
  ds_read_b64_tr_b16 a[168:169], v14 offset:8192
  ds_read_b64_tr_b16 a[170:171], v14 offset:8704
  s_waitcnt lgkmcnt(10)
  global_load_dwordx2 v[166:167], v144, s[52:53] offset:128
  ds_read_b64_tr_b16 v[112:113], v45 offset:0
  ds_read_b64_tr_b16 v[114:115], v93 offset:256
  ds_read_b64_tr_b16 v[116:117], v93 offset:0
  ds_read_b64_tr_b16 v[118:119], v45 offset:256
  ds_write_b128 v44, v[104:107]
  v_mfma_f32_32x32x16_bf16 a[96:111], a[176:179], v[212:215], a[96:111]
  ds_read_b64_tr_b16 a[172:173], v14 offset:10240
  ds_read_b64_tr_b16 a[174:175], v14 offset:10752
  ds_write_b128 v92, v[108:111]
  buffer_load_dwordx4 v[208:211], v20, s[24:27], s96 offen offset:0 sc0 sc1
  v_mfma_f32_32x32x16_bf16 a[112:127], a[180:183], v[212:215], a[112:127]
  ds_read_b64_tr_b16 a[176:177], v13 offset:12288
  ds_read_b64_tr_b16 a[178:179], v13 offset:12800
  ds_read_b64_tr_b16 v[120:121], v45 offset:0
  ds_read_b64_tr_b16 v[122:123], v93 offset:256
  ds_read_b64_tr_b16 v[124:125], v93 offset:0
  ds_read_b64_tr_b16 v[126:127], v45 offset:256
  v_readlane_b32 s82, v21, 17
  v_mfma_f32_32x32x16_bf16 a[128:143], a[184:187], v[212:215], a[128:143]
  ds_read_b64_tr_b16 a[180:181], v13 offset:14336
  ds_read_b64_tr_b16 a[182:183], v13 offset:14848
  s_waitcnt lgkmcnt(15)
  v_accvgpr_read_b32 v48, a32
  v_accvgpr_read_b32 v49, a48
  v_fmac_f32_e32 v48, v26, v40
  v_fmac_f32_e32 v49, v26, v41
  v_fma_f32 v48, -v27, v41, v48
  v_fmac_f32_e32 v49, v27, v40
  v_mul_f32_e32 v52, v28, v48
  v_mul_f32_e64 v54, v28, v49
  v_fma_f32 v52, -v29, v49, v52
  v_fma_f32 v54, -v29, v48, -v54
  v_accvgpr_read_b32 v50, a33
  v_accvgpr_read_b32 v51, a49
  v_fmac_f32_e32 v50, v26, v48
  v_fmac_f32_e32 v51, v26, v49
  v_mfma_f32_32x32x16_bf16 a[144:159], a[188:191], v[212:215], a[144:159]
  ds_read_b64_tr_b16 a[184:185], v14 offset:12288
  ds_read_b64_tr_b16 a[186:187], v14 offset:12800
  buffer_load_dwordx4 a[0:3], v20, s[24:27], s82 offen offset:1024 sc0 sc1
  v_fma_f32 v50, -v27, v49, v50
  v_fmac_f32_e32 v51, v27, v48
  v_mul_f32_e32 v53, v28, v50
  v_mul_f32_e64 v55, v28, v51
  v_fma_f32 v53, -v29, v51, v53
  v_fma_f32 v55, -v29, v50, -v55
  v_cvt_pk_bf16_f32 v96, v52, v53
  v_cvt_pk_bf16_f32 v104, v54, v55
  v_accvgpr_read_b32 v48, a34
  v_accvgpr_read_b32 v49, a50
  v_fmac_f32_e32 v48, v26, v50
  v_fmac_f32_e32 v49, v26, v51
  v_fma_f32 v48, -v27, v51, v48
  v_fmac_f32_e32 v49, v27, v50
  v_mul_f32_e32 v52, v28, v48
  v_mfma_f32_32x32x16_bf16 a[96:111], a[160:163], v[216:219], a[96:111]
  ds_read_b64_tr_b16 a[188:189], v14 offset:14336
  ds_read_b64_tr_b16 a[190:191], v14 offset:14848
  s_waitcnt lgkmcnt(6)
  s_add_u32 s85, s92, 0
  buffer_store_dwordx4 v[112:115], v20, s[24:27], s85 offen offset:0 sc0 sc1
  v_mul_f32_e64 v54, v28, v49
  v_fma_f32 v52, -v29, v49, v52
  v_fma_f32 v54, -v29, v48, -v54
  v_accvgpr_read_b32 v50, a35
  v_accvgpr_read_b32 v51, a51
  v_fmac_f32_e32 v50, v26, v48
  v_fmac_f32_e32 v51, v26, v49
  v_fma_f32 v50, -v27, v49, v50
  v_fmac_f32_e32 v51, v27, v48
  v_mul_f32_e32 v53, v28, v50
  v_mul_f32_e64 v55, v28, v51
  v_fma_f32 v53, -v29, v51, v53
  v_mfma_f32_32x32x16_bf16 a[112:127], a[164:167], v[216:219], a[112:127]
  buffer_store_dwordx4 v[116:119], v20, s[24:27], s85 offen offset:1024 sc0 sc1
  v_fma_f32 v55, -v29, v50, -v55
  v_cvt_pk_bf16_f32 v97, v52, v53
  v_cvt_pk_bf16_f32 v105, v54, v55
  v_accvgpr_read_b32 v48, a36
  v_accvgpr_read_b32 v49, a52
  v_fmac_f32_e32 v48, v26, v50
  v_fmac_f32_e32 v49, v26, v51
  v_fma_f32 v48, -v27, v51, v48
  v_fmac_f32_e32 v49, v27, v50
  v_mul_f32_e32 v52, v28, v48
  v_mul_f32_e64 v54, v28, v49
  v_fma_f32 v52, -v29, v49, v52
  v_fma_f32 v54, -v29, v48, -v54
  v_accvgpr_read_b32 v50, a37
  v_accvgpr_read_b32 v51, a53
  v_mfma_f32_32x32x16_bf16 a[128:143], a[168:171], v[216:219], a[128:143]
  s_waitcnt vmcnt(27) lgkmcnt(0)
  s_barrier
  ds_read_b64_tr_b16 a[160:161], v13 offset:24576
  ds_read_b64_tr_b16 a[162:163], v13 offset:25088
  ds_read_b64_tr_b16 a[164:165], v13 offset:26624
  ds_read_b64_tr_b16 a[166:167], v13 offset:27136
  s_add_u32 s85, s92, 8192
  buffer_store_dwordx4 v[120:123], v20, s[24:27], s85 offen offset:0 sc0 sc1
  v_fmac_f32_e32 v50, v26, v48
  v_fmac_f32_e32 v51, v26, v49
  v_fma_f32 v50, -v27, v49, v50
  v_fmac_f32_e32 v51, v27, v48
  v_mul_f32_e32 v53, v28, v50
  v_mul_f32_e64 v55, v28, v51
  v_fma_f32 v53, -v29, v51, v53
  v_fma_f32 v55, -v29, v50, -v55
  v_mfma_f32_32x32x16_bf16 a[144:159], a[172:175], v[216:219], a[144:159]
  ds_read_b64_tr_b16 a[168:169], v14 offset:24576
  ds_read_b64_tr_b16 a[170:171], v14 offset:25088
  buffer_store_dwordx4 v[124:127], v20, s[24:27], s85 offen offset:1024 sc0 sc1
  v_cvt_pk_bf16_f32 v98, v52, v53
  v_cvt_pk_bf16_f32 v106, v54, v55
  v_accvgpr_read_b32 v48, a38
  v_accvgpr_read_b32 v49, a54
  v_fmac_f32_e32 v48, v26, v50
  v_fmac_f32_e32 v49, v26, v51
  v_fma_f32 v48, -v27, v51, v48
  v_fmac_f32_e32 v49, v27, v50
  v_mul_f32_e32 v52, v28, v48
  v_mul_f32_e64 v54, v28, v49
  v_fma_f32 v52, -v29, v49, v52
  v_fma_f32 v54, -v29, v48, -v54
  v_accvgpr_read_b32 v50, a39
  v_accvgpr_read_b32 v51, a55
  v_mfma_f32_32x32x16_bf16 a[96:111], a[176:179], v[220:223], a[96:111]
  ds_read_b64_tr_b16 a[172:173], v14 offset:26624
  ds_read_b64_tr_b16 a[174:175], v14 offset:27136
  buffer_load_dwordx4 a[4:7], v20, s[24:27], s82 offen offset:2048 sc0 sc1
  v_fmac_f32_e32 v50, v26, v48
  v_fmac_f32_e32 v51, v26, v49
  v_fma_f32 v50, -v27, v49, v50
  v_fmac_f32_e32 v51, v27, v48
  v_mul_f32_e32 v53, v28, v50
  v_mul_f32_e64 v55, v28, v51
  v_fma_f32 v53, -v29, v51, v53
  v_fma_f32 v55, -v29, v50, -v55
  v_cvt_pk_bf16_f32 v99, v52, v53
  v_cvt_pk_bf16_f32 v107, v54, v55
  v_accvgpr_read_b32 v48, a40
  v_accvgpr_read_b32 v49, a56
  v_fmac_f32_e32 v48, v26, v50
  v_fmac_f32_e32 v49, v26, v51
  v_mfma_f32_32x32x16_bf16 a[112:127], a[180:183], v[220:223], a[112:127]
  ds_read_b64_tr_b16 a[176:177], v13 offset:28672
  ds_read_b64_tr_b16 a[178:179], v13 offset:29184
  buffer_load_dwordx4 a[8:11], v20, s[24:27], s82 offen offset:3072 sc0 sc1
  v_fma_f32 v48, -v27, v51, v48
  v_fmac_f32_e32 v49, v27, v50
  v_mul_f32_e32 v52, v28, v48
  v_mul_f32_e64 v54, v28, v49
  v_fma_f32 v52, -v29, v49, v52
  v_fma_f32 v54, -v29, v48, -v54
  v_accvgpr_read_b32 v50, a41
  v_accvgpr_read_b32 v51, a57
  v_fmac_f32_e32 v50, v26, v48
  v_fmac_f32_e32 v51, v26, v49
  v_fma_f32 v50, -v27, v49, v50
  v_fmac_f32_e32 v51, v27, v48
  v_mul_f32_e32 v53, v28, v50
  v_mul_f32_e64 v55, v28, v51
  v_fma_f32 v53, -v29, v51, v53
  v_mfma_f32_32x32x16_bf16 a[128:143], a[184:187], v[220:223], a[128:143]
  ds_read_b64_tr_b16 a[180:181], v13 offset:30720
  ds_read_b64_tr_b16 a[182:183], v13 offset:31232
  v_fma_f32 v55, -v29, v50, -v55
  v_cvt_pk_bf16_f32 v100, v52, v53
  v_cvt_pk_bf16_f32 v108, v54, v55
  v_accvgpr_read_b32 v48, a42
  v_accvgpr_read_b32 v49, a58
  v_fmac_f32_e32 v48, v26, v50
  v_fmac_f32_e32 v49, v26, v51
  v_fma_f32 v48, -v27, v51, v48
  v_fmac_f32_e32 v49, v27, v50
  v_mul_f32_e32 v52, v28, v48
  v_mul_f32_e64 v54, v28, v49
  v_fma_f32 v52, -v29, v49, v52
  v_fma_f32 v54, -v29, v48, -v54
  v_accvgpr_read_b32 v50, a43
  v_accvgpr_read_b32 v51, a59
  v_readlane_b32 s83, v21, 18
  v_mfma_f32_32x32x16_bf16 a[144:159], a[188:191], v[220:223], a[144:159]
  ds_read_b64_tr_b16 a[184:185], v14 offset:28672
  ds_read_b64_tr_b16 a[186:187], v14 offset:29184
  s_waitcnt lgkmcnt(8)
  buffer_load_dwordx4 a[12:15], v94, s[24:27], s82 offen offset:0 sc0 sc1
  v_fmac_f32_e32 v50, v26, v48
  v_fmac_f32_e64 v51, v26, v49
  v_fma_f32 v50, -v27, v49, v50
  v_fmac_f32_e32 v51, v27, v48
  v_mul_f32_e32 v53, v28, v50
  v_mul_f32_e64 v55, v28, v51
  v_fma_f32 v53, -v29, v51, v53
  v_fma_f32 v55, -v29, v50, -v55
  v_cvt_pk_bf16_f32 v101, v52, v53
  v_cvt_pk_bf16_f32 v109, v54, v55
  v_accvgpr_read_b32 v48, a44
  v_accvgpr_read_b32 v49, a60
  v_fmac_f32_e32 v48, v26, v50
  v_fmac_f32_e32 v49, v26, v51
  v_mfma_f32_32x32x16_bf16 a[96:111], a[160:163], v[224:227], a[96:111]
  ds_read_b64_tr_b16 a[188:189], v14 offset:30720
  ds_read_b64_tr_b16 a[190:191], v14 offset:31232
  buffer_load_dwordx4 a[16:19], v20, s[24:27], s83 offen offset:0 sc0 sc1
  v_fma_f32 v48, -v27, v51, v48
  v_fmac_f32_e32 v49, v27, v50
  v_mul_f32_e32 v52, v28, v48
  v_mul_f32_e64 v54, v28, v49
  v_fma_f32 v52, -v29, v49, v52
  v_fma_f32 v54, -v29, v48, -v54
  v_accvgpr_read_b32 v50, a45
  v_accvgpr_read_b32 v51, a61
  v_fmac_f32_e32 v50, v26, v48
  v_fmac_f32_e32 v51, v26, v49
  v_fma_f32 v50, -v27, v49, v50
  v_fmac_f32_e32 v51, v27, v48
  v_mul_f32_e32 v53, v28, v50
  v_mul_f32_e64 v55, v28, v51
  v_fma_f32 v53, -v29, v51, v53
  v_mfma_f32_32x32x16_bf16 a[112:127], a[164:167], v[224:227], a[112:127]
  ds_read_b64_tr_b16 a[160:161], v13 offset:32768
  ds_read_b64_tr_b16 a[162:163], v13 offset:33280
  buffer_load_dwordx4 a[20:23], v20, s[24:27], s83 offen offset:1024 sc0 sc1
  v_fma_f32 v55, -v29, v50, -v55
  v_cvt_pk_bf16_f32 v102, v52, v53
  v_cvt_pk_bf16_f32 v110, v54, v55
  v_accvgpr_read_b32 v48, a46
  v_accvgpr_read_b32 v49, a62
  v_fmac_f32_e32 v48, v26, v50
  v_fmac_f32_e32 v49, v26, v51
  v_fma_f32 v48, -v27, v51, v48
  v_fmac_f32_e32 v49, v27, v50
  v_mul_f32_e32 v52, v28, v48
  v_mul_f32_e64 v54, v28, v49
  v_fma_f32 v52, -v29, v49, v52
  v_fma_f32 v54, -v29, v48, -v54
  v_accvgpr_read_b32 v50, a47
  v_accvgpr_read_b32 v51, a63
  v_mfma_f32_32x32x16_bf16 a[128:143], a[168:171], v[224:227], a[128:143]
  ds_read_b64_tr_b16 a[164:165], v13 offset:34816
  ds_read_b64_tr_b16 a[166:167], v13 offset:35328
  s_waitcnt lgkmcnt(8)
  v_fmac_f32_e32 v50, v26, v48
  v_fmac_f32_e64 v51, v26, v49
  v_fma_f32 v50, -v27, v49, v50
  v_fmac_f32_e32 v51, v27, v48
  v_mul_f32_e32 v53, v28, v50
  v_mul_f32_e64 v55, v28, v51
  v_fma_f32 v53, -v29, v51, v53
  v_fma_f32 v55, -v29, v50, -v55
  v_cvt_pk_bf16_f32 v103, v52, v53
  v_cvt_pk_bf16_f32 v111, v54, v55
  v_mfma_f32_32x32x16_bf16 a[144:159], a[172:175], v[224:227], a[144:159]
  ds_read_b64_tr_b16 a[168:169], v14 offset:32768
  ds_read_b64_tr_b16 a[170:171], v14 offset:33280
  ds_write_b128 v44, v[96:99]
  buffer_load_dwordx4 a[24:27], v20, s[24:27], s83 offen offset:2048 sc0 sc1
  v_readlane_b32 s96, v21, 10
  v_mfma_f32_32x32x16_bf16 a[96:111], a[176:179], v[228:231], a[96:111]
  ds_read_b64_tr_b16 a[172:173], v14 offset:34816
  ds_read_b64_tr_b16 a[174:175], v14 offset:35328
  ds_write_b128 v92, v[100:103]
  buffer_load_dwordx4 a[28:31], v20, s[24:27], s83 offen offset:3072 sc0 sc1
  v_mfma_f32_32x32x16_bf16 a[112:127], a[180:183], v[228:231], a[112:127]
  ds_read_b64_tr_b16 a[176:177], v13 offset:36864
  ds_read_b64_tr_b16 a[178:179], v13 offset:37376
  s_waitcnt lgkmcnt(10)
  ds_read_b64_tr_b16 v[112:113], v45 offset:0
  ds_read_b64_tr_b16 v[114:115], v93 offset:256
  ds_read_b64_tr_b16 v[116:117], v93 offset:0
  ds_read_b64_tr_b16 v[118:119], v45 offset:256
  ds_write_b128 v44, v[104:107]
  buffer_load_dwordx4 v[212:215], v20, s[24:27], s96 offen offset:1024 sc0 sc1
  v_mfma_f32_32x32x16_bf16 a[128:143], a[184:187], v[228:231], a[128:143]
  ds_read_b64_tr_b16 a[180:181], v13 offset:38912
  ds_read_b64_tr_b16 a[182:183], v13 offset:39424
  ds_write_b128 v92, v[108:111]
  v_mfma_f32_32x32x16_bf16 a[144:159], a[188:191], v[228:231], a[144:159]
  ds_read_b64_tr_b16 a[184:185], v14 offset:36864
  ds_read_b64_tr_b16 a[186:187], v14 offset:37376
  ds_read_b64_tr_b16 v[120:121], v45 offset:0
  ds_read_b64_tr_b16 v[122:123], v93 offset:256
  ds_read_b64_tr_b16 v[124:125], v93 offset:0
  ds_read_b64_tr_b16 v[126:127], v45 offset:256
  buffer_load_dwordx4 v[216:219], v20, s[24:27], s96 offen offset:2048 sc0 sc1
  v_mfma_f32_32x32x16_bf16 a[96:111], a[160:163], v[232:235], a[96:111]
  ds_read_b64_tr_b16 a[188:189], v14 offset:38912
  ds_read_b64_tr_b16 a[190:191], v14 offset:39424
  s_waitcnt lgkmcnt(15)
  buffer_load_dwordx4 v[220:223], v20, s[24:27], s96 offen offset:3072 sc0 sc1
  v_mfma_f32_32x32x16_bf16 a[112:127], a[164:167], v[232:235], a[112:127]
  v_mfma_f32_32x32x16_bf16 a[128:143], a[168:171], v[232:235], a[128:143]
  s_waitcnt vmcnt(30) lgkmcnt(0)
  s_barrier
  ds_read_b64_tr_b16 a[160:161], v15 offset:0
  ds_read_b64_tr_b16 a[162:163], v15 offset:512
  ds_read_b64_tr_b16 a[164:165], v15 offset:2048
  ds_read_b64_tr_b16 a[166:167], v15 offset:2560
  s_add_u32 s85, s92, 4096
  buffer_store_dwordx4 v[112:115], v20, s[24:27], s85 offen offset:0 sc0 sc1
  v_mfma_f32_32x32x16_bf16 a[144:159], a[172:175], v[232:235], a[144:159]
  ds_read_b64_tr_b16 a[168:169], v15 offset:4096
  ds_read_b64_tr_b16 a[170:171], v15 offset:4608
  buffer_store_dwordx4 v[116:119], v20, s[24:27], s85 offen offset:1024 sc0 sc1
  v_mfma_f32_32x32x16_bf16 a[96:111], a[176:179], v[236:239], a[96:111]
  ds_read_b64_tr_b16 a[172:173], v15 offset:6144
  ds_read_b64_tr_b16 a[174:175], v15 offset:6656
  s_add_u32 s85, s92, 12288
  buffer_store_dwordx4 v[120:123], v20, s[24:27], s85 offen offset:0 sc0 sc1
  v_mfma_f32_32x32x16_bf16 a[112:127], a[180:183], v[236:239], a[112:127]
  ds_read_b64_tr_b16 a[176:177], v15 offset:8192
  ds_read_b64_tr_b16 a[178:179], v15 offset:8704
  buffer_store_dwordx4 v[124:127], v20, s[24:27], s85 offen offset:1024 sc0 sc1
  v_readlane_b32 s82, v21, 11
  v_mfma_f32_32x32x16_bf16 a[128:143], a[184:187], v[236:239], a[128:143]
  ds_read_b64_tr_b16 a[180:181], v15 offset:10240
  ds_read_b64_tr_b16 a[182:183], v15 offset:10752
  s_waitcnt lgkmcnt(8)
  buffer_load_dwordx4 v[224:227], v94, s[24:27], s96 offen offset:0 sc0 sc1
  v_readlane_b32 s83, v21, 18
  v_mfma_f32_32x32x16_bf16 a[144:159], a[188:191], v[236:239], a[144:159]
  ds_read_b64_tr_b16 a[184:185], v15 offset:12288
  ds_read_b64_tr_b16 a[186:187], v15 offset:12800
  buffer_load_dwordx4 v[228:231], v20, s[24:27], s82 offen offset:0 sc0 sc1
  v_readlane_b32 s96, v21, 19
  v_mfma_f32_32x32x16_bf16 a[96:111], a[160:163], v[240:243], a[96:111]
  ds_read_b64_tr_b16 a[188:189], v15 offset:14336
  ds_read_b64_tr_b16 a[190:191], v15 offset:14848
  buffer_load_dwordx4 a[32:35], v94, s[24:27], s83 offen offset:0 sc0 sc1
  v_mfma_f32_32x32x16_bf16 a[112:127], a[164:167], v[240:243], a[112:127]
  ds_read_b64_tr_b16 a[160:161], v16 offset:0
  ds_read_b64_tr_b16 a[162:163], v16 offset:512
  s_waitcnt lgkmcnt(8)
  buffer_load_dwordx4 a[36:39], v20, s[24:27], s96 offen offset:0 sc0 sc1
  v_mfma_f32_32x32x16_bf16 a[96:111], a[168:171], v[244:247], a[96:111]
  ds_read_b64_tr_b16 a[164:165], v16 offset:2048
  ds_read_b64_tr_b16 a[166:167], v16 offset:2560
  v_mfma_f32_32x32x16_bf16 a[112:127], a[172:175], v[244:247], a[112:127]
  ds_read_b64_tr_b16 a[168:169], v16 offset:4096
  ds_read_b64_tr_b16 a[170:171], v16 offset:4608
  buffer_load_dwordx4 a[40:43], v20, s[24:27], s96 offen offset:1024 sc0 sc1
  v_mfma_f32_32x32x16_bf16 a[96:111], a[176:179], v[248:251], a[96:111]
  ds_read_b64_tr_b16 a[172:173], v16 offset:6144
  ds_read_b64_tr_b16 a[174:175], v16 offset:6656
  s_waitcnt lgkmcnt(8)
  buffer_load_dwordx4 a[44:47], v20, s[24:27], s96 offen offset:2048 sc0 sc1
  v_mfma_f32_32x32x16_bf16 a[112:127], a[180:183], v[248:251], a[112:127]
  ds_read_b64_tr_b16 a[176:177], v16 offset:8192
  ds_read_b64_tr_b16 a[178:179], v16 offset:8704
  buffer_load_dwordx4 a[48:51], v20, s[24:27], s96 offen offset:3072 sc0 sc1
  v_mfma_f32_32x32x16_bf16 a[96:111], a[184:187], v[252:255], a[96:111]
  ds_read_b64_tr_b16 a[180:181], v16 offset:10240
  ds_read_b64_tr_b16 a[182:183], v16 offset:10752
  v_readlane_b32 s82, v21, 20
  v_mfma_f32_32x32x16_bf16 a[112:127], a[188:191], v[252:255], a[112:127]
  ds_read_b64_tr_b16 a[184:185], v16 offset:12288
  ds_read_b64_tr_b16 a[186:187], v16 offset:12800
  s_waitcnt lgkmcnt(8)
  buffer_load_dwordx4 a[52:55], v94, s[24:27], s96 offen offset:0 sc0 sc1
  v_mfma_f32_32x32x16_bf16 a[128:143], a[160:163], v[240:243], a[128:143]
  ds_read_b64_tr_b16 a[188:189], v16 offset:14336
  ds_read_b64_tr_b16 a[190:191], v16 offset:14848
  buffer_load_dwordx4 a[56:59], v20, s[24:27], s82 offen offset:0 sc0 sc1
  v_mfma_f32_32x32x16_bf16 a[144:159], a[164:167], v[240:243], a[144:159]
  v_mfma_f32_32x32x16_bf16 a[128:143], a[168:171], v[244:247], a[128:143]
  s_waitcnt lgkmcnt(0)
  s_barrier
  v_mfma_f32_32x32x16_bf16 a[144:159], a[172:175], v[244:247], a[144:159]
  s_add_u32 s85, s89, 0
  v_accvgpr_read_b32 v64, a96
  v_accvgpr_read_b32 v65, a97
  v_accvgpr_read_b32 v66, a112
  v_accvgpr_read_b32 v67, a113
  v_max_f32_e32 v64, 0, v64
  v_max_f32_e64 v65, 0, v65
  v_mfma_f32_32x32x16_bf16 a[128:143], a[176:179], v[248:251], a[128:143]
  v_mul_f32_e32 v64, v64, v66
  v_mul_f32_e32 v65, v65, v67
  v_cvt_pk_bf16_f32 v56, v64, v65
  v_accvgpr_read_b32 v68, a98
  v_accvgpr_read_b32 v69, a99
  v_accvgpr_read_b32 v70, a114
  v_accvgpr_read_b32 v71, a115
  v_mfma_f32_32x32x16_bf16 a[144:159], a[180:183], v[248:251], a[144:159]
  v_max_f32_e32 v68, 0, v68
  v_max_f32_e32 v69, 0, v69
  v_mul_f32_e32 v68, v68, v70
  v_mul_f32_e32 v69, v69, v71
  v_cvt_pk_bf16_f32 v57, v68, v69
  v_accvgpr_read_b32 v64, a100
  v_mfma_f32_32x32x16_bf16 a[128:143], a[184:187], v[252:255], a[128:143]
  v_accvgpr_read_b32 v65, a101
  v_accvgpr_read_b32 v66, a116
  v_accvgpr_read_b32 v67, a117
  v_max_f32_e32 v64, 0, v64
  v_max_f32_e32 v65, 0, v65
  v_mul_f32_e32 v64, v64, v66
  v_mul_f32_e32 v65, v65, v67
  v_mfma_f32_32x32x16_bf16 a[144:159], a[188:191], v[252:255], a[144:159]
  v_cvt_pk_bf16_f32 v58, v64, v65
  v_accvgpr_read_b32 v68, a102
  v_accvgpr_read_b32 v69, a103
  v_accvgpr_read_b32 v70, a118
  v_accvgpr_read_b32 v71, a119
  v_max_f32_e32 v68, 0, v68
  v_max_f32_e32 v69, 0, v69
  v_mul_f32_e32 v68, v68, v70
  v_mul_f32_e32 v69, v69, v71
  v_cvt_pk_bf16_f32 v59, v68, v69
  buffer_store_dwordx4 v[56:59], v19, s[24:27], s85 offen offset:0 sc0 sc1
  v_accvgpr_read_b32 v64, a104
  v_accvgpr_read_b32 v65, a105
  v_accvgpr_read_b32 v66, a120
  v_accvgpr_read_b32 v67, a121
  v_max_f32_e32 v64, 0, v64
  v_max_f32_e32 v65, 0, v65
  v_mul_f32_e32 v64, v64, v66
  v_mul_f32_e32 v65, v65, v67
  v_cvt_pk_bf16_f32 v60, v64, v65
  v_accvgpr_read_b32 v68, a106
  v_accvgpr_read_b32 v69, a107
  v_accvgpr_read_b32 v70, a122
  v_accvgpr_read_b32 v71, a123
  v_max_f32_e32 v68, 0, v68
  v_max_f32_e32 v69, 0, v69
  v_mul_f32_e32 v68, v68, v70
  v_mul_f32_e32 v69, v69, v71
  v_cvt_pk_bf16_f32 v61, v68, v69
  v_accvgpr_read_b32 v64, a108
  v_accvgpr_read_b32 v65, a109
  v_accvgpr_read_b32 v66, a124
  v_accvgpr_read_b32 v67, a125
  v_max_f32_e32 v64, 0, v64
  v_max_f32_e32 v65, 0, v65
  v_mul_f32_e32 v64, v64, v66
  v_mul_f32_e32 v65, v65, v67
  v_cvt_pk_bf16_f32 v62, v64, v65
  v_accvgpr_read_b32 v68, a110
  v_accvgpr_read_b32 v69, a111
  v_accvgpr_read_b32 v70, a126
  v_accvgpr_read_b32 v71, a127
  v_max_f32_e32 v68, 0, v68
  v_max_f32_e32 v69, 0, v69
  v_mul_f32_e32 v68, v68, v70
  v_mul_f32_e32 v69, v69, v71
  v_cvt_pk_bf16_f32 v63, v68, v69
  buffer_store_dwordx4 v[60:63], v19, s[24:27], s85 offen offset:512 sc0 sc1
  s_waitcnt vmcnt(11)
  s_barrier
  s_lshl_b32 s84, s29, 11
  s_lshl_b32 s85, s30, 7
  s_add_u32 s84, s84, s85
  s_add_u32 s84, s84, 12943360
  s_cmp_eq_u32 s28, 0
  s_cselect_b32 s84, s84, 0x10000000
  v_mov_b32_e32 v54, 0
  v_mov_b32_e32 v55, s32
  buffer_store_dword v55, v54, s[24:27], s84 offen sc0 sc1
  s_add_u32 s85, s89, 4096
  v_accvgpr_read_b32 v80, a128
  v_accvgpr_read_b32 v81, a129
  v_accvgpr_read_b32 v82, a144
  v_accvgpr_read_b32 v83, a145
  v_max_f32_e32 v80, 0, v80
  v_max_f32_e32 v81, 0, v81
  v_mul_f32_e32 v80, v80, v82
  v_mul_f32_e32 v81, v81, v83
  v_cvt_pk_bf16_f32 v72, v80, v81
  v_accvgpr_read_b32 v84, a130
  v_accvgpr_read_b32 v85, a131
  v_accvgpr_read_b32 v86, a146
  v_accvgpr_read_b32 v87, a147
  v_max_f32_e32 v84, 0, v84
  v_max_f32_e32 v85, 0, v85
  v_mul_f32_e32 v84, v84, v86
  v_mul_f32_e32 v85, v85, v87
  v_cvt_pk_bf16_f32 v73, v84, v85
  v_accvgpr_read_b32 v80, a132
  v_accvgpr_read_b32 v81, a133
  v_accvgpr_read_b32 v82, a148
  v_accvgpr_read_b32 v83, a149
  v_max_f32_e32 v80, 0, v80
  v_max_f32_e32 v81, 0, v81
  v_mul_f32_e32 v80, v80, v82
  v_mul_f32_e32 v81, v81, v83
  v_cvt_pk_bf16_f32 v74, v80, v81
  v_accvgpr_read_b32 v84, a134
  v_accvgpr_read_b32 v85, a135
  v_accvgpr_read_b32 v86, a150
  v_accvgpr_read_b32 v87, a151
  v_max_f32_e32 v84, 0, v84
  v_max_f32_e32 v85, 0, v85
  v_mul_f32_e32 v84, v84, v86
  v_mul_f32_e32 v85, v85, v87
  v_cvt_pk_bf16_f32 v75, v84, v85
  buffer_store_dwordx4 v[72:75], v19, s[24:27], s85 offen offset:0 sc0 sc1
  v_accvgpr_read_b32 v80, a136
  v_accvgpr_read_b32 v81, a137
  v_accvgpr_read_b32 v82, a152
  v_accvgpr_read_b32 v83, a153
  v_max_f32_e32 v80, 0, v80
  v_max_f32_e32 v81, 0, v81
  v_mul_f32_e32 v80, v80, v82
  v_mul_f32_e32 v81, v81, v83
  v_cvt_pk_bf16_f32 v76, v80, v81
  v_accvgpr_read_b32 v84, a138
  v_accvgpr_read_b32 v85, a139
  v_accvgpr_read_b32 v86, a154
  v_accvgpr_read_b32 v87, a155
  v_max_f32_e32 v84, 0, v84
  v_max_f32_e32 v85, 0, v85
  v_mul_f32_e32 v84, v84, v86
  v_mul_f32_e32 v85, v85, v87
  v_cvt_pk_bf16_f32 v77, v84, v85
  v_accvgpr_read_b32 v80, a140
  v_accvgpr_read_b32 v81, a141
  v_accvgpr_read_b32 v82, a156
  v_accvgpr_read_b32 v83, a157
  v_max_f32_e32 v80, 0, v80
  v_max_f32_e32 v81, 0, v81
  v_mul_f32_e32 v80, v80, v82
  v_mul_f32_e32 v81, v81, v83
  v_cvt_pk_bf16_f32 v78, v80, v81
  v_accvgpr_read_b32 v84, a142
  v_accvgpr_read_b32 v85, a143
  v_accvgpr_read_b32 v86, a158
  v_accvgpr_read_b32 v87, a159
  v_max_f32_e32 v84, 0, v84
  v_max_f32_e32 v85, 0, v85
  v_mul_f32_e32 v84, v84, v86
  v_mul_f32_e32 v85, v85, v87
  v_cvt_pk_bf16_f32 v79, v84, v85
  buffer_store_dwordx4 v[76:79], v19, s[24:27], s85 offen offset:512 sc0 sc1
  v_readlane_b32 s83, v21, 11
  s_nop 4
  buffer_load_dwordx4 v[232:235], v20, s[24:27], s83 offen offset:1024 sc0 sc1
  buffer_load_dwordx4 v[236:239], v20, s[24:27], s83 offen offset:2048 sc0 sc1
  buffer_load_dwordx4 v[240:243], v20, s[24:27], s83 offen offset:3072 sc0 sc1
  v_readlane_b32 s96, v21, 12
  buffer_load_dwordx4 v[244:247], v94, s[24:27], s83 offen offset:0 sc0 sc1
  s_nop 3
  buffer_load_dwordx4 v[248:251], v20, s[24:27], s96 offen offset:0 sc0 sc1
  v_readlane_b32 s82, v21, 20
  buffer_load_dwordx4 v[252:255], v20, s[24:27], s96 offen offset:1024 sc0 sc1
  s_nop 3
  buffer_load_dwordx4 a[60:63], v20, s[24:27], s82 offen offset:1024 sc0 sc1
  buffer_load_dwordx4 v[96:99], v20, s[24:27], s82 offen offset:2048 sc0 sc1
  buffer_load_dwordx4 v[100:103], v20, s[24:27], s82 offen offset:3072 sc0 sc1
  v_readlane_b32 s83, v21, 21
  buffer_load_dwordx4 v[104:107], v94, s[24:27], s82 offen offset:0 sc0 sc1
  s_nop 3
  buffer_load_dwordx4 v[108:111], v20, s[24:27], s83 offen offset:0 sc0 sc1
  buffer_load_dwordx4 v[112:115], v20, s[24:27], s83 offen offset:1024 sc0 sc1
  buffer_load_dwordx4 v[116:119], v20, s[24:27], s83 offen offset:2048 sc0 sc1
  s_waitcnt vmcnt(13)
  s_barrier
  s_lshl_b32 s84, s29, 11
  s_lshl_b32 s85, s30, 7
  s_add_u32 s84, s84, s85
  s_add_u32 s84, s84, 12976128
  s_cmp_eq_u32 s28, 0
  s_cselect_b32 s84, s84, 0x10000000
  v_mov_b32_e32 v54, 0
  v_mov_b32_e32 v55, s32
  buffer_store_dword v55, v54, s[24:27], s84 offen sc0 sc1
  buffer_load_dwordx4 v[120:123], v20, s[24:27], s83 offen offset:3072 sc0 sc1
  v_readlane_b32 s96, v21, 4
  buffer_load_dwordx4 v[124:127], v94, s[24:27], s83 offen offset:0 sc0 sc1
  s_add_u32 m0, s97, 0
  s_nop 2
  buffer_load_dwordx4 v20, s[24:27], s96 offen offset:0 sc0 sc1 lds
  buffer_load_dwordx4 v20, s[24:27], s96 offen offset:1024 sc0 sc1 lds
  buffer_load_dwordx4 v20, s[24:27], s96 offen offset:2048 sc0 sc1 lds
  buffer_load_dwordx4 v20, s[24:27], s96 offen offset:3072 sc0 sc1 lds
  v_readlane_b32 s82, v21, 5
  s_add_u32 m0, s97, 4096
  s_nop 0
  buffer_load_dwordx4 v94, s[24:27], s96 offen offset:0 sc0 sc1 lds
  s_add_u32 m0, s97, 5120
  s_nop 0
  buffer_load_dwordx4 v20, s[24:27], s82 offen offset:0 sc0 sc1 lds
  buffer_load_dwordx4 v20, s[24:27], s82 offen offset:1024 sc0 sc1 lds
  buffer_load_dwordx4 v20, s[24:27], s82 offen offset:2048 sc0 sc1 lds
L_P2:
  s_mov_b32 s80, s62
  s_mov_b32 s81, s63
  s_mov_b32 s82, 5242880
  s_mov_b32 s83, 0x20000
  v_mov_b32_e32 v27, v47
  v_and_b32_e32 v16, 15, v1
  v_lshrrev_b32_e64 v17, 4, v1
  v_bfe_u32 v18, v16, 1, 2
  v_xor_b32_e64 v18, v18, v17
  v_mul_u32_u24 v19, 320, v16
  v_lshl_add_u32 v19, v18, 4, v19
  v_add_u32_e32 v15, s97, v19
  v_add_u32_e32 v13, s97, v20
  v_add_u32 v14, 81920, v13
  s_lshr_b32 s84, s33, 1
  s_lshl_b32 s84, s84, 11
  s_add_u32 s86, s84, 12976128
  s_add_u32 s84, s84, 12943360
  v_lshlrev_b32_e32 v16, 7, v16
  s_mov_b32 s85, 0
  v_readlane_b32 s40, v27, 0
  v_readlane_b32 s41, v27, 1
  v_readlane_b32 s42, v27, 2
  v_readlane_b32 s43, v27, 3
  v_readlane_b32 s44, v27, 4
  v_readlane_b32 s45, v27, 5
  v_readlane_b32 s46, v27, 6
  v_readlane_b32 s47, v27, 7
  v_readlane_b32 s48, v27, 8
  v_readlane_b32 s49, v27, 9
  v_readlane_b32 s50, v27, 10
  v_readlane_b32 s51, v27, 11
  s_cmp_eq_u32 s28, 0
  s_cselect_b32 s84, s84, 0x10000000
  buffer_load_dword v17, v16, s[24:27], s84 offen sc0 sc1
  v_readlane_b32 s96, v21, 5
  s_add_u32 m0, s97, 5120
  s_nop 3
  buffer_load_dwordx4 v20, s[24:27], s96 offen offset:3072 sc0 sc1 lds
  s_add_u32 m0, s97, 9216
  s_nop 0
  buffer_load_dwordx4 v94, s[24:27], s96 offen offset:0 sc0 sc1 lds
  v_readlane_b32 s96, v21, 6
  s_add_u32 m0, s97, 40960
  s_nop 3
  buffer_load_dwordx4 v20, s[24:27], s96 offen offset:0 sc0 sc1 lds
  buffer_load_dwordx4 v20, s[24:27], s96 offen offset:1024 sc0 sc1 lds
  buffer_load_dwordx4 v20, s[24:27], s96 offen offset:2048 sc0 sc1 lds
  buffer_load_dwordx4 v20, s[24:27], s96 offen offset:3072 sc0 sc1 lds
  s_add_u32 m0, s97, 45056
  s_nop 0
  buffer_load_dwordx4 v94, s[24:27], s96 offen offset:0 sc0 sc1 lds
  v_readlane_b32 s96, v21, 7
  s_add_u32 m0, s97, 46080
  s_nop 3
  buffer_load_dwordx4 v20, s[24:27], s96 offen offset:0 sc0 sc1 lds
  buffer_load_dwordx4 v20, s[24:27], s96 offen offset:1024 sc0 sc1 lds
  buffer_load_dwordx4 v20, s[24:27], s96 offen offset:2048 sc0 sc1 lds
  buffer_load_dwordx4 v20, s[24:27], s96 offen offset:3072 sc0 sc1 lds
  s_add_u32 m0, s97, 50176
  s_nop 0
  buffer_load_dwordx4 v94, s[24:27], s96 offen offset:0 sc0 sc1 lds
  s_waitcnt vmcnt(12)
  v_cmp_ne_u32 vcc, s77, v17
  s_cbranch_vccnz L_poll
L_polld:
  s_barrier
  buffer_load_dwordx4 v[28:31], v20, s[24:27], s40 offen offset:0 sc0 sc1
  buffer_load_dwordx4 v[32:35], v20, s[24:27], s40 offen offset:1024 sc0 sc1
  buffer_load_dwordx4 v[36:39], v20, s[24:27], s40 offen offset:2048 sc0 sc1
  buffer_load_dwordx4 v[40:43], v20, s[24:27], s40 offen offset:3072 sc0 sc1
  buffer_load_dwordx4 v[44:47], v20, s[24:27], s41 offen offset:0 sc0 sc1
  buffer_load_dwordx4 v[48:51], v20, s[24:27], s41 offen offset:1024 sc0 sc1
  buffer_load_dwordx4 v[52:55], v20, s[24:27], s41 offen offset:2048 sc0 sc1
  buffer_load_dwordx4 v[56:59], v20, s[24:27], s41 offen offset:3072 sc0 sc1
  buffer_load_dwordx4 v[60:63], v20, s[24:27], s42 offen offset:0 sc0 sc1
  buffer_load_dwordx4 v[64:67], v20, s[24:27], s42 offen offset:1024 sc0 sc1
  buffer_load_dwordx4 v[68:71], v20, s[24:27], s42 offen offset:2048 sc0 sc1
  buffer_load_dwordx4 v[72:75], v20, s[24:27], s42 offen offset:3072 sc0 sc1
  s_waitcnt vmcnt(11)
  ds_read_b128 a[176:179], v14 offset:0
  ds_read_b128 a[180:183], v14 offset:1024
  s_waitcnt vmcnt(8) lgkmcnt(1)
.p2align 3
  v_mfma_f32_16x16x32_bf16 a[96:99], a[176:179], v[28:31], 0
  ds_read_b128 a[184:187], v14 offset:2048
  v_mfma_f32_16x16x32_bf16 a[100:103], a[176:179], v[32:35], 0
  buffer_load_dwordx4 v[76:79], v20, s[24:27], s43 offen offset:0 sc0 sc1
  v_mfma_f32_16x16x32_bf16 a[104:107], a[176:179], v[36:39], 0
  v_mfma_f32_16x16x32_bf16 a[108:111], a[176:179], v[40:43], 0
  s_waitcnt lgkmcnt(1)
  v_mfma_f32_16x16x32_bf16 a[112:115], a[180:183], v[28:31], 0
  ds_read_b128 a[176:179], v14 offset:3072
  v_bfe_u32 v2, v128, 1, 2
  v_mfma_f32_16x16x32_bf16 a[116:119], a[180:183], v[32:35], 0
  buffer_load_dwordx4 v[80:83], v20, s[24:27], s43 offen offset:1024 sc0 sc1
  v_xor_b32_e32 v2, v2, v129
  v_mfma_f32_16x16x32_bf16 a[120:123], a[180:183], v[36:39], 0
  v_lshrrev_b32_e64 v3, 5, v128
  v_mul_u32_u24 v3, 30720, v3
  v_mfma_f32_16x16x32_bf16 a[124:127], a[180:183], v[40:43], 0
  s_waitcnt lgkmcnt(1)
  v_mul_u32_u24 v128, 320, v128
  v_mfma_f32_16x16x32_bf16 a[128:131], a[184:187], v[28:31], 0
  ds_read_b128 a[180:183], v14 offset:4096
  v_lshl_add_u32 v2, v2, 4, v3
  v_mfma_f32_16x16x32_bf16 a[132:135], a[184:187], v[32:35], 0
  buffer_load_dwordx4 v[84:87], v20, s[24:27], s43 offen offset:2048 sc0 sc1
  v_add_u32_e32 v128, v128, v2
  v_mfma_f32_16x16x32_bf16 a[136:139], a[184:187], v[36:39], 0
  v_add_u32 v129, 81920, v128
  v_lshlrev_b32_e64 v130, 1, v130
  v_mfma_f32_16x16x32_bf16 a[140:143], a[184:187], v[40:43], 0
  s_waitcnt lgkmcnt(1)
  v_lshlrev_b32_e32 v22, 16, v134
  v_mfma_f32_16x16x32_bf16 a[144:147], a[176:179], v[28:31], 0
  ds_read_b128 a[184:187], v14 offset:5120
  v_and_b32_e64 v23, s31, v134
  v_mfma_f32_16x16x32_bf16 a[148:151], a[176:179], v[32:35], 0
  buffer_load_dwordx4 v[88:91], v20, s[24:27], s43 offen offset:3072 sc0 sc1
  v_lshlrev_b32_e64 v24, 16, v135
  v_mfma_f32_16x16x32_bf16 a[152:155], a[176:179], v[36:39], 0
  v_and_b32_e32 v25, s31, v135
  v_lshlrev_b32_e32 v6, 16, v150
  v_mfma_f32_16x16x32_bf16 a[156:159], a[176:179], v[40:43], 0
  s_waitcnt lgkmcnt(1)
  v_and_b32_e32 v7, s31, v150
  v_mfma_f32_16x16x32_bf16 a[160:163], a[180:183], v[28:31], 0
  ds_read_b128 a[176:179], v14 offset:6144
  v_readlane_b32 s40, v27, 12
  v_mfma_f32_16x16x32_bf16 a[164:167], a[180:183], v[32:35], 0
  v_lshlrev_b32_e32 v8, 16, v151
  v_and_b32_e32 v9, s31, v151
  v_mfma_f32_16x16x32_bf16 a[168:171], a[180:183], v[36:39], 0
  s_waitcnt vmcnt(8)
  v_sub_f32_e32 v2, v22, v132
  v_mfma_f32_16x16x32_bf16 a[172:175], a[180:183], v[40:43], 0
  s_waitcnt lgkmcnt(1)
  v_sub_f32_e32 v3, v23, v132
  v_mfma_f32_16x16x32_bf16 a[96:99], a[184:187], v[44:47], a[96:99]
  ds_read_b128 a[180:183], v14 offset:7168
  v_sub_f32_e64 v4, v24, v132
  v_mfma_f32_16x16x32_bf16 a[100:103], a[184:187], v[48:51], a[100:103]
  buffer_load_dwordx4 v[28:31], v20, s[24:27], s44 offen offset:0 sc0 sc1
  v_sub_f32_e64 v5, v25, v132
  v_mfma_f32_16x16x32_bf16 a[104:107], a[184:187], v[52:55], a[104:107]
  v_cvt_pk_bf16_f32 v10, v2, v3
  v_cvt_pk_bf16_f32 v11, v4, v5
  v_mfma_f32_16x16x32_bf16 a[108:111], a[184:187], v[56:59], a[108:111]
  s_waitcnt lgkmcnt(1)
  v_lshlrev_b32_e32 v2, 16, v10
  v_mfma_f32_16x16x32_bf16 a[112:115], a[176:179], v[44:47], a[112:115]
  ds_read_b128 a[184:187], v14 offset:8192
  v_and_b32_e64 v3, s31, v10
  v_mfma_f32_16x16x32_bf16 a[116:119], a[176:179], v[48:51], a[116:119]
  buffer_load_dwordx4 v[32:35], v20, s[24:27], s44 offen offset:1024 sc0 sc1
  v_lshlrev_b32_e64 v4, 16, v11
  v_mfma_f32_16x16x32_bf16 a[120:123], a[176:179], v[52:55], a[120:123]
  v_and_b32_e32 v5, s31, v11
  v_mul_f32_e32 v2, v2, v133
  v_mfma_f32_16x16x32_bf16 a[124:127], a[176:179], v[56:59], a[124:127]
  s_waitcnt lgkmcnt(1)
  v_mul_f32_e32 v3, v3, v133
  v_mfma_f32_16x16x32_bf16 a[128:131], a[180:183], v[44:47], a[128:131]
  ds_read_b128 a[176:179], v14 offset:9216
  v_mul_f32_e64 v4, v4, v133
  v_mfma_f32_16x16x32_bf16 a[132:135], a[180:183], v[48:51], a[132:135]
  buffer_load_dwordx4 v[36:39], v20, s[24:27], s44 offen offset:2048 sc0 sc1
  v_mul_f32_e64 v5, v5, v133
  v_mfma_f32_16x16x32_bf16 a[136:139], a[180:183], v[52:55], a[136:139]
  v_cvt_pk_bf16_f32 v10, v2, v3
  v_cvt_pk_bf16_f32 v11, v4, v5
  v_mfma_f32_16x16x32_bf16 a[140:143], a[180:183], v[56:59], a[140:143]
  s_waitcnt lgkmcnt(1)
  v_lshlrev_b32_e32 v2, 16, v10
  v_mfma_f32_16x16x32_bf16 a[144:147], a[184:187], v[44:47], a[144:147]
  ds_read_b128 a[180:183], v14 offset:40960
  v_and_b32_e64 v3, s31, v10
  v_mfma_f32_16x16x32_bf16 a[148:151], a[184:187], v[48:51], a[148:151]
  buffer_load_dwordx4 v[40:43], v20, s[24:27], s44 offen offset:3072 sc0 sc1
  v_lshlrev_b32_e64 v4, 16, v11
  v_mfma_f32_16x16x32_bf16 a[152:155], a[184:187], v[52:55], a[152:155]
  v_and_b32_e32 v5, s31, v11
  v_mul_f32_e32 v2, v2, v6
  v_mfma_f32_16x16x32_bf16 a[156:159], a[184:187], v[56:59], a[156:159]
  s_waitcnt lgkmcnt(1)
  v_mul_f32_e32 v3, v3, v7
  v_mfma_f32_16x16x32_bf16 a[160:163], a[176:179], v[44:47], a[160:163]
  ds_read_b128 a[184:187], v14 offset:41984
  v_readlane_b32 s41, v27, 13
  v_mfma_f32_16x16x32_bf16 a[164:167], a[176:179], v[48:51], a[164:167]
  v_mul_f32_e32 v4, v4, v8
  v_mul_f32_e32 v5, v5, v9
  v_mfma_f32_16x16x32_bf16 a[168:171], a[176:179], v[52:55], a[168:171]
  s_waitcnt vmcnt(8)
  v_cvt_pk_bf16_f32 v10, v2, v3
  v_mfma_f32_16x16x32_bf16 a[172:175], a[176:179], v[56:59], a[172:175]
  s_waitcnt lgkmcnt(1)
  v_cvt_pk_bf16_f32 v11, v4, v5
  v_mfma_f32_16x16x32_bf16 a[96:99], a[180:183], v[60:63], a[96:99]
  ds_read_b128 a[176:179], v14 offset:43008
  v_lshlrev_b32_e64 v148, 16, v10
  v_mfma_f32_16x16x32_bf16 a[100:103], a[180:183], v[64:67], a[100:103]
  buffer_load_dwordx4 v[44:47], v20, s[24:27], s45 offen offset:0 sc0 sc1
  v_and_b32_e64 v149, s31, v10
  v_mfma_f32_16x16x32_bf16 a[104:107], a[180:183], v[68:71], a[104:107]
  v_lshlrev_b32_e32 v150, 16, v11
  v_and_b32_e32 v151, s31, v11
  v_mfma_f32_16x16x32_bf16 a[108:111], a[180:183], v[72:75], a[108:111]
  s_waitcnt lgkmcnt(1)
  v_lshlrev_b32_e32 v22, 16, v136
  v_mfma_f32_16x16x32_bf16 a[112:115], a[184:187], v[60:63], a[112:115]
  ds_read_b128 a[180:183], v14 offset:44032
  v_and_b32_e64 v23, s31, v136
  v_mfma_f32_16x16x32_bf16 a[116:119], a[184:187], v[64:67], a[116:119]
  buffer_load_dwordx4 v[48:51], v20, s[24:27], s45 offen offset:1024 sc0 sc1
  v_lshlrev_b32_e64 v24, 16, v137
  v_mfma_f32_16x16x32_bf16 a[120:123], a[184:187], v[68:71], a[120:123]
  v_and_b32_e32 v25, s31, v137
  v_lshlrev_b32_e32 v6, 16, v154
  v_mfma_f32_16x16x32_bf16 a[124:127], a[184:187], v[72:75], a[124:127]
  s_waitcnt lgkmcnt(1)
  v_and_b32_e32 v7, s31, v154
  v_mfma_f32_16x16x32_bf16 a[128:131], a[176:179], v[60:63], a[128:131]
  ds_read_b128 a[184:187], v14 offset:45056
  v_lshlrev_b32_e64 v8, 16, v155
  v_mfma_f32_16x16x32_bf16 a[132:135], a[176:179], v[64:67], a[132:135]
  buffer_load_dwordx4 v[52:55], v20, s[24:27], s45 offen offset:2048 sc0 sc1
  v_and_b32_e64 v9, s31, v155
  v_mfma_f32_16x16x32_bf16 a[136:139], a[176:179], v[68:71], a[136:139]
  v_sub_f32_e32 v2, v22, v132
  v_sub_f32_e32 v3, v23, v132
  v_mfma_f32_16x16x32_bf16 a[140:143], a[176:179], v[72:75], a[140:143]
  s_waitcnt lgkmcnt(1)
  v_sub_f32_e32 v4, v24, v132
  v_mfma_f32_16x16x32_bf16 a[144:147], a[180:183], v[60:63], a[144:147]
  ds_read_b128 a[176:179], v14 offset:46080
  v_sub_f32_e64 v5, v25, v132
  v_mfma_f32_16x16x32_bf16 a[148:151], a[180:183], v[64:67], a[148:151]
  buffer_load_dwordx4 v[56:59], v20, s[24:27], s45 offen offset:3072 sc0 sc1
  v_cvt_pk_bf16_f32 v10, v2, v3
  v_mfma_f32_16x16x32_bf16 a[152:155], a[180:183], v[68:71], a[152:155]
  buffer_load_dword v17, v16, s[24:27], s86 offen sc0 sc1
  v_cvt_pk_bf16_f32 v11, v4, v5
  v_mfma_f32_16x16x32_bf16 a[156:159], a[180:183], v[72:75], a[156:159]
  s_waitcnt lgkmcnt(1)
  v_lshlrev_b32_e32 v2, 16, v10
  v_mfma_f32_16x16x32_bf16 a[160:163], a[184:187], v[60:63], a[160:163]
  ds_read_b128 a[180:183], v14 offset:47104
  v_readlane_b32 s42, v27, 14
  v_mfma_f32_16x16x32_bf16 a[164:167], a[184:187], v[64:67], a[164:167]
  v_and_b32_e32 v3, s31, v10
  v_lshlrev_b32_e32 v4, 16, v11
  v_mfma_f32_16x16x32_bf16 a[168:171], a[184:187], v[68:71], a[168:171]
  s_waitcnt vmcnt(9)
  v_and_b32_e32 v5, s31, v11
  v_mfma_f32_16x16x32_bf16 a[172:175], a[184:187], v[72:75], a[172:175]
  s_waitcnt lgkmcnt(1)
  v_mul_f32_e32 v2, v2, v133
  v_mfma_f32_16x16x32_bf16 a[96:99], a[176:179], v[76:79], a[96:99]
  ds_read_b128 a[184:187], v14 offset:48128
  v_mul_f32_e64 v3, v3, v133
  v_mfma_f32_16x16x32_bf16 a[100:103], a[176:179], v[80:83], a[100:103]
  buffer_load_dwordx4 v[60:63], v20, s[24:27], s46 offen offset:0 sc0 sc1
  v_mul_f32_e64 v4, v4, v133
  v_mfma_f32_16x16x32_bf16 a[104:107], a[176:179], v[84:87], a[104:107]
  v_mul_f32_e64 v5, v5, v133
  v_cvt_pk_bf16_f32 v10, v2, v3
  v_mfma_f32_16x16x32_bf16 a[108:111], a[176:179], v[88:91], a[108:111]
  s_waitcnt lgkmcnt(1)
  v_cvt_pk_bf16_f32 v11, v4, v5
  v_mfma_f32_16x16x32_bf16 a[112:115], a[180:183], v[76:79], a[112:115]
  ds_read_b128 a[176:179], v14 offset:49152
  v_lshlrev_b32_e32 v2, 16, v10
  v_mfma_f32_16x16x32_bf16 a[116:119], a[180:183], v[80:83], a[116:119]
  buffer_load_dwordx4 v[64:67], v20, s[24:27], s46 offen offset:1024 sc0 sc1
  v_and_b32_e64 v3, s31, v10
  v_mfma_f32_16x16x32_bf16 a[120:123], a[180:183], v[84:87], a[120:123]
  v_lshlrev_b32_e32 v4, 16, v11
  v_and_b32_e32 v5, s31, v11
  v_mfma_f32_16x16x32_bf16 a[124:127], a[180:183], v[88:91], a[124:127]
  s_waitcnt lgkmcnt(1)
  v_mul_f32_e32 v2, v2, v6
  v_mfma_f32_16x16x32_bf16 a[128:131], a[184:187], v[76:79], a[128:131]
  ds_read_b128 a[180:183], v14 offset:50176
  v_mul_f32_e64 v3, v3, v7
  v_mfma_f32_16x16x32_bf16 a[132:135], a[184:187], v[80:83], a[132:135]
  buffer_load_dwordx4 v[68:71], v20, s[24:27], s46 offen offset:2048 sc0 sc1
  v_mul_f32_e64 v4, v4, v8
  v_mfma_f32_16x16x32_bf16 a[136:139], a[184:187], v[84:87], a[136:139]
  v_mul_f32_e64 v5, v5, v9
  v_cvt_pk_bf16_f32 v10, v2, v3
  v_mfma_f32_16x16x32_bf16 a[140:143], a[184:187], v[88:91], a[140:143]
  s_waitcnt lgkmcnt(1)
  v_cvt_pk_bf16_f32 v11, v4, v5
  v_mfma_f32_16x16x32_bf16 a[144:147], a[176:179], v[76:79], a[144:147]
  ds_read_b128 a[184:187], v13 offset:0
  v_lshlrev_b32_e32 v152, 16, v10
  v_mfma_f32_16x16x32_bf16 a[148:151], a[176:179], v[80:83], a[148:151]
  buffer_load_dwordx4 v[72:75], v20, s[24:27], s46 offen offset:3072 sc0 sc1
  v_and_b32_e64 v153, s31, v10
  v_mfma_f32_16x16x32_bf16 a[152:155], a[176:179], v[84:87], a[152:155]
  v_lshlrev_b32_e32 v154, 16, v11
  v_and_b32_e32 v155, s31, v11
  v_mfma_f32_16x16x32_bf16 a[156:159], a[176:179], v[88:91], a[156:159]
  s_waitcnt lgkmcnt(1)
  v_lshlrev_b32_e32 v22, 16, v138
  v_mfma_f32_16x16x32_bf16 a[160:163], a[180:183], v[76:79], a[160:163]
  ds_read_b128 a[176:179], v13 offset:1024
  v_readlane_b32 s43, v27, 15
  v_mfma_f32_16x16x32_bf16 a[164:167], a[180:183], v[80:83], a[164:167]
  v_and_b32_e32 v23, s31, v138
  v_lshlrev_b32_e32 v24, 16, v139
  v_mfma_f32_16x16x32_bf16 a[168:171], a[180:183], v[84:87], a[168:171]
  s_waitcnt vmcnt(9)
  v_and_b32_e32 v25, s31, v139
  v_mfma_f32_16x16x32_bf16 a[172:175], a[180:183], v[88:91], a[172:175]
  s_waitcnt lgkmcnt(1)
  v_lshlrev_b32_e32 v6, 16, v158
  v_mfma_f32_16x16x32_bf16 a[96:99], a[184:187], v[28:31], a[96:99]
  ds_read_b128 a[180:183], v13 offset:2048
  v_and_b32_e64 v7, s31, v158
  v_mfma_f32_16x16x32_bf16 a[100:103], a[184:187], v[32:35], a[100:103]
  buffer_load_dwordx4 v[76:79], v20, s[24:27], s47 offen offset:0 sc0 sc1
  v_lshlrev_b32_e64 v8, 16, v159
  v_mfma_f32_16x16x32_bf16 a[104:107], a[184:187], v[36:39], a[104:107]
  v_and_b32_e32 v9, s31, v159
  v_sub_f32_e32 v2, v22, v132
  v_mfma_f32_16x16x32_bf16 a[108:111], a[184:187], v[40:43], a[108:111]
  s_waitcnt lgkmcnt(1)
  v_sub_f32_e32 v3, v23, v132
  v_mfma_f32_16x16x32_bf16 a[112:115], a[176:179], v[28:31], a[112:115]
  ds_read_b128 a[184:187], v13 offset:3072
  v_sub_f32_e64 v4, v24, v132
  v_mfma_f32_16x16x32_bf16 a[116:119], a[176:179], v[32:35], a[116:119]
  buffer_load_dwordx4 v[80:83], v20, s[24:27], s47 offen offset:1024 sc0 sc1
  v_sub_f32_e64 v5, v25, v132
  v_mfma_f32_16x16x32_bf16 a[120:123], a[176:179], v[36:39], a[120:123]
  v_cvt_pk_bf16_f32 v10, v2, v3
  v_cvt_pk_bf16_f32 v11, v4, v5
  v_mfma_f32_16x16x32_bf16 a[124:127], a[176:179], v[40:43], a[124:127]
  s_waitcnt lgkmcnt(1)
  v_lshlrev_b32_e32 v2, 16, v10
  v_mfma_f32_16x16x32_bf16 a[128:131], a[180:183], v[28:31], a[128:131]
  ds_read_b128 a[176:179], v13 offset:4096
  v_and_b32_e64 v3, s31, v10
  v_mfma_f32_16x16x32_bf16 a[132:135], a[180:183], v[32:35], a[132:135]
  buffer_load_dwordx4 v[84:87], v20, s[24:27], s47 offen offset:2048 sc0 sc1
  v_lshlrev_b32_e64 v4, 16, v11
  v_mfma_f32_16x16x32_bf16 a[136:139], a[180:183], v[36:39], a[136:139]
  v_and_b32_e32 v5, s31, v11
  v_mul_f32_e32 v2, v2, v133
  v_mfma_f32_16x16x32_bf16 a[140:143], a[180:183], v[40:43], a[140:143]
  s_waitcnt lgkmcnt(1)
  v_mul_f32_e32 v3, v3, v133
  v_mfma_f32_16x16x32_bf16 a[144:147], a[184:187], v[28:31], a[144:147]
  ds_read_b128 a[180:183], v13 offset:5120
  v_mul_f32_e64 v4, v4, v133
  v_mfma_f32_16x16x32_bf16 a[148:151], a[184:187], v[32:35], a[148:151]
  buffer_load_dwordx4 v[88:91], v20, s[24:27], s47 offen offset:3072 sc0 sc1
  v_mul_f32_e64 v5, v5, v133
  v_mfma_f32_16x16x32_bf16 a[152:155], a[184:187], v[36:39], a[152:155]
  v_cvt_pk_bf16_f32 v10, v2, v3
  v_cvt_pk_bf16_f32 v11, v4, v5
  v_mfma_f32_16x16x32_bf16 a[156:159], a[184:187], v[40:43], a[156:159]
  s_waitcnt lgkmcnt(1)
  v_lshlrev_b32_e32 v2, 16, v10
  v_mfma_f32_16x16x32_bf16 a[160:163], a[176:179], v[28:31], a[160:163]
  ds_read_b128 a[184:187], v13 offset:6144
  v_readlane_b32 s44, v27, 16
  v_mfma_f32_16x16x32_bf16 a[164:167], a[176:179], v[32:35], a[164:167]
  s_waitcnt vmcnt(8)
  v_cmp_ne_u32 vcc, s32, v17
  v_mfma_f32_16x16x32_bf16 a[168:171], a[176:179], v[36:39], a[168:171]
  v_and_b32_e64 v3, s31, v10
  v_mfma_f32_16x16x32_bf16 a[172:175], a[176:179], v[40:43], a[172:175]
  s_waitcnt lgkmcnt(1)
  s_cbranch_vccnz L_pl
L_plr:
  v_mfma_f32_16x16x32_bf16 a[96:99], a[180:183], v[44:47], a[96:99]
  ds_read_b128 a[176:179], v13 offset:7168
  v_lshlrev_b32_e64 v4, 16, v11
  v_mfma_f32_16x16x32_bf16 a[100:103], a[180:183], v[48:51], a[100:103]
  buffer_load_dwordx4 v[28:31], v20, s[24:27], s48 offen offset:0 sc0 sc1
  v_and_b32_e64 v5, s31, v11
  v_mfma_f32_16x16x32_bf16 a[104:107], a[180:183], v[52:55], a[104:107]
  v_mul_f32_e32 v2, v2, v6
  v_mul_f32_e32 v3, v3, v7
  v_mfma_f32_16x16x32_bf16 a[108:111], a[180:183], v[56:59], a[108:111]
  s_waitcnt lgkmcnt(1)
  v_mul_f32_e32 v4, v4, v8
  v_mfma_f32_16x16x32_bf16 a[112:115], a[184:187], v[44:47], a[112:115]
  ds_read_b128 a[180:183], v13 offset:8192
  v_mul_f32_e64 v5, v5, v9
  v_mfma_f32_16x16x32_bf16 a[116:119], a[184:187], v[48:51], a[116:119]
  buffer_load_dwordx4 v[32:35], v20, s[24:27], s48 offen offset:1024 sc0 sc1
  v_cvt_pk_bf16_f32 v10, v2, v3
  v_mfma_f32_16x16x32_bf16 a[120:123], a[184:187], v[52:55], a[120:123]
  v_cvt_pk_bf16_f32 v11, v4, v5
  v_lshlrev_b32_e64 v156, 16, v10
  v_mfma_f32_16x16x32_bf16 a[124:127], a[184:187], v[56:59], a[124:127]
  s_waitcnt lgkmcnt(1)
  v_and_b32_e32 v157, s31, v10
  v_mfma_f32_16x16x32_bf16 a[128:131], a[176:179], v[44:47], a[128:131]
  ds_read_b128 a[184:187], v13 offset:9216
  v_lshlrev_b32_e64 v158, 16, v11
  v_mfma_f32_16x16x32_bf16 a[132:135], a[176:179], v[48:51], a[132:135]
  buffer_load_dwordx4 v[36:39], v20, s[24:27], s48 offen offset:2048 sc0 sc1
  v_and_b32_e64 v159, s31, v11
  v_mfma_f32_16x16x32_bf16 a[136:139], a[176:179], v[52:55], a[136:139]
  v_lshlrev_b32_e32 v22, 16, v140
  v_and_b32_e32 v23, s31, v140
  v_mfma_f32_16x16x32_bf16 a[140:143], a[176:179], v[56:59], a[140:143]
  s_waitcnt lgkmcnt(1)
  v_lshlrev_b32_e32 v24, 16, v141
  v_mfma_f32_16x16x32_bf16 a[144:147], a[180:183], v[44:47], a[144:147]
  ds_read_b128 a[176:179], v13 offset:40960
  v_and_b32_e64 v25, s31, v141
  v_mfma_f32_16x16x32_bf16 a[148:151], a[180:183], v[48:51], a[148:151]
  buffer_load_dwordx4 v[40:43], v20, s[24:27], s48 offen offset:3072 sc0 sc1
  v_lshlrev_b32_e64 v6, 16, v162
  v_mfma_f32_16x16x32_bf16 a[152:155], a[180:183], v[52:55], a[152:155]
  v_and_b32_e32 v7, s31, v162
  v_lshlrev_b32_e32 v8, 16, v163
  v_mfma_f32_16x16x32_bf16 a[156:159], a[180:183], v[56:59], a[156:159]
  s_waitcnt lgkmcnt(1)
  v_and_b32_e32 v9, s31, v163
  v_mfma_f32_16x16x32_bf16 a[160:163], a[184:187], v[44:47], a[160:163]
  ds_read_b128 a[180:183], v13 offset:41984
  v_readlane_b32 s45, v27, 17
  v_mfma_f32_16x16x32_bf16 a[164:167], a[184:187], v[48:51], a[164:167]
  v_sub_f32_e32 v2, v22, v132
  v_sub_f32_e32 v3, v23, v132
  v_mfma_f32_16x16x32_bf16 a[168:171], a[184:187], v[52:55], a[168:171]
  s_waitcnt vmcnt(8)
  v_sub_f32_e32 v4, v24, v132
  v_mfma_f32_16x16x32_bf16 a[172:175], a[184:187], v[56:59], a[172:175]
  s_waitcnt lgkmcnt(1)
  v_sub_f32_e32 v5, v25, v132
  v_mfma_f32_16x16x32_bf16 a[96:99], a[176:179], v[60:63], a[96:99]
  ds_read_b128 a[184:187], v13 offset:43008
  v_cvt_pk_bf16_f32 v10, v2, v3
  v_mfma_f32_16x16x32_bf16 a[100:103], a[176:179], v[64:67], a[100:103]
  buffer_load_dwordx4 v[44:47], v20, s[24:27], s49 offen offset:0 sc0 sc1
  v_cvt_pk_bf16_f32 v11, v4, v5
  v_mfma_f32_16x16x32_bf16 a[104:107], a[176:179], v[68:71], a[104:107]
  v_lshlrev_b32_e32 v2, 16, v10
  v_and_b32_e32 v3, s31, v10
  v_mfma_f32_16x16x32_bf16 a[108:111], a[176:179], v[72:75], a[108:111]
  s_waitcnt lgkmcnt(1)
  v_lshlrev_b32_e32 v4, 16, v11
  v_mfma_f32_16x16x32_bf16 a[112:115], a[180:183], v[60:63], a[112:115]
  ds_read_b128 a[176:179], v13 offset:44032
  v_and_b32_e64 v5, s31, v11
  v_mfma_f32_16x16x32_bf16 a[116:119], a[180:183], v[64:67], a[116:119]
  buffer_load_dwordx4 v[48:51], v20, s[24:27], s49 offen offset:1024 sc0 sc1
  v_mul_f32_e64 v2, v2, v133
  v_mfma_f32_16x16x32_bf16 a[120:123], a[180:183], v[68:71], a[120:123]
  v_mul_f32_e32 v3, v3, v133
  v_mul_f32_e32 v4, v4, v133
  v_mfma_f32_16x16x32_bf16 a[124:127], a[180:183], v[72:75], a[124:127]
  s_waitcnt lgkmcnt(1)
  v_mul_f32_e32 v5, v5, v133
  v_mfma_f32_16x16x32_bf16 a[128:131], a[184:187], v[60:63], a[128:131]
  ds_read_b128 a[180:183], v13 offset:45056
  v_cvt_pk_bf16_f32 v10, v2, v3
  v_mfma_f32_16x16x32_bf16 a[132:135], a[184:187], v[64:67], a[132:135]
  buffer_load_dwordx4 v[52:55], v20, s[24:27], s49 offen offset:2048 sc0 sc1
  v_cvt_pk_bf16_f32 v11, v4, v5
  v_mfma_f32_16x16x32_bf16 a[136:139], a[184:187], v[68:71], a[136:139]
  v_lshlrev_b32_e32 v2, 16, v10
  v_and_b32_e32 v3, s31, v10
  v_mfma_f32_16x16x32_bf16 a[140:143], a[184:187], v[72:75], a[140:143]
  s_waitcnt lgkmcnt(1)
  v_lshlrev_b32_e32 v4, 16, v11
  v_mfma_f32_16x16x32_bf16 a[144:147], a[176:179], v[60:63], a[144:147]
  ds_read_b128 a[184:187], v13 offset:46080
  v_and_b32_e64 v5, s31, v11
  v_mfma_f32_16x16x32_bf16 a[148:151], a[176:179], v[64:67], a[148:151]
  buffer_load_dwordx4 v[56:59], v20, s[24:27], s49 offen offset:3072 sc0 sc1
  v_mul_f32_e64 v2, v2, v6
  v_mfma_f32_16x16x32_bf16 a[152:155], a[176:179], v[68:71], a[152:155]
  v_mul_f32_e32 v3, v3, v7
  v_mul_f32_e32 v4, v4, v8
  v_mfma_f32_16x16x32_bf16 a[156:159], a[176:179], v[72:75], a[156:159]
  s_waitcnt lgkmcnt(1)
  v_mul_f32_e32 v5, v5, v9
  v_mfma_f32_16x16x32_bf16 a[160:163], a[180:183], v[60:63], a[160:163]
  ds_read_b128 a[176:179], v13 offset:47104
  v_readlane_b32 s46, v27, 18
  v_mfma_f32_16x16x32_bf16 a[164:167], a[180:183], v[64:67], a[164:167]
  v_cvt_pk_bf16_f32 v10, v2, v3
  v_cvt_pk_bf16_f32 v11, v4, v5
  v_mfma_f32_16x16x32_bf16 a[168:171], a[180:183], v[68:71], a[168:171]
  s_waitcnt vmcnt(8)
  v_lshlrev_b32_e32 v160, 16, v10
  v_mfma_f32_16x16x32_bf16 a[172:175], a[180:183], v[72:75], a[172:175]
  s_waitcnt lgkmcnt(1)
  v_and_b32_e32 v161, s31, v10
  v_mfma_f32_16x16x32_bf16 a[96:99], a[184:187], v[76:79], a[96:99]
  ds_read_b128 a[180:183], v13 offset:48128
  v_lshlrev_b32_e64 v162, 16, v11
  v_mfma_f32_16x16x32_bf16 a[100:103], a[184:187], v[80:83], a[100:103]
  buffer_load_dwordx4 v[60:63], v20, s[24:27], s50 offen offset:0 sc0 sc1
  v_and_b32_e64 v163, s31, v11
  v_mfma_f32_16x16x32_bf16 a[104:107], a[184:187], v[84:87], a[104:107]
  v_lshlrev_b32_e32 v22, 16, v142
  v_and_b32_e32 v23, s31, v142
  v_mfma_f32_16x16x32_bf16 a[108:111], a[184:187], v[88:91], a[108:111]
  s_waitcnt lgkmcnt(1)
  v_lshlrev_b32_e32 v24, 16, v143
  v_mfma_f32_16x16x32_bf16 a[112:115], a[176:179], v[76:79], a[112:115]
  ds_read_b128 a[184:187], v13 offset:49152
  v_and_b32_e64 v25, s31, v143
  v_mfma_f32_16x16x32_bf16 a[116:119], a[176:179], v[80:83], a[116:119]
  buffer_load_dwordx4 v[64:67], v20, s[24:27], s50 offen offset:1024 sc0 sc1
  v_lshlrev_b32_e64 v6, 16, v166
  v_mfma_f32_16x16x32_bf16 a[120:123], a[176:179], v[84:87], a[120:123]
  v_and_b32_e32 v7, s31, v166
  v_lshlrev_b32_e32 v8, 16, v167
  v_mfma_f32_16x16x32_bf16 a[124:127], a[176:179], v[88:91], a[124:127]
  s_waitcnt lgkmcnt(1)
  v_and_b32_e32 v9, s31, v167
  v_mfma_f32_16x16x32_bf16 a[128:131], a[180:183], v[76:79], a[128:131]
  ds_read_b128 a[176:179], v13 offset:50176
  v_sub_f32_e64 v2, v22, v132
  v_mfma_f32_16x16x32_bf16 a[132:135], a[180:183], v[80:83], a[132:135]
  buffer_load_dwordx4 v[68:71], v20, s[24:27], s50 offen offset:2048 sc0 sc1
  v_sub_f32_e64 v3, v23, v132
  v_mfma_f32_16x16x32_bf16 a[136:139], a[180:183], v[84:87], a[136:139]
  v_sub_f32_e32 v4, v24, v132
  v_sub_f32_e32 v5, v25, v132
  v_mfma_f32_16x16x32_bf16 a[140:143], a[180:183], v[88:91], a[140:143]
  s_waitcnt lgkmcnt(1)
  v_cvt_pk_bf16_f32 v10, v2, v3
  v_mfma_f32_16x16x32_bf16 a[144:147], a[184:187], v[76:79], a[144:147]
  v_cvt_pk_bf16_f32 v11, v4, v5
  v_lshlrev_b32_e32 v2, 16, v10
  v_mfma_f32_16x16x32_bf16 a[148:151], a[184:187], v[80:83], a[148:151]
  buffer_load_dwordx4 v[72:75], v20, s[24:27], s50 offen offset:3072 sc0 sc1
  v_and_b32_e64 v3, s31, v10
  v_mfma_f32_16x16x32_bf16 a[152:155], a[184:187], v[84:87], a[152:155]
  v_lshlrev_b32_e32 v4, 16, v11
  v_and_b32_e32 v5, s31, v11
  v_mfma_f32_16x16x32_bf16 a[156:159], a[184:187], v[88:91], a[156:159]
  s_waitcnt lgkmcnt(0)
  v_mul_f32_e32 v2, v2, v133
  v_mfma_f32_16x16x32_bf16 a[160:163], a[176:179], v[76:79], a[160:163]
  v_readlane_b32 s47, v27, 19
  v_mul_f32_e64 v3, v3, v133
  v_mfma_f32_16x16x32_bf16 a[164:167], a[176:179], v[80:83], a[164:167]
  v_mul_f32_e32 v4, v4, v133
  v_mul_f32_e32 v5, v5, v133
  v_mfma_f32_16x16x32_bf16 a[168:171], a[176:179], v[84:87], a[168:171]
  s_waitcnt vmcnt(8)
  v_cvt_pk_bf16_f32 v10, v2, v3
  v_mfma_f32_16x16x32_bf16 a[172:175], a[176:179], v[88:91], a[172:175]
  v_cvt_pk_bf16_f32 v11, v4, v5
  v_lshlrev_b32_e32 v2, 16, v10
  v_mfma_f32_16x16x32_bf16 a[96:99], v[168:171], v[28:31], a[96:99]
  v_and_b32_e32 v3, s31, v10
  v_lshlrev_b32_e32 v4, 16, v11
  v_mfma_f32_16x16x32_bf16 a[100:103], v[168:171], v[32:35], a[100:103]
  buffer_load_dwordx4 v[76:79], v20, s[24:27], s51 offen offset:0 sc0 sc1
  v_and_b32_e64 v5, s31, v11
  v_mfma_f32_16x16x32_bf16 a[104:107], v[168:171], v[36:39], a[104:107]
  v_mul_f32_e32 v2, v2, v6
  v_mul_f32_e32 v3, v3, v7
  v_mfma_f32_16x16x32_bf16 a[108:111], v[168:171], v[40:43], a[108:111]
  v_mul_f32_e32 v4, v4, v8
  v_mul_f32_e32 v5, v5, v9
  v_mfma_f32_16x16x32_bf16 a[112:115], v[172:175], v[28:31], a[112:115]
  v_cvt_pk_bf16_f32 v10, v2, v3
  v_cvt_pk_bf16_f32 v11, v4, v5
  v_mfma_f32_16x16x32_bf16 a[116:119], v[172:175], v[32:35], a[116:119]
  buffer_load_dwordx4 v[80:83], v20, s[24:27], s51 offen offset:1024 sc0 sc1
  v_lshlrev_b32_e64 v164, 16, v10
  v_mfma_f32_16x16x32_bf16 a[120:123], v[172:175], v[36:39], a[120:123]
  v_and_b32_e32 v165, s31, v10
  v_lshlrev_b32_e32 v166, 16, v11
  v_mfma_f32_16x16x32_bf16 a[124:127], v[172:175], v[40:43], a[124:127]
  v_and_b32_e64 v167, s31, v11
  v_mfma_f32_16x16x32_bf16 a[128:131], v[176:179], v[28:31], a[128:131]
  v_mfma_f32_16x16x32_bf16 a[132:135], v[176:179], v[32:35], a[132:135]
  buffer_load_dwordx4 v[84:87], v20, s[24:27], s51 offen offset:2048 sc0 sc1
  v_mfma_f32_16x16x32_bf16 a[136:139], v[176:179], v[36:39], a[136:139]
  v_mfma_f32_16x16x32_bf16 a[140:143], v[176:179], v[40:43], a[140:143]
  v_mfma_f32_16x16x32_bf16 a[144:147], v[180:183], v[28:31], a[144:147]
  v_mfma_f32_16x16x32_bf16 a[148:151], v[180:183], v[32:35], a[148:151]
  buffer_load_dwordx4 v[88:91], v20, s[24:27], s51 offen offset:3072 sc0 sc1
  v_mfma_f32_16x16x32_bf16 a[152:155], v[180:183], v[36:39], a[152:155]
  v_mfma_f32_16x16x32_bf16 a[156:159], v[180:183], v[40:43], a[156:159]
  v_mfma_f32_16x16x32_bf16 a[160:163], v[184:187], v[28:31], a[160:163]
  v_readlane_b32 s48, v27, 20
  v_mfma_f32_16x16x32_bf16 a[164:167], v[184:187], v[32:35], a[164:167]
  v_mfma_f32_16x16x32_bf16 a[168:171], v[184:187], v[36:39], a[168:171]
  s_waitcnt vmcnt(8)
  v_mfma_f32_16x16x32_bf16 a[172:175], v[184:187], v[40:43], a[172:175]
  v_mfma_f32_16x16x32_bf16 a[96:99], v[188:191], v[44:47], a[96:99]
  v_mfma_f32_16x16x32_bf16 a[100:103], v[188:191], v[48:51], a[100:103]
  buffer_load_dwordx4 v[28:31], v20, s[24:27], s40 offen offset:0 sc0 sc1
  v_mfma_f32_16x16x32_bf16 a[104:107], v[188:191], v[52:55], a[104:107]
  v_mfma_f32_16x16x32_bf16 a[108:111], v[188:191], v[56:59], a[108:111]
  v_mfma_f32_16x16x32_bf16 a[112:115], v[192:195], v[44:47], a[112:115]
  v_mfma_f32_16x16x32_bf16 a[116:119], v[192:195], v[48:51], a[116:119]
  buffer_load_dwordx4 v[32:35], v20, s[24:27], s40 offen offset:1024 sc0 sc1
  v_mfma_f32_16x16x32_bf16 a[120:123], v[192:195], v[52:55], a[120:123]
  v_mfma_f32_16x16x32_bf16 a[124:127], v[192:195], v[56:59], a[124:127]
  v_mfma_f32_16x16x32_bf16 a[128:131], v[196:199], v[44:47], a[128:131]
  v_mfma_f32_16x16x32_bf16 a[132:135], v[196:199], v[48:51], a[132:135]
  buffer_load_dwordx4 v[36:39], v20, s[24:27], s40 offen offset:2048 sc0 sc1
  v_mfma_f32_16x16x32_bf16 a[136:139], v[196:199], v[52:55], a[136:139]
  v_mfma_f32_16x16x32_bf16 a[140:143], v[196:199], v[56:59], a[140:143]
  v_mfma_f32_16x16x32_bf16 a[144:147], v[200:203], v[44:47], a[144:147]
  v_mfma_f32_16x16x32_bf16 a[148:151], v[200:203], v[48:51], a[148:151]
  buffer_load_dwordx4 v[40:43], v20, s[24:27], s40 offen offset:3072 sc0 sc1
  v_mfma_f32_16x16x32_bf16 a[152:155], v[200:203], v[52:55], a[152:155]
  v_mfma_f32_16x16x32_bf16 a[156:159], v[200:203], v[56:59], a[156:159]
  v_mfma_f32_16x16x32_bf16 a[160:163], v[204:207], v[44:47], a[160:163]
  v_readlane_b32 s49, v27, 21
  v_mfma_f32_16x16x32_bf16 a[164:167], v[204:207], v[48:51], a[164:167]
  v_mfma_f32_16x16x32_bf16 a[168:171], v[204:207], v[52:55], a[168:171]
  s_waitcnt vmcnt(8)
  v_mfma_f32_16x16x32_bf16 a[172:175], v[204:207], v[56:59], a[172:175]
  v_mfma_f32_16x16x32_bf16 a[96:99], v[208:211], v[60:63], a[96:99]
  v_mfma_f32_16x16x32_bf16 a[100:103], v[208:211], v[64:67], a[100:103]
  buffer_load_dwordx4 v[44:47], v20, s[24:27], s41 offen offset:0 sc0 sc1
  v_mfma_f32_16x16x32_bf16 a[104:107], v[208:211], v[68:71], a[104:107]
  v_mfma_f32_16x16x32_bf16 a[108:111], v[208:211], v[72:75], a[108:111]
  v_mfma_f32_16x16x32_bf16 a[112:115], v[212:215], v[60:63], a[112:115]
  v_mfma_f32_16x16x32_bf16 a[116:119], v[212:215], v[64:67], a[116:119]
  buffer_load_dwordx4 v[48:51], v20, s[24:27], s41 offen offset:1024 sc0 sc1
  v_mfma_f32_16x16x32_bf16 a[120:123], v[212:215], v[68:71], a[120:123]
  v_mfma_f32_16x16x32_bf16 a[124:127], v[212:215], v[72:75], a[124:127]
  v_readlane_b32 s96, v21, 22
  v_mfma_f32_16x16x32_bf16 a[128:131], v[216:219], v[60:63], a[128:131]
  v_mfma_f32_16x16x32_bf16 a[132:135], v[216:219], v[64:67], a[132:135]
  buffer_load_dwordx4 v[52:55], v20, s[24:27], s41 offen offset:2048 sc0 sc1
  v_mfma_f32_16x16x32_bf16 a[136:139], v[216:219], v[68:71], a[136:139]
  v_mfma_f32_16x16x32_bf16 a[140:143], v[216:219], v[72:75], a[140:143]
  buffer_load_dwordx4 v[168:171], v20, s[24:27], s96 offen offset:0 sc0 sc1
  v_mfma_f32_16x16x32_bf16 a[144:147], v[220:223], v[60:63], a[144:147]
  v_mfma_f32_16x16x32_bf16 a[148:151], v[220:223], v[64:67], a[148:151]
  buffer_load_dwordx4 v[56:59], v20, s[24:27], s41 offen offset:3072 sc0 sc1
  v_mfma_f32_16x16x32_bf16 a[152:155], v[220:223], v[68:71], a[152:155]
  v_mfma_f32_16x16x32_bf16 a[156:159], v[220:223], v[72:75], a[156:159]
  v_mfma_f32_16x16x32_bf16 a[160:163], v[224:227], v[60:63], a[160:163]
  v_readlane_b32 s50, v27, 22
  v_mfma_f32_16x16x32_bf16 a[164:167], v[224:227], v[64:67], a[164:167]
  v_mfma_f32_16x16x32_bf16 a[168:171], v[224:227], v[68:71], a[168:171]
  s_waitcnt vmcnt(9)
  v_mfma_f32_16x16x32_bf16 a[172:175], v[224:227], v[72:75], a[172:175]
  v_mfma_f32_16x16x32_bf16 a[96:99], v[228:231], v[76:79], a[96:99]
  v_mfma_f32_16x16x32_bf16 a[100:103], v[228:231], v[80:83], a[100:103]
  buffer_load_dwordx4 v[60:63], v20, s[24:27], s42 offen offset:0 sc0 sc1
  v_mfma_f32_16x16x32_bf16 a[104:107], v[228:231], v[84:87], a[104:107]
  v_mfma_f32_16x16x32_bf16 a[108:111], v[228:231], v[88:91], a[108:111]
  v_mfma_f32_16x16x32_bf16 a[112:115], v[232:235], v[76:79], a[112:115]
  v_mfma_f32_16x16x32_bf16 a[116:119], v[232:235], v[80:83], a[116:119]
  buffer_load_dwordx4 v[64:67], v20, s[24:27], s42 offen offset:1024 sc0 sc1
  v_mfma_f32_16x16x32_bf16 a[120:123], v[232:235], v[84:87], a[120:123]
  v_mfma_f32_16x16x32_bf16 a[124:127], v[232:235], v[88:91], a[124:127]
  v_readlane_b32 s96, v21, 22
  v_mfma_f32_16x16x32_bf16 a[128:131], v[236:239], v[76:79], a[128:131]
  v_mfma_f32_16x16x32_bf16 a[132:135], v[236:239], v[80:83], a[132:135]
  buffer_load_dwordx4 v[68:71], v20, s[24:27], s42 offen offset:2048 sc0 sc1
  v_mfma_f32_16x16x32_bf16 a[136:139], v[236:239], v[84:87], a[136:139]
  v_mfma_f32_16x16x32_bf16 a[140:143], v[236:239], v[88:91], a[140:143]
  buffer_load_dwordx4 v[172:175], v20, s[24:27], s96 offen offset:1024 sc0 sc1
  v_mfma_f32_16x16x32_bf16 a[144:147], v[240:243], v[76:79], a[144:147]
  v_mfma_f32_16x16x32_bf16 a[148:151], v[240:243], v[80:83], a[148:151]
  buffer_load_dwordx4 v[72:75], v20, s[24:27], s42 offen offset:3072 sc0 sc1
  v_mfma_f32_16x16x32_bf16 a[152:155], v[240:243], v[84:87], a[152:155]
  v_mfma_f32_16x16x32_bf16 a[156:159], v[240:243], v[88:91], a[156:159]
  v_mfma_f32_16x16x32_bf16 a[160:163], v[244:247], v[76:79], a[160:163]
  v_readlane_b32 s51, v27, 23
  v_mfma_f32_16x16x32_bf16 a[164:167], v[244:247], v[80:83], a[164:167]
  v_mfma_f32_16x16x32_bf16 a[168:171], v[244:247], v[84:87], a[168:171]
  s_waitcnt vmcnt(10)
  v_mfma_f32_16x16x32_bf16 a[172:175], v[244:247], v[88:91], a[172:175]
  v_mfma_f32_16x16x32_bf16 a[96:99], v[248:251], v[28:31], a[96:99]
  v_mfma_f32_16x16x32_bf16 a[100:103], v[248:251], v[32:35], a[100:103]
  buffer_load_dwordx4 v[76:79], v20, s[24:27], s43 offen offset:0 sc0 sc1
  v_mfma_f32_16x16x32_bf16 a[104:107], v[248:251], v[36:39], a[104:107]
  v_mfma_f32_16x16x32_bf16 a[108:111], v[248:251], v[40:43], a[108:111]
  v_mfma_f32_16x16x32_bf16 a[112:115], v[252:255], v[28:31], a[112:115]
  v_mfma_f32_16x16x32_bf16 a[116:119], v[252:255], v[32:35], a[116:119]
  buffer_load_dwordx4 v[80:83], v20, s[24:27], s43 offen offset:1024 sc0 sc1
  v_mfma_f32_16x16x32_bf16 a[120:123], v[252:255], v[36:39], a[120:123]
  v_mfma_f32_16x16x32_bf16 a[124:127], v[252:255], v[40:43], a[124:127]
  v_readlane_b32 s96, v21, 22
  v_mfma_f32_16x16x32_bf16 a[128:131], a[192:195], v[28:31], a[128:131]
  v_mfma_f32_16x16x32_bf16 a[132:135], a[192:195], v[32:35], a[132:135]
  buffer_load_dwordx4 v[84:87], v20, s[24:27], s43 offen offset:2048 sc0 sc1
  v_mfma_f32_16x16x32_bf16 a[136:139], a[192:195], v[36:39], a[136:139]
  v_mfma_f32_16x16x32_bf16 a[140:143], a[192:195], v[40:43], a[140:143]
  buffer_load_dwordx4 v[176:179], v20, s[24:27], s96 offen offset:2048 sc0 sc1
  v_mfma_f32_16x16x32_bf16 a[144:147], a[196:199], v[28:31], a[144:147]
  v_mfma_f32_16x16x32_bf16 a[148:151], a[196:199], v[32:35], a[148:151]
  buffer_load_dwordx4 v[88:91], v20, s[24:27], s43 offen offset:3072 sc0 sc1
  v_mfma_f32_16x16x32_bf16 a[152:155], a[196:199], v[36:39], a[152:155]
  v_mfma_f32_16x16x32_bf16 a[156:159], a[196:199], v[40:43], a[156:159]
  v_mfma_f32_16x16x32_bf16 a[160:163], a[200:203], v[28:31], a[160:163]
  v_mfma_f32_16x16x32_bf16 a[164:167], a[200:203], v[32:35], a[164:167]
  v_mfma_f32_16x16x32_bf16 a[168:171], a[200:203], v[36:39], a[168:171]
  s_waitcnt vmcnt(10)
  v_mfma_f32_16x16x32_bf16 a[172:175], a[200:203], v[40:43], a[172:175]
  v_mfma_f32_16x16x32_bf16 a[96:99], a[204:207], v[44:47], a[96:99]
  v_mfma_f32_16x16x32_bf16 a[100:103], a[204:207], v[48:51], a[100:103]
  buffer_load_dwordx4 v[28:31], v20, s[24:27], s44 offen offset:0 sc0 sc1
  v_mfma_f32_16x16x32_bf16 a[104:107], a[204:207], v[52:55], a[104:107]
  v_mfma_f32_16x16x32_bf16 a[108:111], a[204:207], v[56:59], a[108:111]
  v_mfma_f32_16x16x32_bf16 a[112:115], a[208:211], v[44:47], a[112:115]
  v_mfma_f32_16x16x32_bf16 a[116:119], a[208:211], v[48:51], a[116:119]
  buffer_load_dwordx4 v[32:35], v20, s[24:27], s44 offen offset:1024 sc0 sc1
  v_mfma_f32_16x16x32_bf16 a[120:123], a[208:211], v[52:55], a[120:123]
  v_mfma_f32_16x16x32_bf16 a[124:127], a[208:211], v[56:59], a[124:127]
  v_readlane_b32 s96, v21, 22
  v_mfma_f32_16x16x32_bf16 a[128:131], a[212:215], v[44:47], a[128:131]
  v_mfma_f32_16x16x32_bf16 a[132:135], a[212:215], v[48:51], a[132:135]
  buffer_load_dwordx4 v[36:39], v20, s[24:27], s44 offen offset:2048 sc0 sc1
  v_mfma_f32_16x16x32_bf16 a[136:139], a[212:215], v[52:55], a[136:139]
  v_mfma_f32_16x16x32_bf16 a[140:143], a[212:215], v[56:59], a[140:143]
  buffer_load_dwordx4 v[180:183], v20, s[24:27], s96 offen offset:3072 sc0 sc1
  v_mfma_f32_16x16x32_bf16 a[144:147], a[216:219], v[44:47], a[144:147]
  v_mfma_f32_16x16x32_bf16 a[148:151], a[216:219], v[48:51], a[148:151]
  buffer_load_dwordx4 v[40:43], v20, s[24:27], s44 offen offset:3072 sc0 sc1
  v_mfma_f32_16x16x32_bf16 a[152:155], a[216:219], v[52:55], a[152:155]
  v_mfma_f32_16x16x32_bf16 a[156:159], a[216:219], v[56:59], a[156:159]
  v_mfma_f32_16x16x32_bf16 a[160:163], a[220:223], v[44:47], a[160:163]
  v_mfma_f32_16x16x32_bf16 a[164:167], a[220:223], v[48:51], a[164:167]
  v_mfma_f32_16x16x32_bf16 a[168:171], a[220:223], v[52:55], a[168:171]
  s_waitcnt vmcnt(10)
  v_mfma_f32_16x16x32_bf16 a[172:175], a[220:223], v[56:59], a[172:175]
  v_mfma_f32_16x16x32_bf16 a[96:99], a[224:227], v[60:63], a[96:99]
  v_mfma_f32_16x16x32_bf16 a[100:103], a[224:227], v[64:67], a[100:103]
  buffer_load_dwordx4 v[44:47], v20, s[24:27], s45 offen offset:0 sc0 sc1
  v_mfma_f32_16x16x32_bf16 a[104:107], a[224:227], v[68:71], a[104:107]
  v_mfma_f32_16x16x32_bf16 a[108:111], a[224:227], v[72:75], a[108:111]
  v_mfma_f32_16x16x32_bf16 a[112:115], a[228:231], v[60:63], a[112:115]
  v_mfma_f32_16x16x32_bf16 a[116:119], a[228:231], v[64:67], a[116:119]
  buffer_load_dwordx4 v[48:51], v20, s[24:27], s45 offen offset:1024 sc0 sc1
  v_mfma_f32_16x16x32_bf16 a[120:123], a[228:231], v[68:71], a[120:123]
  v_mfma_f32_16x16x32_bf16 a[124:127], a[228:231], v[72:75], a[124:127]
  v_readlane_b32 s96, v21, 22
  v_mfma_f32_16x16x32_bf16 a[128:131], a[232:235], v[60:63], a[128:131]
  v_mfma_f32_16x16x32_bf16 a[132:135], a[232:235], v[64:67], a[132:135]
  buffer_load_dwordx4 v[52:55], v20, s[24:27], s45 offen offset:2048 sc0 sc1
  v_mfma_f32_16x16x32_bf16 a[136:139], a[232:235], v[68:71], a[136:139]
  v_mfma_f32_16x16x32_bf16 a[140:143], a[232:235], v[72:75], a[140:143]
  buffer_load_dwordx4 v[184:187], v94, s[24:27], s96 offen offset:0 sc0 sc1
  v_mfma_f32_16x16x32_bf16 a[144:147], a[236:239], v[60:63], a[144:147]
  v_mfma_f32_16x16x32_bf16 a[148:151], a[236:239], v[64:67], a[148:151]
  buffer_load_dwordx4 v[56:59], v20, s[24:27], s45 offen offset:3072 sc0 sc1
  v_mfma_f32_16x16x32_bf16 a[152:155], a[236:239], v[68:71], a[152:155]
  v_mfma_f32_16x16x32_bf16 a[156:159], a[236:239], v[72:75], a[156:159]
  v_mfma_f32_16x16x32_bf16 a[160:163], a[240:243], v[60:63], a[160:163]
  v_mfma_f32_16x16x32_bf16 a[164:167], a[240:243], v[64:67], a[164:167]
  v_mfma_f32_16x16x32_bf16 a[168:171], a[240:243], v[68:71], a[168:171]
  s_waitcnt vmcnt(10)
  v_mfma_f32_16x16x32_bf16 a[172:175], a[240:243], v[72:75], a[172:175]
  v_mfma_f32_16x16x32_bf16 a[96:99], a[244:247], v[76:79], a[96:99]
  v_lshlrev_b32_e32 v208, 16, v134
  v_and_b32_e64 v209, s31, v134
  v_mfma_f32_16x16x32_bf16 a[100:103], a[244:247], v[80:83], a[100:103]
  buffer_load_dwordx4 v[60:63], v20, s[24:27], s46 offen offset:0 sc0 sc1
  v_lshlrev_b32_e64 v210, 16, v135
  v_mfma_f32_16x16x32_bf16 a[104:107], a[244:247], v[84:87], a[104:107]
  v_and_b32_e32 v211, s31, v135
  v_lshlrev_b32_e32 v212, 16, v136
  v_mfma_f32_16x16x32_bf16 a[108:111], a[244:247], v[88:91], a[108:111]
  v_and_b32_e32 v213, s31, v136
  v_lshlrev_b32_e32 v214, 16, v137
  v_mfma_f32_16x16x32_bf16 a[112:115], a[248:251], v[76:79], a[112:115]
  v_and_b32_e32 v215, s31, v137
  v_lshlrev_b32_e32 v216, 16, v138
  v_mfma_f32_16x16x32_bf16 a[116:119], a[248:251], v[80:83], a[116:119]
  buffer_load_dwordx4 v[64:67], v20, s[24:27], s46 offen offset:1024 sc0 sc1
  v_and_b32_e64 v217, s31, v138
  v_mfma_f32_16x16x32_bf16 a[120:123], a[248:251], v[84:87], a[120:123]
  v_lshlrev_b32_e32 v218, 16, v139
  v_and_b32_e32 v219, s31, v139
  v_mfma_f32_16x16x32_bf16 a[124:127], a[248:251], v[88:91], a[124:127]
  v_lshlrev_b32_e32 v220, 16, v140
  v_and_b32_e32 v221, s31, v140
  v_readlane_b32 s96, v21, 23
  v_mfma_f32_16x16x32_bf16 a[128:131], a[252:255], v[76:79], a[128:131]
  v_lshlrev_b32_e32 v222, 16, v141
  v_and_b32_e32 v223, s31, v141
  v_mfma_f32_16x16x32_bf16 a[132:135], a[252:255], v[80:83], a[132:135]
  buffer_load_dwordx4 v[68:71], v20, s[24:27], s46 offen offset:2048 sc0 sc1
  v_lshlrev_b32_e64 v224, 16, v142
  v_mfma_f32_16x16x32_bf16 a[136:139], a[252:255], v[84:87], a[136:139]
  v_and_b32_e32 v225, s31, v142
  v_lshlrev_b32_e32 v226, 16, v143
  v_mfma_f32_16x16x32_bf16 a[140:143], a[252:255], v[88:91], a[140:143]
  buffer_load_dwordx4 v[188:191], v20, s[24:27], s96 offen offset:0 sc0 sc1
  v_and_b32_e64 v227, s31, v143
  v_mfma_f32_16x16x32_bf16 a[144:147], a[64:67], v[76:79], a[144:147]
  v_mfma_f32_16x16x32_bf16 a[148:151], a[64:67], v[80:83], a[148:151]
  buffer_load_dwordx4 v[72:75], v20, s[24:27], s46 offen offset:3072 sc0 sc1
  v_mfma_f32_16x16x32_bf16 a[152:155], a[64:67], v[84:87], a[152:155]
  v_mfma_f32_16x16x32_bf16 a[156:159], a[64:67], v[88:91], a[156:159]
  v_mfma_f32_16x16x32_bf16 a[160:163], a[68:71], v[76:79], a[160:163]
  v_mfma_f32_16x16x32_bf16 a[164:167], a[68:71], v[80:83], a[164:167]
  v_mfma_f32_16x16x32_bf16 a[168:171], a[68:71], v[84:87], a[168:171]
  s_waitcnt vmcnt(10)
  v_mfma_f32_16x16x32_bf16 a[172:175], a[68:71], v[88:91], a[172:175]
  s_cmp_eq_u32 s28, 1
  s_cbranch_scc1 L_cut
L_c16:
  v_mfma_f32_16x16x32_bf16 a[96:99], a[72:75], v[28:31], a[96:99]
  v_mfma_f32_16x16x32_bf16 a[100:103], a[72:75], v[32:35], a[100:103]
  buffer_load_dwordx4 v[76:79], v20, s[24:27], s47 offen offset:0 sc0 sc1
  v_mfma_f32_16x16x32_bf16 a[104:107], a[72:75], v[36:39], a[104:107]
  v_mfma_f32_16x16x32_bf16 a[108:111], a[72:75], v[40:43], a[108:111]
  v_mfma_f32_16x16x32_bf16 a[112:115], a[76:79], v[28:31], a[112:115]
  v_mfma_f32_16x16x32_bf16 a[116:119], a[76:79], v[32:35], a[116:119]
  buffer_load_dwordx4 v[80:83], v20, s[24:27], s47 offen offset:1024 sc0 sc1
  v_mfma_f32_16x16x32_bf16 a[120:123], a[76:79], v[36:39], a[120:123]
  v_mfma_f32_16x16x32_bf16 a[124:127], a[76:79], v[40:43], a[124:127]
  v_readlane_b32 s96, v21, 23
  v_mfma_f32_16x16x32_bf16 a[128:131], a[80:83], v[28:31], a[128:131]
  v_mfma_f32_16x16x32_bf16 a[132:135], a[80:83], v[32:35], a[132:135]
  buffer_load_dwordx4 v[84:87], v20, s[24:27], s47 offen offset:2048 sc0 sc1
  v_mfma_f32_16x16x32_bf16 a[136:139], a[80:83], v[36:39], a[136:139]
  v_mfma_f32_16x16x32_bf16 a[140:143], a[80:83], v[40:43], a[140:143]
  buffer_load_dwordx4 v[192:195], v20, s[24:27], s96 offen offset:1024 sc0 sc1
  v_mfma_f32_16x16x32_bf16 a[144:147], a[84:87], v[28:31], a[144:147]
  v_mfma_f32_16x16x32_bf16 a[148:151], a[84:87], v[32:35], a[148:151]
  buffer_load_dwordx4 v[88:91], v20, s[24:27], s47 offen offset:3072 sc0 sc1
  v_mfma_f32_16x16x32_bf16 a[152:155], a[84:87], v[36:39], a[152:155]
  v_mfma_f32_16x16x32_bf16 a[156:159], a[84:87], v[40:43], a[156:159]
  v_mfma_f32_16x16x32_bf16 a[160:163], a[88:91], v[28:31], a[160:163]
  v_mfma_f32_16x16x32_bf16 a[164:167], a[88:91], v[32:35], a[164:167]
  v_mfma_f32_16x16x32_bf16 a[168:171], a[88:91], v[36:39], a[168:171]
  s_waitcnt vmcnt(10)
  v_mfma_f32_16x16x32_bf16 a[172:175], a[88:91], v[40:43], a[172:175]
  v_mfma_f32_16x16x32_bf16 a[96:99], a[92:95], v[44:47], a[96:99]
  v_mfma_f32_16x16x32_bf16 a[100:103], a[92:95], v[48:51], a[100:103]
  buffer_load_dwordx4 v[28:31], v20, s[24:27], s48 offen offset:0 sc0 sc1
  v_mfma_f32_16x16x32_bf16 a[104:107], a[92:95], v[52:55], a[104:107]
  v_mfma_f32_16x16x32_bf16 a[108:111], a[92:95], v[56:59], a[108:111]
  v_mfma_f32_16x16x32_bf16 a[112:115], a[0:3], v[44:47], a[112:115]
  v_mfma_f32_16x16x32_bf16 a[116:119], a[0:3], v[48:51], a[116:119]
  buffer_load_dwordx4 v[32:35], v20, s[24:27], s48 offen offset:1024 sc0 sc1
  v_mfma_f32_16x16x32_bf16 a[120:123], a[0:3], v[52:55], a[120:123]
  v_mfma_f32_16x16x32_bf16 a[124:127], a[0:3], v[56:59], a[124:127]
  v_readlane_b32 s96, v21, 23
  v_mfma_f32_16x16x32_bf16 a[128:131], a[4:7], v[44:47], a[128:131]
  v_mfma_f32_16x16x32_bf16 a[132:135], a[4:7], v[48:51], a[132:135]
  buffer_load_dwordx4 v[36:39], v20, s[24:27], s48 offen offset:2048 sc0 sc1
  v_mfma_f32_16x16x32_bf16 a[136:139], a[4:7], v[52:55], a[136:139]
  v_mfma_f32_16x16x32_bf16 a[140:143], a[4:7], v[56:59], a[140:143]
  buffer_load_dwordx4 v[196:199], v20, s[24:27], s96 offen offset:2048 sc0 sc1
  v_mfma_f32_16x16x32_bf16 a[144:147], a[8:11], v[44:47], a[144:147]
  v_mfma_f32_16x16x32_bf16 a[148:151], a[8:11], v[48:51], a[148:151]
  buffer_load_dwordx4 v[40:43], v20, s[24:27], s48 offen offset:3072 sc0 sc1
  v_mfma_f32_16x16x32_bf16 a[152:155], a[8:11], v[52:55], a[152:155]
  v_mfma_f32_16x16x32_bf16 a[156:159], a[8:11], v[56:59], a[156:159]
  v_mfma_f32_16x16x32_bf16 a[160:163], a[12:15], v[44:47], a[160:163]
  v_mfma_f32_16x16x32_bf16 a[164:167], a[12:15], v[48:51], a[164:167]
  v_mfma_f32_16x16x32_bf16 a[168:171], a[12:15], v[52:55], a[168:171]
  s_waitcnt vmcnt(10)
  v_mfma_f32_16x16x32_bf16 a[172:175], a[12:15], v[56:59], a[172:175]
L_c18:
  v_mfma_f32_16x16x32_bf16 a[96:99], a[16:19], v[60:63], a[96:99]
  v_mfma_f32_16x16x32_bf16 a[100:103], a[16:19], v[64:67], a[100:103]
  buffer_load_dwordx4 v[44:47], v20, s[24:27], s49 offen offset:0 sc0 sc1
  v_mfma_f32_16x16x32_bf16 a[104:107], a[16:19], v[68:71], a[104:107]
  v_mfma_f32_16x16x32_bf16 a[108:111], a[16:19], v[72:75], a[108:111]
  v_mfma_f32_16x16x32_bf16 a[112:115], a[20:23], v[60:63], a[112:115]
  v_mfma_f32_16x16x32_bf16 a[116:119], a[20:23], v[64:67], a[116:119]
  buffer_load_dwordx4 v[48:51], v20, s[24:27], s49 offen offset:1024 sc0 sc1
  v_mfma_f32_16x16x32_bf16 a[120:123], a[20:23], v[68:71], a[120:123]
  v_mfma_f32_16x16x32_bf16 a[124:127], a[20:23], v[72:75], a[124:127]
  v_readlane_b32 s96, v21, 23
  v_mfma_f32_16x16x32_bf16 a[128:131], a[24:27], v[60:63], a[128:131]
  v_mfma_f32_16x16x32_bf16 a[132:135], a[24:27], v[64:67], a[132:135]
  buffer_load_dwordx4 v[52:55], v20, s[24:27], s49 offen offset:2048 sc0 sc1
  v_mfma_f32_16x16x32_bf16 a[136:139], a[24:27], v[68:71], a[136:139]
  v_mfma_f32_16x16x32_bf16 a[140:143], a[24:27], v[72:75], a[140:143]
  buffer_load_dwordx4 v[200:203], v20, s[24:27], s96 offen offset:3072 sc0 sc1
  v_mfma_f32_16x16x32_bf16 a[144:147], a[28:31], v[60:63], a[144:147]
  v_mfma_f32_16x16x32_bf16 a[148:151], a[28:31], v[64:67], a[148:151]
  buffer_load_dwordx4 v[56:59], v20, s[24:27], s49 offen offset:3072 sc0 sc1
  v_mfma_f32_16x16x32_bf16 a[152:155], a[28:31], v[68:71], a[152:155]
  v_mfma_f32_16x16x32_bf16 a[156:159], a[28:31], v[72:75], a[156:159]
  v_mfma_f32_16x16x32_bf16 a[160:163], a[32:35], v[60:63], a[160:163]
  v_mfma_f32_16x16x32_bf16 a[164:167], a[32:35], v[64:67], a[164:167]
  v_mfma_f32_16x16x32_bf16 a[168:171], a[32:35], v[68:71], a[168:171]
  s_waitcnt vmcnt(10)
  v_mfma_f32_16x16x32_bf16 a[172:175], a[32:35], v[72:75], a[172:175]
L_cutr:
  v_mfma_f32_16x16x32_bf16 a[96:99], a[36:39], v[76:79], a[96:99]
  v_mfma_f32_16x16x32_bf16 a[100:103], a[36:39], v[80:83], a[100:103]
  buffer_load_dwordx4 v[60:63], v20, s[24:27], s50 offen offset:0 sc0 sc1
  v_mfma_f32_16x16x32_bf16 a[104:107], a[36:39], v[84:87], a[104:107]
  v_mfma_f32_16x16x32_bf16 a[108:111], a[36:39], v[88:91], a[108:111]
  v_mfma_f32_16x16x32_bf16 a[112:115], a[40:43], v[76:79], a[112:115]
  v_mfma_f32_16x16x32_bf16 a[116:119], a[40:43], v[80:83], a[116:119]
  buffer_load_dwordx4 v[64:67], v20, s[24:27], s50 offen offset:1024 sc0 sc1
  v_mfma_f32_16x16x32_bf16 a[120:123], a[40:43], v[84:87], a[120:123]
  v_mfma_f32_16x16x32_bf16 a[124:127], a[40:43], v[88:91], a[124:127]
  v_readlane_b32 s96, v21, 23
  v_mfma_f32_16x16x32_bf16 a[128:131], a[44:47], v[76:79], a[128:131]
  v_mfma_f32_16x16x32_bf16 a[132:135], a[44:47], v[80:83], a[132:135]
  buffer_load_dwordx4 v[68:71], v20, s[24:27], s50 offen offset:2048 sc0 sc1
  v_mfma_f32_16x16x32_bf16 a[136:139], a[44:47], v[84:87], a[136:139]
  v_mfma_f32_16x16x32_bf16 a[140:143], a[44:47], v[88:91], a[140:143]
  buffer_load_dwordx4 v[204:207], v94, s[24:27], s96 offen offset:0 sc0 sc1
  v_mfma_f32_16x16x32_bf16 a[144:147], a[48:51], v[76:79], a[144:147]
  v_mfma_f32_16x16x32_bf16 a[148:151], a[48:51], v[80:83], a[148:151]
  buffer_load_dwordx4 v[72:75], v20, s[24:27], s50 offen offset:3072 sc0 sc1
  v_mfma_f32_16x16x32_bf16 a[152:155], a[48:51], v[84:87], a[152:155]
  v_mfma_f32_16x16x32_bf16 a[156:159], a[48:51], v[88:91], a[156:159]
  v_mfma_f32_16x16x32_bf16 a[160:163], a[52:55], v[76:79], a[160:163]
  v_mfma_f32_16x16x32_bf16 a[164:167], a[52:55], v[80:83], a[164:167]
  v_mfma_f32_16x16x32_bf16 a[168:171], a[52:55], v[84:87], a[168:171]
  s_waitcnt vmcnt(10)
  v_mfma_f32_16x16x32_bf16 a[172:175], a[52:55], v[88:91], a[172:175]
  v_mfma_f32_16x16x32_bf16 a[96:99], a[56:59], v[28:31], a[96:99]
  v_mfma_f32_16x16x32_bf16 a[100:103], a[56:59], v[32:35], a[100:103]
  buffer_load_dwordx4 v[76:79], v20, s[24:27], s51 offen offset:0 sc0 sc1
  v_mfma_f32_16x16x32_bf16 a[104:107], a[56:59], v[36:39], a[104:107]
  v_mfma_f32_16x16x32_bf16 a[108:111], a[56:59], v[40:43], a[108:111]
  v_mfma_f32_16x16x32_bf16 a[112:115], a[60:63], v[28:31], a[112:115]
  v_mfma_f32_16x16x32_bf16 a[116:119], a[60:63], v[32:35], a[116:119]
  buffer_load_dwordx4 v[80:83], v20, s[24:27], s51 offen offset:1024 sc0 sc1
  v_mfma_f32_16x16x32_bf16 a[120:123], a[60:63], v[36:39], a[120:123]
  v_mfma_f32_16x16x32_bf16 a[124:127], a[60:63], v[40:43], a[124:127]
  v_mfma_f32_16x16x32_bf16 a[128:131], v[96:99], v[28:31], a[128:131]
  v_mfma_f32_16x16x32_bf16 a[132:135], v[96:99], v[32:35], a[132:135]
  buffer_load_dwordx4 v[84:87], v20, s[24:27], s51 offen offset:2048 sc0 sc1
  v_mfma_f32_16x16x32_bf16 a[136:139], v[96:99], v[36:39], a[136:139]
  v_mfma_f32_16x16x32_bf16 a[140:143], v[96:99], v[40:43], a[140:143]
  v_mfma_f32_16x16x32_bf16 a[144:147], v[100:103], v[28:31], a[144:147]
  v_mfma_f32_16x16x32_bf16 a[148:151], v[100:103], v[32:35], a[148:151]
  buffer_load_dwordx4 v[88:91], v20, s[24:27], s51 offen offset:3072 sc0 sc1
  v_mfma_f32_16x16x32_bf16 a[152:155], v[100:103], v[36:39], a[152:155]
  v_mfma_f32_16x16x32_bf16 a[156:159], v[100:103], v[40:43], a[156:159]
  v_mfma_f32_16x16x32_bf16 a[160:163], v[104:107], v[28:31], a[160:163]
  v_mfma_f32_16x16x32_bf16 a[164:167], v[104:107], v[32:35], a[164:167]
  v_mfma_f32_16x16x32_bf16 a[168:171], v[104:107], v[36:39], a[168:171]
  s_waitcnt vmcnt(9)
  v_mfma_f32_16x16x32_bf16 a[172:175], v[104:107], v[40:43], a[172:175]
  v_mfma_f32_16x16x32_bf16 a[96:99], v[108:111], v[44:47], a[96:99]
  v_mfma_f32_16x16x32_bf16 a[100:103], v[108:111], v[48:51], a[100:103]
  v_mfma_f32_16x16x32_bf16 a[104:107], v[108:111], v[52:55], a[104:107]
  v_mfma_f32_16x16x32_bf16 a[108:111], v[108:111], v[56:59], a[108:111]
  v_mfma_f32_16x16x32_bf16 a[112:115], v[112:115], v[44:47], a[112:115]
  v_mfma_f32_16x16x32_bf16 a[116:119], v[112:115], v[48:51], a[116:119]
  v_mfma_f32_16x16x32_bf16 a[120:123], v[112:115], v[52:55], a[120:123]
  v_mfma_f32_16x16x32_bf16 a[124:127], v[112:115], v[56:59], a[124:127]
  v_mfma_f32_16x16x32_bf16 a[128:131], v[116:119], v[44:47], a[128:131]
  v_mfma_f32_16x16x32_bf16 a[132:135], v[116:119], v[48:51], a[132:135]
  v_mfma_f32_16x16x32_bf16 a[136:139], v[116:119], v[52:55], a[136:139]
  v_mfma_f32_16x16x32_bf16 a[140:143], v[116:119], v[56:59], a[140:143]
  v_mfma_f32_16x16x32_bf16 a[144:147], v[120:123], v[44:47], a[144:147]
  v_mfma_f32_16x16x32_bf16 a[148:151], v[120:123], v[48:51], a[148:151]
  v_mfma_f32_16x16x32_bf16 a[152:155], v[120:123], v[52:55], a[152:155]
  v_mfma_f32_16x16x32_bf16 a[156:159], v[120:123], v[56:59], a[156:159]
  v_mfma_f32_16x16x32_bf16 a[160:163], v[124:127], v[44:47], a[160:163]
  v_mfma_f32_16x16x32_bf16 a[164:167], v[124:127], v[48:51], a[164:167]
  v_mfma_f32_16x16x32_bf16 a[168:171], v[124:127], v[52:55], a[168:171]
  s_waitcnt vmcnt(4)
  v_mfma_f32_16x16x32_bf16 a[172:175], v[124:127], v[56:59], a[172:175]
  v_mfma_f32_16x16x32_bf16 a[96:99], v[168:171], v[60:63], a[96:99]
  v_mfma_f32_16x16x32_bf16 a[100:103], v[168:171], v[64:67], a[100:103]
  v_mfma_f32_16x16x32_bf16 a[104:107], v[168:171], v[68:71], a[104:107]
  v_mfma_f32_16x16x32_bf16 a[108:111], v[168:171], v[72:75], a[108:111]
  v_mfma_f32_16x16x32_bf16 a[112:115], v[172:175], v[60:63], a[112:115]
  v_mfma_f32_16x16x32_bf16 a[116:119], v[172:175], v[64:67], a[116:119]
  v_mfma_f32_16x16x32_bf16 a[120:123], v[172:175], v[68:71], a[120:123]
  v_mfma_f32_16x16x32_bf16 a[124:127], v[172:175], v[72:75], a[124:127]
  v_mfma_f32_16x16x32_bf16 a[128:131], v[176:179], v[60:63], a[128:131]
  v_mfma_f32_16x16x32_bf16 a[132:135], v[176:179], v[64:67], a[132:135]
  v_mfma_f32_16x16x32_bf16 a[136:139], v[176:179], v[68:71], a[136:139]
  v_mfma_f32_16x16x32_bf16 a[140:143], v[176:179], v[72:75], a[140:143]
  v_mfma_f32_16x16x32_bf16 a[144:147], v[180:183], v[60:63], a[144:147]
  v_mfma_f32_16x16x32_bf16 a[148:151], v[180:183], v[64:67], a[148:151]
  v_mfma_f32_16x16x32_bf16 a[152:155], v[180:183], v[68:71], a[152:155]
  v_mfma_f32_16x16x32_bf16 a[156:159], v[180:183], v[72:75], a[156:159]
  v_mfma_f32_16x16x32_bf16 a[160:163], v[184:187], v[60:63], a[160:163]
  v_mfma_f32_16x16x32_bf16 a[164:167], v[184:187], v[64:67], a[164:167]
  v_mfma_f32_16x16x32_bf16 a[168:171], v[184:187], v[68:71], a[168:171]
  s_waitcnt vmcnt(0)
  v_mfma_f32_16x16x32_bf16 a[172:175], v[184:187], v[72:75], a[172:175]
  v_mfma_f32_16x16x32_bf16 a[96:99], v[188:191], v[76:79], a[96:99]
  v_mfma_f32_16x16x32_bf16 a[100:103], v[188:191], v[80:83], a[100:103]
  v_mfma_f32_16x16x32_bf16 a[104:107], v[188:191], v[84:87], a[104:107]
  v_mfma_f32_16x16x32_bf16 a[108:111], v[188:191], v[88:91], a[108:111]
  v_mfma_f32_16x16x32_bf16 a[112:115], v[192:195], v[76:79], a[112:115]
  v_mfma_f32_16x16x32_bf16 a[116:119], v[192:195], v[80:83], a[116:119]
  s_nop 2
  ds_write_b128 v15, a[96:99] offset:0
  v_mfma_f32_16x16x32_bf16 a[120:123], v[192:195], v[84:87], a[120:123]
  ds_write_b128 v15, a[100:103] offset:5120
  v_mfma_f32_16x16x32_bf16 a[124:127], v[192:195], v[88:91], a[124:127]
  ds_write_b128 v15, a[104:107] offset:40960
  v_mfma_f32_16x16x32_bf16 a[128:131], v[196:199], v[76:79], a[128:131]
  ds_write_b128 v15, a[108:111] offset:46080
  v_mfma_f32_16x16x32_bf16 a[132:135], v[196:199], v[80:83], a[132:135]
  ds_write_b128 v15, a[112:115] offset:64
  v_mfma_f32_16x16x32_bf16 a[136:139], v[196:199], v[84:87], a[136:139]
  ds_write_b128 v15, a[116:119] offset:5184
  v_mfma_f32_16x16x32_bf16 a[140:143], v[196:199], v[88:91], a[140:143]
  ds_write_b128 v15, a[120:123] offset:41024
  v_mfma_f32_16x16x32_bf16 a[144:147], v[200:203], v[76:79], a[144:147]
  ds_write_b128 v15, a[124:127] offset:46144
  v_mfma_f32_16x16x32_bf16 a[148:151], v[200:203], v[80:83], a[148:151]
  ds_write_b128 v15, a[128:131] offset:128
  v_mfma_f32_16x16x32_bf16 a[152:155], v[200:203], v[84:87], a[152:155]
  ds_write_b128 v15, a[132:135] offset:5248
  v_mfma_f32_16x16x32_bf16 a[156:159], v[200:203], v[88:91], a[156:159]
  ds_write_b128 v15, a[136:139] offset:41088
  v_mfma_f32_16x16x32_bf16 a[160:163], v[204:207], v[76:79], a[160:163]
  ds_write_b128 v15, a[140:143] offset:46208
  v_mfma_f32_16x16x32_bf16 a[164:167], v[204:207], v[80:83], a[164:167]
  ds_write_b128 v15, a[144:147] offset:192
  v_mfma_f32_16x16x32_bf16 a[168:171], v[204:207], v[84:87], a[168:171]
  ds_write_b128 v15, a[148:151] offset:5312
  v_mfma_f32_16x16x32_bf16 a[172:175], v[204:207], v[88:91], a[172:175]
  ds_write_b128 v15, a[152:155] offset:41152
  ds_write_b128 v15, a[156:159] offset:46272
  ds_write_b128 v15, a[160:163] offset:256
  s_nop 0
  ds_write_b128 v15, a[164:167] offset:5376
  s_nop 0
  ds_write_b128 v15, a[168:171] offset:41216
  s_nop 0
  ds_write_b128 v15, a[172:175] offset:46336
  s_waitcnt lgkmcnt(0)
  s_barrier
  s_lshl_b32 s91, s72, 1
  s_mov_b32 s84, 0xbfb8aa3b
  s_mov_b32 s85, s84
  ds_read_b128 v[44:47], v129 offset:10240
  ds_read_b128 v[36:39], v128 offset:20480
  ds_read_b128 v[40:43], v128 offset:30720
  ds_read_b128 v[28:31], v128 offset:0
  ds_read_b128 v[32:35], v128 offset:10240
  ds_read_b128 v[64:67], v129 offset:10304
  ds_read_b128 v[56:59], v128 offset:20544
  ds_read_b128 v[60:63], v128 offset:30784
  ds_read_b128 v[48:51], v128 offset:64
  ds_read_b128 v[52:55], v128 offset:10304
  ds_read_b128 v[84:87], v129 offset:10368
  ds_read_b128 v[76:79], v128 offset:20608
  ds_read_b128 v[80:83], v128 offset:30848
  ds_read_b128 v[68:71], v128 offset:128
  ds_read_b128 v[72:75], v128 offset:10368
  ds_read_b128 v[112:115], v129 offset:10432
  ds_read_b128 v[104:107], v128 offset:20672
  ds_read_b128 v[108:111], v128 offset:30912
  ds_read_b128 v[96:99], v128 offset:192
  ds_read_b128 v[100:103], v128 offset:10432
  ds_read_b128 v[184:187], v129 offset:10496
  ds_read_b128 v[176:179], v128 offset:20736
  ds_read_b128 v[180:183], v128 offset:30976
  ds_read_b128 v[168:171], v128 offset:256
  ds_read_b128 v[172:175], v128 offset:10496
  s_waitcnt lgkmcnt(15)
  v_pk_add_f32 v[36:37], v[36:37], v[44:45]
  v_pk_add_f32 v[38:39], v[38:39], v[46:47]
  v_pk_add_f32 v[36:37], v[36:37], v[40:41]
  v_pk_add_f32 v[38:39], v[38:39], v[42:43]
  v_cvt_pk_bf16_f32 v10, v36, v37
  v_cvt_pk_bf16_f32 v11, v38, v39
  v_lshlrev_b32_e32 v36, 16, v10
  v_and_b32_e32 v37, s31, v10
  v_lshlrev_b32_e32 v38, 16, v11
  v_and_b32_e64 v39, s31, v11
  v_pk_mul_f32 v[40:41], v[36:37], s[84:85]
  v_pk_mul_f32 v[42:43], v[38:39], s[84:85]
  v_exp_f32_e32 v40, v40
  v_exp_f32_e32 v41, v41
  v_exp_f32_e32 v42, v42
  v_exp_f32_e32 v43, v43
  v_pk_add_f32 v[28:29], v[28:29], v[32:33]
  v_pk_add_f32 v[30:31], v[30:31], v[34:35]
  v_pk_add_f32 v[40:41], v[40:41], 1.0 op_sel_hi:[1,0]
  v_pk_add_f32 v[42:43], v[42:43], 1.0 op_sel_hi:[1,0]
  v_rcp_f32_e32 v40, v40
  v_rcp_f32_e32 v41, v41
  v_rcp_f32_e32 v42, v42
  v_rcp_f32_e32 v43, v43
  v_pk_add_f32 v[28:29], v[28:29], v[148:149]
  v_pk_add_f32 v[30:31], v[30:31], v[150:151]
  v_pk_mul_f32 v[40:41], v[40:41], v[36:37]
  v_pk_mul_f32 v[42:43], v[42:43], v[38:39]
  v_cvt_pk_bf16_f32 v10, v40, v41
  v_cvt_pk_bf16_f32 v11, v42, v43
  v_lshlrev_b32_e32 v40, 16, v10
  v_and_b32_e32 v41, s31, v10
  v_lshlrev_b32_e32 v42, 16, v11
  v_and_b32_e32 v43, s31, v11
  v_pk_fma_f32 v[28:29], v[28:29], v[40:41], v[208:209]
  v_pk_fma_f32 v[30:31], v[30:31], v[42:43], v[210:211]
  buffer_store_dwordx4 v[28:31], v130, s[80:83], s91 offen offset:0 sc0 sc1 nt
  v_pk_add_f32 v[56:57], v[56:57], v[64:65]
  v_pk_add_f32 v[58:59], v[58:59], v[66:67]
  v_pk_add_f32 v[56:57], v[56:57], v[60:61]
  v_pk_add_f32 v[58:59], v[58:59], v[62:63]
  v_cvt_pk_bf16_f32 v10, v56, v57
  v_cvt_pk_bf16_f32 v11, v58, v59
  v_lshlrev_b32_e32 v56, 16, v10
  v_and_b32_e32 v57, s31, v10
  v_lshlrev_b32_e32 v58, 16, v11
  v_and_b32_e32 v59, s31, v11
  v_pk_mul_f32 v[60:61], v[56:57], s[84:85]
  v_pk_mul_f32 v[62:63], v[58:59], s[84:85]
  v_exp_f32_e32 v60, v60
  v_exp_f32_e32 v61, v61
  v_exp_f32_e32 v62, v62
  v_exp_f32_e32 v63, v63
  v_pk_add_f32 v[48:49], v[48:49], v[52:53]
  v_pk_add_f32 v[50:51], v[50:51], v[54:55]
  v_pk_add_f32 v[60:61], v[60:61], 1.0 op_sel_hi:[1,0]
  v_pk_add_f32 v[62:63], v[62:63], 1.0 op_sel_hi:[1,0]
  v_rcp_f32_e32 v60, v60
  v_rcp_f32_e32 v61, v61
  v_rcp_f32_e32 v62, v62
  v_rcp_f32_e32 v63, v63
  v_pk_add_f32 v[48:49], v[48:49], v[152:153]
  v_pk_add_f32 v[50:51], v[50:51], v[154:155]
  v_pk_mul_f32 v[60:61], v[60:61], v[56:57]
  v_pk_mul_f32 v[62:63], v[62:63], v[58:59]
  v_cvt_pk_bf16_f32 v10, v60, v61
  v_cvt_pk_bf16_f32 v11, v62, v63
  v_lshlrev_b32_e32 v60, 16, v10
  v_and_b32_e32 v61, s31, v10
  v_lshlrev_b32_e32 v62, 16, v11
  v_and_b32_e32 v63, s31, v11
  v_pk_fma_f32 v[48:49], v[48:49], v[60:61], v[212:213]
  v_pk_fma_f32 v[50:51], v[50:51], v[62:63], v[214:215]
  buffer_store_dwordx4 v[48:51], v130, s[80:83], s91 offen offset:64 sc0 sc1 nt
  s_waitcnt lgkmcnt(12)
  v_pk_add_f32 v[76:77], v[76:77], v[84:85]
  v_pk_add_f32 v[78:79], v[78:79], v[86:87]
  v_pk_add_f32 v[76:77], v[76:77], v[80:81]
  v_pk_add_f32 v[78:79], v[78:79], v[82:83]
  v_cvt_pk_bf16_f32 v10, v76, v77
  v_cvt_pk_bf16_f32 v11, v78, v79
  v_lshlrev_b32_e32 v76, 16, v10
  v_and_b32_e32 v77, s31, v10
  v_lshlrev_b32_e32 v78, 16, v11
  v_and_b32_e64 v79, s31, v11
  v_pk_mul_f32 v[80:81], v[76:77], s[84:85]
  v_pk_mul_f32 v[82:83], v[78:79], s[84:85]
  v_exp_f32_e32 v80, v80
  v_exp_f32_e32 v81, v81
  v_exp_f32_e32 v82, v82
  v_exp_f32_e32 v83, v83
  s_waitcnt lgkmcnt(10)
  v_pk_add_f32 v[68:69], v[68:69], v[72:73]
  v_pk_add_f32 v[70:71], v[70:71], v[74:75]
  v_pk_add_f32 v[80:81], v[80:81], 1.0 op_sel_hi:[1,0]
  v_pk_add_f32 v[82:83], v[82:83], 1.0 op_sel_hi:[1,0]
  v_rcp_f32_e32 v80, v80
  v_rcp_f32_e32 v81, v81
  v_rcp_f32_e32 v82, v82
  v_rcp_f32_e64 v83, v83
  v_pk_add_f32 v[68:69], v[68:69], v[156:157]
  v_pk_add_f32 v[70:71], v[70:71], v[158:159]
  v_pk_mul_f32 v[80:81], v[80:81], v[76:77]
  v_pk_mul_f32 v[82:83], v[82:83], v[78:79]
  v_cvt_pk_bf16_f32 v10, v80, v81
  v_cvt_pk_bf16_f32 v11, v82, v83
  v_lshlrev_b32_e32 v80, 16, v10
  v_and_b32_e32 v81, s31, v10
  v_lshlrev_b32_e32 v82, 16, v11
  v_and_b32_e32 v83, s31, v11
  v_pk_fma_f32 v[68:69], v[68:69], v[80:81], v[216:217]
  v_pk_fma_f32 v[70:71], v[70:71], v[82:83], v[218:219]
  buffer_store_dwordx4 v[68:71], v130, s[80:83], s91 offen offset:128 sc0 sc1 nt
  s_waitcnt lgkmcnt(7)
  v_pk_add_f32 v[104:105], v[104:105], v[112:113]
  v_pk_add_f32 v[106:107], v[106:107], v[114:115]
  v_pk_add_f32 v[104:105], v[104:105], v[108:109]
  v_pk_add_f32 v[106:107], v[106:107], v[110:111]
  v_cvt_pk_bf16_f32 v10, v104, v105
  v_cvt_pk_bf16_f32 v11, v106, v107
  v_lshlrev_b32_e32 v104, 16, v10
  v_and_b32_e32 v105, s31, v10
  v_lshlrev_b32_e32 v106, 16, v11
  v_and_b32_e64 v107, s31, v11
  v_pk_mul_f32 v[108:109], v[104:105], s[84:85]
  v_pk_mul_f32 v[110:111], v[106:107], s[84:85]
  v_exp_f32_e32 v108, v108
  v_exp_f32_e32 v109, v109
  v_exp_f32_e32 v110, v110
  v_exp_f32_e32 v111, v111
  s_waitcnt lgkmcnt(5)
  v_pk_add_f32 v[96:97], v[96:97], v[100:101]
  v_pk_add_f32 v[98:99], v[98:99], v[102:103]
  v_pk_add_f32 v[108:109], v[108:109], 1.0 op_sel_hi:[1,0]
  v_pk_add_f32 v[110:111], v[110:111], 1.0 op_sel_hi:[1,0]
  v_rcp_f32_e32 v108, v108
  v_rcp_f32_e32 v109, v109
  v_rcp_f32_e32 v110, v110
  v_rcp_f32_e64 v111, v111
  v_pk_add_f32 v[96:97], v[96:97], v[160:161]
  v_pk_add_f32 v[98:99], v[98:99], v[162:163]
  v_pk_mul_f32 v[108:109], v[108:109], v[104:105]
  v_pk_mul_f32 v[110:111], v[110:111], v[106:107]
  v_cvt_pk_bf16_f32 v10, v108, v109
  v_cvt_pk_bf16_f32 v11, v110, v111
  v_lshlrev_b32_e32 v108, 16, v10
  v_and_b32_e32 v109, s31, v10
  v_lshlrev_b32_e32 v110, 16, v11
  v_and_b32_e32 v111, s31, v11
  v_pk_fma_f32 v[96:97], v[96:97], v[108:109], v[220:221]
  v_pk_fma_f32 v[98:99], v[98:99], v[110:111], v[222:223]
  buffer_store_dwordx4 v[96:99], v130, s[80:83], s91 offen offset:192 sc0 sc1 nt
  s_waitcnt lgkmcnt(2)
  v_pk_add_f32 v[176:177], v[176:177], v[184:185]
  v_pk_add_f32 v[178:179], v[178:179], v[186:187]
  v_pk_add_f32 v[176:177], v[176:177], v[180:181]
  v_pk_add_f32 v[178:179], v[178:179], v[182:183]
  v_cvt_pk_bf16_f32 v10, v176, v177
  v_cvt_pk_bf16_f32 v11, v178, v179
  v_lshlrev_b32_e32 v176, 16, v10
  v_and_b32_e32 v177, s31, v10
  v_lshlrev_b32_e32 v178, 16, v11
  v_and_b32_e64 v179, s31, v11
  v_pk_mul_f32 v[180:181], v[176:177], s[84:85]
  v_pk_mul_f32 v[182:183], v[178:179], s[84:85]
  v_exp_f32_e32 v180, v180
  v_exp_f32_e32 v181, v181
  v_exp_f32_e32 v182, v182
  v_exp_f32_e32 v183, v183
  s_waitcnt lgkmcnt(0)
  v_pk_add_f32 v[168:169], v[168:169], v[172:173]
  v_pk_add_f32 v[170:171], v[170:171], v[174:175]
  v_pk_add_f32 v[180:181], v[180:181], 1.0 op_sel_hi:[1,0]
  v_pk_add_f32 v[182:183], v[182:183], 1.0 op_sel_hi:[1,0]
  v_rcp_f32_e32 v180, v180
  v_rcp_f32_e32 v181, v181
  v_rcp_f32_e32 v182, v182
  v_rcp_f32_e64 v183, v183
  v_pk_add_f32 v[168:169], v[168:169], v[164:165]
  v_pk_add_f32 v[170:171], v[170:171], v[166:167]
  v_pk_mul_f32 v[180:181], v[180:181], v[176:177]
  v_pk_mul_f32 v[182:183], v[182:183], v[178:179]
  v_cvt_pk_bf16_f32 v10, v180, v181
  v_cvt_pk_bf16_f32 v11, v182, v183
  v_lshlrev_b32_e32 v180, 16, v10
  v_and_b32_e32 v181, s31, v10
  v_lshlrev_b32_e32 v182, 16, v11
  v_and_b32_e32 v183, s31, v11
  v_pk_fma_f32 v[168:169], v[168:169], v[180:181], v[224:225]
  v_pk_fma_f32 v[170:171], v[170:171], v[182:183], v[226:227]
  buffer_store_dwordx4 v[168:171], v130, s[80:83], s91 offen offset:256 sc0 sc1 nt
L_end:
  s_endpgm
L_p31:
  s_mov_b32 s85, 0
L_p321:
  buffer_load_dword v55, v54, s[24:27], s43 offen sc0 sc1
  s_add_u32 s85, s85, 1
  s_waitcnt vmcnt(0)
  v_cmp_ne_u32 vcc, s44, v55
  s_cmp_gt_u32 s85, 0x40000
  s_cbranch_scc1 L_p3r1
  s_cbranch_vccz L_p3r1
  s_sleep 1
  s_branch L_p321
L_f21:
  s_mov_b32 s86, 0
L_f221:
  s_sleep 4
  buffer_load_dwordx4 v[38:41], v52, s[24:27], s87 offen sc0 sc1
  s_add_u32 s86, s86, 1
  s_waitcnt vmcnt(0)
  v_bitop3_b32 v38, v38, v39, s77 bitop3:0x7e
  v_bitop3_b32 v40, v40, v41, s77 bitop3:0x7e
  v_or_b32_e32 v38, v38, v40
  v_cmp_ne_u32 vcc, 0, v38
  s_cmp_gt_u32 s86, 0x20000
  s_cbranch_scc1 L_f2r1
  s_cbranch_vccnz L_f221
  s_branch L_f2r1
L_gr1:
  s_mov_b32 s86, 0
L_gr21:
  s_sleep 4
  s_movk_i32 s87, 1024
  buffer_load_dwordx4 v[124:127], v46, s[36:39], s87 offen offset:0 sc0 sc1
  buffer_load_dwordx4 v[120:123], v46, s[36:39], s87 offen offset:1024 sc0 sc1
  buffer_load_dwordx4 v[116:119], v46, s[36:39], s87 offen offset:2048 sc0 sc1
  buffer_load_dwordx4 v[112:115], v46, s[36:39], s87 offen offset:3072 sc0 sc1
  s_movk_i32 s87, 5120
  buffer_load_dwordx4 v[108:111], v46, s[36:39], s87 offen offset:0 sc0 sc1
  buffer_load_dwordx4 v[104:107], v46, s[36:39], s87 offen offset:1024 sc0 sc1
  buffer_load_dwordx4 v[100:103], v46, s[36:39], s87 offen offset:2048 sc0 sc1
  buffer_load_dwordx4 v[96:99], v46, s[36:39], s87 offen offset:3072 sc0 sc1
  s_add_u32 s86, s86, 1
  s_waitcnt vmcnt(0)
  v_mov_b32_e64 v48, v28
  v_bitop3_b32 v97, v97, v99, s32 bitop3:0x7e
  v_min_u32_e64 v97, 1, v97
  v_bitop3_b32 v101, v101, v103, s32 bitop3:0x7e
  v_min_u32_e64 v101, 1, v101
  v_add3_u32 v48, v48, v101, v97
  v_bitop3_b32 v105, v105, v107, s32 bitop3:0x7e
  v_min_u32_e64 v105, 1, v105
  v_bitop3_b32 v109, v109, v111, s32 bitop3:0x7e
  v_min_u32_e64 v109, 1, v109
  v_add3_u32 v48, v48, v109, v105
  v_bitop3_b32 v113, v113, v115, s32 bitop3:0x7e
  v_min_u32_e64 v113, 1, v113
  v_bitop3_b32 v117, v117, v119, s32 bitop3:0x7e
  v_min_u32_e64 v117, 1, v117
  v_add3_u32 v48, v48, v117, v113
  v_bitop3_b32 v121, v121, v123, s32 bitop3:0x7e
  v_min_u32_e64 v121, 1, v121
  v_bitop3_b32 v125, v125, v127, s32 bitop3:0x7e
  v_min_u32_e64 v125, 1, v125
  v_add3_u32 v48, v48, v125, v121
  v_cmp_ne_u32 vcc, 8, v48
  s_cmp_gt_u32 s86, 0x10000
  s_cbranch_scc1 L_grr1
  s_cbranch_vccnz L_gr21
  s_branch L_grr1
L_p32:
  s_mov_b32 s85, 0
L_p322:
  buffer_load_dword v55, v54, s[24:27], s43 offen sc0 sc1
  s_add_u32 s85, s85, 1
  s_waitcnt vmcnt(0)
  v_cmp_ne_u32 vcc, s44, v55
  s_cmp_gt_u32 s85, 0x40000
  s_cbranch_scc1 L_p3r2
  s_cbranch_vccz L_p3r2
  s_sleep 1
  s_branch L_p322
L_f22:
  s_mov_b32 s86, 0
L_f222:
  s_sleep 4
  buffer_load_dwordx4 v[60:63], v58, s[24:27], s87 offen sc0 sc1
  s_add_u32 s86, s86, 1
  s_waitcnt vmcnt(0)
  v_bitop3_b32 v60, v60, v61, s77 bitop3:0x7e
  v_bitop3_b32 v62, v62, v63, s77 bitop3:0x7e
  v_or_b32_e32 v60, v60, v62
  v_cmp_ne_u32 vcc, 0, v60
  s_cmp_gt_u32 s86, 0x20000
  s_cbranch_scc1 L_f2r2
  s_cbranch_vccnz L_f222
  s_branch L_f2r2
L_gr2:
  s_mov_b32 s86, 0
L_gr22:
  s_sleep 4
  s_movk_i32 s87, 1024
  buffer_load_dwordx4 v[152:155], v46, s[36:39], s87 offen offset:0 sc0 sc1
  buffer_load_dwordx4 v[148:151], v46, s[36:39], s87 offen offset:1024 sc0 sc1
  buffer_load_dwordx4 v[144:147], v46, s[36:39], s87 offen offset:2048 sc0 sc1
  buffer_load_dwordx4 v[140:143], v46, s[36:39], s87 offen offset:3072 sc0 sc1
  s_movk_i32 s87, 5120
  buffer_load_dwordx4 v[136:139], v46, s[36:39], s87 offen offset:0 sc0 sc1
  buffer_load_dwordx4 v[132:135], v46, s[36:39], s87 offen offset:1024 sc0 sc1
  buffer_load_dwordx4 v[128:131], v46, s[36:39], s87 offen offset:2048 sc0 sc1
  buffer_load_dwordx4 v[124:127], v46, s[36:39], s87 offen offset:3072 sc0 sc1
  s_movk_i32 s87, 9216
  buffer_load_dwordx4 v[120:123], v46, s[36:39], s87 offen offset:0 sc0 sc1
  buffer_load_dwordx4 v[116:119], v46, s[36:39], s87 offen offset:1024 sc0 sc1
  buffer_load_dwordx4 v[112:115], v46, s[36:39], s87 offen offset:2048 sc0 sc1
  buffer_load_dwordx4 v[108:111], v46, s[36:39], s87 offen offset:3072 sc0 sc1
  s_movk_i32 s87, 13312
  buffer_load_dwordx4 v[104:107], v46, s[36:39], s87 offen offset:0 sc0 sc1
  buffer_load_dwordx4 v[100:103], v46, s[36:39], s87 offen offset:1024 sc0 sc1
  buffer_load_dwordx4 v[96:99], v46, s[36:39], s87 offen offset:2048 sc0 sc1
  s_add_u32 s86, s86, 1
  s_waitcnt vmcnt(0)
  v_mov_b32_e32 v48, s29
  v_bitop3_b32 v97, v97, v99, s32 bitop3:0x7e
  v_min_u32_e64 v97, 1, v97
  v_bitop3_b32 v101, v101, v103, s32 bitop3:0x7e
  v_min_u32_e64 v101, 1, v101
  v_add3_u32 v48, v48, v101, v97
  v_bitop3_b32 v105, v105, v107, s32 bitop3:0x7e
  v_min_u32_e64 v105, 1, v105
  v_bitop3_b32 v109, v109, v111, s32 bitop3:0x7e
  v_min_u32_e64 v109, 1, v109
  v_add3_u32 v48, v48, v109, v105
  v_bitop3_b32 v113, v113, v115, s32 bitop3:0x7e
  v_min_u32_e64 v113, 1, v113
  v_bitop3_b32 v117, v117, v119, s32 bitop3:0x7e
  v_min_u32_e64 v117, 1, v117
  v_add3_u32 v48, v48, v117, v113
  v_bitop3_b32 v121, v121, v123, s32 bitop3:0x7e
  v_min_u32_e64 v121, 1, v121
  v_bitop3_b32 v125, v125, v127, s32 bitop3:0x7e
  v_min_u32_e64 v125, 1, v125
  v_add3_u32 v48, v48, v125, v121
  v_bitop3_b32 v129, v129, v131, s32 bitop3:0x7e
  v_min_u32_e64 v129, 1, v129
  v_bitop3_b32 v133, v133, v135, s32 bitop3:0x7e
  v_min_u32_e64 v133, 1, v133
  v_add3_u32 v48, v48, v133, v129
  v_bitop3_b32 v137, v137, v139, s32 bitop3:0x7e
  v_min_u32_e64 v137, 1, v137
  v_bitop3_b32 v141, v141, v143, s32 bitop3:0x7e
  v_min_u32_e64 v141, 1, v141
  v_add3_u32 v48, v48, v141, v137
  v_bitop3_b32 v145, v145, v147, s32 bitop3:0x7e
  v_min_u32_e64 v145, 1, v145
  v_bitop3_b32 v149, v149, v151, s32 bitop3:0x7e
  v_min_u32_e64 v149, 1, v149
  v_add3_u32 v48, v48, v149, v145
  v_bitop3_b32 v153, v153, v155, s32 bitop3:0x7e
  v_min_u32_e32 v153, 1, v153
  v_add_u32_e32 v48, v48, v153
  v_cmp_ne_u32 vcc, 15, v48
  s_cmp_gt_u32 s86, 0x10000
  s_cbranch_scc1 L_grr2
  s_cbranch_vccnz L_gr22
  s_branch L_grr2
L_poll:
  buffer_load_dword v17, v16, s[24:27], s84 offen sc0 sc1
  s_add_u32 s85, s85, 1
  s_waitcnt vmcnt(0)
  v_cmp_ne_u32 vcc, s77, v17
  s_cmp_gt_u32 s85, 0x40000
  s_cbranch_scc1 L_polld
  s_cbranch_vccz L_polld
  s_sleep 1
  s_branch L_poll
L_pl:
  buffer_load_dword v17, v16, s[24:27], s86 offen sc0 sc1
  s_add_u32 s85, s85, 1
  s_waitcnt vmcnt(0)
  v_cmp_ne_u32 vcc, s32, v17
  s_cmp_gt_u32 s85, 0x40000
  s_cbranch_scc1 L_plr
  s_cbranch_vccz L_plr
  s_sleep 1
  s_branch L_pl
.p2align 3
L_cut:
  s_nop 7
  buffer_load_dwordx4 v[76:79], v20, s[24:27], s47 offen offset:0 sc0 sc1
  ds_write_b128 v15, a[96:99] offset:0
  ds_write_b128 v15, a[100:103] offset:5120
  buffer_load_dwordx4 v[80:83], v20, s[24:27], s47 offen offset:1024 sc0 sc1
  ds_write_b128 v15, a[104:107] offset:40960
  v_readlane_b32 s96, v21, 23
  ds_write_b128 v15, a[108:111] offset:46080
  ds_write_b128 v15, a[112:115] offset:64
  buffer_load_dwordx4 v[84:87], v20, s[24:27], s47 offen offset:2048 sc0 sc1
  ds_write_b128 v15, a[116:119] offset:5184
  s_nop 0
  buffer_load_dwordx4 v[192:195], v20, s[24:27], s96 offen offset:1024 sc0 sc1
  ds_write_b128 v15, a[120:123] offset:41024
  ds_write_b128 v15, a[124:127] offset:46144
  buffer_load_dwordx4 v[88:91], v20, s[24:27], s47 offen offset:3072 sc0 sc1
  ds_write_b128 v15, a[128:131] offset:128
  s_waitcnt vmcnt(10)
  ds_write_b128 v15, a[132:135] offset:5248
  buffer_load_dwordx4 v[28:31], v20, s[24:27], s48 offen offset:0 sc0 sc1
  ds_write_b128 v15, a[136:139] offset:41088
  ds_write_b128 v15, a[140:143] offset:46208
  buffer_load_dwordx4 v[32:35], v20, s[24:27], s48 offen offset:1024 sc0 sc1
  ds_write_b128 v15, a[144:147] offset:192
  v_readlane_b32 s96, v21, 23
  ds_write_b128 v15, a[148:151] offset:5312
  ds_write_b128 v15, a[152:155] offset:41152
  buffer_load_dwordx4 v[36:39], v20, s[24:27], s48 offen offset:2048 sc0 sc1
  ds_write_b128 v15, a[156:159] offset:46272
  s_nop 0
  buffer_load_dwordx4 v[196:199], v20, s[24:27], s96 offen offset:2048 sc0 sc1
  ds_write_b128 v15, a[160:163] offset:256
  ds_write_b128 v15, a[164:167] offset:5376
  buffer_load_dwordx4 v[40:43], v20, s[24:27], s48 offen offset:3072 sc0 sc1
  ds_write_b128 v15, a[168:171] offset:41216
  s_waitcnt vmcnt(10)
  ds_write_b128 v15, a[172:175] offset:46336
  s_waitcnt lgkmcnt(0)
  v_add_u32 v15, 81920, v15
  v_mfma_f32_16x16x32_bf16 a[96:99], a[16:19], v[60:63], 0
  v_mfma_f32_16x16x32_bf16 a[100:103], a[16:19], v[64:67], 0
  buffer_load_dwordx4 v[44:47], v20, s[24:27], s49 offen offset:0 sc0 sc1
  v_mfma_f32_16x16x32_bf16 a[104:107], a[16:19], v[68:71], 0
  v_mfma_f32_16x16x32_bf16 a[108:111], a[16:19], v[72:75], 0
  v_mfma_f32_16x16x32_bf16 a[112:115], a[20:23], v[60:63], 0
  v_mfma_f32_16x16x32_bf16 a[116:119], a[20:23], v[64:67], 0
  buffer_load_dwordx4 v[48:51], v20, s[24:27], s49 offen offset:1024 sc0 sc1
  v_mfma_f32_16x16x32_bf16 a[120:123], a[20:23], v[68:71], 0
  v_mfma_f32_16x16x32_bf16 a[124:127], a[20:23], v[72:75], 0
  v_readlane_b32 s96, v21, 23
  v_mfma_f32_16x16x32_bf16 a[128:131], a[24:27], v[60:63], 0
  v_mfma_f32_16x16x32_bf16 a[132:135], a[24:27], v[64:67], 0
  buffer_load_dwordx4 v[52:55], v20, s[24:27], s49 offen offset:2048 sc0 sc1
  v_mfma_f32_16x16x32_bf16 a[136:139], a[24:27], v[68:71], 0
  v_mfma_f32_16x16x32_bf16 a[140:143], a[24:27], v[72:75], 0
  buffer_load_dwordx4 v[200:203], v20, s[24:27], s96 offen offset:3072 sc0 sc1
  v_mfma_f32_16x16x32_bf16 a[144:147], a[28:31], v[60:63], 0
  v_mfma_f32_16x16x32_bf16 a[148:151], a[28:31], v[64:67], 0
  buffer_load_dwordx4 v[56:59], v20, s[24:27], s49 offen offset:3072 sc0 sc1
  v_mfma_f32_16x16x32_bf16 a[152:155], a[28:31], v[68:71], 0
  v_mfma_f32_16x16x32_bf16 a[156:159], a[28:31], v[72:75], 0
  v_mfma_f32_16x16x32_bf16 a[160:163], a[32:35], v[60:63], 0
  v_mfma_f32_16x16x32_bf16 a[164:167], a[32:35], v[64:67], 0
  v_mfma_f32_16x16x32_bf16 a[168:171], a[32:35], v[68:71], 0
  s_waitcnt vmcnt(10)
  v_mfma_f32_16x16x32_bf16 a[172:175], a[32:35], v[72:75], 0
  s_branch L_cutr
.section .rodata,"a"
.p2align 6
.amdhsa_kernel recurrent_scan__ssm_conv_s5__glu_gated_reglu__prompt_kernel
  .amdhsa_next_free_vgpr 512
  .amdhsa_next_free_sgpr 102
  .amdhsa_accum_offset 256
  .amdhsa_group_segment_fixed_size 0
  .amdhsa_kernarg_size 128
  .amdhsa_user_sgpr_count 2
  .amdhsa_user_sgpr_kernarg_segment_ptr 1
  .amdhsa_system_sgpr_workgroup_id_x 1
.end_amdhsa_kernel
```
